```python
import torch

def _softmax(x, axis=-1):
    return torch.softmax(x, dim=axis)

def _gelu(x):
    return torch.nn.functional.gelu(x, approximate='tanh')

def _silu(x):
    return torch.nn.functional.silu(x)

def _sigmoid(x):
    return torch.sigmoid(x)

def _layernorm(x, axis=-1, eps=1e-05):
    m = x.mean(dim=axis, keepdim=True)
    v = x.var(dim=axis, keepdim=True, unbiased=False)
    return (x - m) / torch.sqrt(v + eps)

def _scatter_add(tgt, idx, src, axis=0):
    return tgt.clone().index_add_(axis, idx, src)

def _segment_sum(src, seg, n):
    out = torch.zeros((n,) + src.shape[1:], dtype=src.dtype)
    return out.index_add_(0, seg, src)

def _pad(x, pw):
    flat = tuple((v for pair in reversed(pw) for v in pair))
    return torch.nn.functional.pad(x, flat)
kernel_name = 'gated_mix__ssm_conv_s4d__mixer_gmlp__prompt'

def setup_inputs():

    _w = lambda a: (lambda t: t.to(torch.bfloat16) if t.is_floating_point() else t)(torch.as_tensor(a))

    def _A_setup():
        Bsz, L, D, N = (1, 2048, 576, 128)
        return {'u': _w((lambda *s: torch.randn(*s, dtype=torch.bfloat16) * 0.05)(Bsz, L, D)), 'log_A_real': _w((lambda *s: torch.randn(*s, dtype=torch.bfloat16) * 3.2)(D, N) * 0.5), 'A_imag': _w((lambda *s: torch.randn(*s, dtype=torch.bfloat16) * 0.05)(D, N) * 3.14), 'C_real': _w((lambda *s: torch.randn(*s, dtype=torch.bfloat16) * 3.2)(D, N) / N ** 0.5), 'C_imag': _w((lambda *s: torch.randn(*s, dtype=torch.bfloat16) * 3.2)(D, N) / N ** 0.5), 'log_dt': _w((lambda *s: torch.randn(*s, dtype=torch.bfloat16) * 0.05)(D) * 0.5 - 4.0), 'D_skip': _w((lambda *s: torch.randn(*s, dtype=torch.bfloat16) * 0.4)(D))}
    _A_in = _A_setup()

    def _B_setup():
        B, S, D, F = (1, 2048, 576, 4608)
        Fh = F // 2
        return {'x': _w((lambda *s: torch.randn(*s, dtype=torch.bfloat16) * 0.05)(B, S, D)), 'w_in': _w((lambda *s: torch.randn(*s, dtype=torch.bfloat16) * 0.2)(D, 2 * Fh)), 'w_sp': _w(0.01 * (lambda *s: torch.randn(*s, dtype=torch.bfloat16) * 0.2)(S, S)), 'b_sp': _w(1.0 + 0.01 * (lambda *s: torch.randn(*s, dtype=torch.bfloat16) * 0.05)(S)), 'w_out': _w((lambda *s: torch.randn(*s, dtype=torch.bfloat16) * 0.05)(Fh, D))}
    _B_in = _B_setup()
    return {'A_u': _A_in['u'], 'A_log_A_real': _A_in['log_A_real'], 'A_A_imag': _A_in['A_imag'], 'A_C_real': _A_in['C_real'], 'A_C_imag': _A_in['C_imag'], 'A_log_dt': _A_in['log_dt'], 'A_D_skip': _A_in['D_skip'], 'B_x': _B_in['x'], 'B_w_in': _B_in['w_in'], 'B_w_sp': _B_in['w_sp'], 'B_b_sp': _B_in['b_sp'], 'B_w_out': _B_in['w_out'], 'gate_w': _w((lambda *s: torch.randn(*s, dtype=torch.bfloat16) * 0.05)(576) * 16.0)}

def reference(A_u, A_log_A_real, A_A_imag, A_C_real, A_C_imag, A_log_dt, A_D_skip, B_x, B_w_in, B_w_sp, B_b_sp, B_w_out, gate_w):

    def _A_ref(u, log_A_real, A_imag, C_real, C_imag, log_dt, D_skip):
        L = u.shape[1]
        dt = torch.exp(log_dt)
        A = -torch.exp(log_A_real) + 1j * A_imag
        C = (C_real + 1j * C_imag) * dt[:, None]
        pos = (lambda x, dt: x.to(dt))(torch.arange(L), log_dt.dtype)
        P = torch.exp((A * dt[:, None])[:, :, None] * pos[None, None, :])
        K = 2.0 * torch.einsum('dn,dnl->dl', C, P).real
        L2 = 2 * L
        u_t = (lambda x, *d: x.permute(*d))(u, 0, 2, 1)
        Kf = (lambda x, *a, **k: torch.fft.rfft(x.float(), *a, **k))(K, L2)
        Uf = (lambda x, *a, **k: torch.fft.rfft(x.float(), *a, **k))(u_t, L2)
        y = (lambda x, *a, **k: torch.fft.irfft(x, *a, **k).to(torch.bfloat16))(Uf * Kf[None, :, :], L2)[:, :, :L]
        y = (lambda x, *d: x.permute(*d))(y, 0, 2, 1)
        return y + u * D_skip[None, None, :]

    def _B_ref(x, w_in, w_sp, b_sp, w_out):
        B, S, D = x.shape
        F = w_in.shape[-1]
        Fh = F // 2
        z = _gelu(torch.einsum('bsd,df->bsf', x, w_in))
        z1 = z[..., :Fh].clone()
        z2 = _layernorm(z[..., Fh:], axis=-1)
        g = torch.einsum('ts,bsf->btf', w_sp, z2) + b_sp[None, :, None]
        return torch.einsum('bsf,fd->bsd', z1 * g, w_out)
    x = A_u
    g = _sigmoid((x * gate_w).sum(-1, keepdims=True))
    a = _A_ref(x, A_log_A_real, A_A_imag, A_C_real, A_C_imag, A_log_dt, A_D_skip)
    b = _B_ref(x, B_w_in, B_w_sp, B_b_sp, B_w_out)
    return g * a + (1 - g) * b
```

```asm
; @launch kernel=mk_kernel grid=(256,1,1) block=(512,1,1) lds=163840
.amdgcn_target "amdgcn-amd-amdhsa--gfx950"
.text
.globl mk_kernel
.p2align 8
.type mk_kernel,@function
mk_kernel:
    s_cmp_ge_u32 s2, 256
    s_cbranch_scc1 L_mk_done
    s_load_dwordx2 s[24:25], s[0:1], 0
    s_load_dwordx2 s[26:27], s[0:1], 64
    s_load_dwordx4 s[28:31], s[0:1], 112
    v_lshrrev_b32 v12, 6, v0
    v_and_b32 v3, 63, v0
    v_lshlrev_b32 v1, 4, v3
    v_and_b32 v2, 255, v0
    v_readfirstlane_b32 s20, v12
    s_and_b32 s18, s2, 7
    s_lshr_b32 s19, s2, 3
    s_and_b32 s16, s18, 3
    s_lshl_b32 s16, s16, 2
    s_and_b32 s17, s19, 3
    s_add_u32 s16, s16, s17
    s_lshr_b32 s17, s18, 2
    s_lshl_b32 s17, s17, 3
    s_lshr_b32 s19, s19, 2
    s_add_u32 s17, s17, s19
    s_and_b32 s21, s20, 3
    s_mov_b32 s53, 0
    s_mov_b32 s23, 0
    v_mov_b32 v230, 0
    v_lshrrev_b32 v14, 3, v3
    v_add_u32 v14, 0, v14
    v_bfe_u32 v15, v14, 1, 3
    v_and_b32 v13, 7, v3
    v_xor_b32 v15, v15, v13
    v_and_b32 v13, 3, v14
    v_bfe_u32 v12, v14, 2, 2
    v_lshl_add_u32 v13, v12, 3, v13
    v_lshrrev_b32 v12, 4, v14
    v_lshl_add_u32 v14, v12, 2, v13
    v_mul_u32_u24 v14, 1152, v14
    v_lshl_add_u32 v221, v15, 4, v14
    v_lshrrev_b32 v14, 3, v3
    v_add_u32 v14, 8, v14
    v_bfe_u32 v15, v14, 1, 3
    v_and_b32 v13, 7, v3
    v_xor_b32 v15, v15, v13
    v_and_b32 v13, 3, v14
    v_bfe_u32 v12, v14, 2, 2
    v_lshl_add_u32 v13, v12, 3, v13
    v_lshrrev_b32 v12, 4, v14
    v_lshl_add_u32 v14, v12, 2, v13
    v_mul_u32_u24 v14, 1152, v14
    v_lshl_add_u32 v222, v15, 4, v14
    v_lshrrev_b32 v14, 3, v3
    v_add_u32 v14, 16, v14
    v_bfe_u32 v15, v14, 1, 3
    v_and_b32 v13, 7, v3
    v_xor_b32 v15, v15, v13
    v_and_b32 v13, 3, v14
    v_bfe_u32 v12, v14, 2, 2
    v_lshl_add_u32 v13, v12, 3, v13
    v_lshrrev_b32 v12, 4, v14
    v_lshl_add_u32 v14, v12, 2, v13
    v_mul_u32_u24 v14, 1152, v14
    v_lshl_add_u32 v223, v15, 4, v14
    v_lshrrev_b32 v14, 3, v3
    v_add_u32 v14, 24, v14
    v_bfe_u32 v15, v14, 1, 3
    v_and_b32 v13, 7, v3
    v_xor_b32 v15, v15, v13
    v_and_b32 v13, 3, v14
    v_bfe_u32 v12, v14, 2, 2
    v_lshl_add_u32 v13, v12, 3, v13
    v_lshrrev_b32 v12, 4, v14
    v_lshl_add_u32 v14, v12, 2, v13
    v_mul_u32_u24 v14, 1152, v14
    v_lshl_add_u32 v224, v15, 4, v14
    s_waitcnt lgkmcnt(0)
    s_mov_b32 s32, s24
    s_mov_b32 s33, s25
    s_mov_b32 s34, 0x240000
    s_mov_b32 s35, 0x00020000
    s_mov_b32 s36, s26
    s_mov_b32 s37, s27
    s_mov_b32 s38, 0x510000
    s_mov_b32 s39, 0x00020000
    s_mov_b32 s40, s30
    s_mov_b32 s41, s31
    s_mov_b32 s42, 0x10000000
    s_mov_b32 s43, 0x00020000
    s_mov_b32 s48, s28
    s_mov_b32 s49, s29
    s_mov_b32 s50, 0x100
    s_mov_b32 s51, 0x00020000
    s_mov_b32 s44, s24
    s_mov_b32 s45, s25
    s_mov_b32 s46, 0x240000
    s_mov_b32 s47, 0x00020000
    s_lshl_b32 s26, s21, 10
    s_lshl_b32 s27, s21, 12
    s_add_u32 s27, s27, 18432
    s_add_u32 s55, s26, 16384
    s_cmp_lt_u32 s21, 2
    s_cselect_b32 s24, s55, 34816
    s_lshl_b32 s29, s17, 2
    s_add_u32 s29, s29, s21
    s_mov_b32 s60, s29
    s_mul_i32 s29, s29, 36864
    s_mov_b32 s31, s29
    s_mul_i32 s30, s16, 288
    s_add_u32 s28, s30, 4608
    s_cmp_ge_u32 s20, 4
    s_cbranch_scc1 L_L
    s_setprio 1
    s_load_dwordx2 s[4:5], s[0:1], 72
    s_load_dwordx2 s[6:7], s[0:1], 80
    s_or_b32 s55, s21, s2
    s_cmp_lg_u32 s55, 0
    s_cbranch_scc1 L_nononce
    s_memrealtime s[56:57]
    s_waitcnt lgkmcnt(0)
    s_or_b32 s56, s56, 1
    v_mov_b32 v231, s56
    s_mov_b64 exec, 1
    buffer_store_dword v231, v230, s[48:51], 0 offen sc1
    s_mov_b64 exec, -1
L_nononce:
    s_and_b32 s64, s17, 7
    s_lshl_b32 s64, s64, 2
    s_add_u32 s64, s64, s21
    s_mul_i32 s64, s64, 165888
    s_and_b32 s56, s30, 0xffffff80
    s_add_u32 s64, s64, s56
    v_lshrrev_b32 v214, 2, v3
    v_mul_u32_u24 v214, 9216, v214
    v_and_b32 v15, 3, v3
    v_lshl_add_u32 v214, v15, 7, v214
    v_lshlrev_b32 v213, 7, v3
    v_mov_b32 v15, 0x40000000
    v_cmp_gt_u32 vcc, 8, v3
    s_nop 1
    v_cndmask_b32 v211, v15, v213, vcc
    v_cndmask_b32 v212, v15, v214, vcc
    s_getpc_b64 s[56:57]
L_pc_ref:
    s_lshr_b32 s55, s2, 3
    s_lshl_b32 s55, s55, 2
    s_add_u32 s55, s55, s21
    s_and_b32 s55, s55, 7
    s_lshl_b32 s55, s55, 13
    v_add_u32 v14, s55, v213
    v_min_u32 v14, L_mk_done-L_pc_ref, v14
    v_mov_b32 v15, s57
    v_add_co_u32 v14, vcc, s56, v14
    s_nop 1
    v_addc_co_u32 v15, vcc, 0, v15, vcc
    global_load_dword v226, v[14:15], off
    s_lshl_b32 s55, s17, 2
    s_and_b32 s56, s16, 3
    s_add_u32 s55, s55, s56
    s_lshl_b32 s55, s55, 2
    s_add_u32 s55, s55, s21
    s_mul_i32 s55, s55, 9216
    buffer_load_dword v226, v213, s[32:35], s55 offen
    s_add_u32 s56, s64, 4608
    buffer_load_dword v226, v214, s[36:39], s56 offen
    s_add_u32 s55, s55, 8192
    buffer_load_dword v226, v211, s[32:35], s55 offen
    s_add_u32 s56, s56, 147456
    buffer_load_dword v226, v212, s[36:39], s56 offen
    s_waitcnt lgkmcnt(0)
    v_lshrrev_b32 v14, 4, v3
    v_lshlrev_b32 v14, 2, v14
    v_bfe_u32 v15, v3, 2, 2
    v_add_u32 v14, v14, v15
    v_mul_u32_u24 v14, 288, v14
    v_and_b32 v15, 3, v3
    v_lshl_add_u32 v7, v15, 3, v14
    v_and_b32 v14, 15, v3
    v_lshlrev_b32 v14, 7, v14
    v_bfe_u32 v15, v3, 1, 3
    v_lshrrev_b32 v13, 4, v3
    v_xor_b32 v15, v15, v13
    v_lshl_add_u32 v14, v15, 4, v14
    s_lshl_b32 s55, s21, 12
    s_add_u32 s55, s55, 18432
    v_add_u32 v8, s55, v14
    v_xor_b32 v9, 64, v8
    v_add_u32 v10, s53, v7
    v_add_u32 v11, s53, v8
    v_add_u32 v12, s53, v9
    s_barrier
    ds_read_b128 v[124:127], v11 offset:0
    ds_read_b128 v[128:131], v11 offset:2048
    ds_read_b64_tr_b16 v[88:89], v10 offset:0
    ds_read_b64_tr_b16 v[90:91], v10 offset:4608
    ds_read_b64_tr_b16 v[92:93], v10 offset:32
    ds_read_b64_tr_b16 v[94:95], v10 offset:4640
    ds_read_b64_tr_b16 v[96:97], v10 offset:64
    ds_read_b64_tr_b16 v[98:99], v10 offset:4672
    ds_read_b64_tr_b16 v[100:101], v10 offset:96
    ds_read_b64_tr_b16 v[102:103], v10 offset:4704
    ds_read_b64_tr_b16 v[104:105], v10 offset:128
    ds_read_b64_tr_b16 v[106:107], v10 offset:4736
    ds_read_b64_tr_b16 v[108:109], v10 offset:160
    ds_read_b64_tr_b16 v[110:111], v10 offset:4768
    ds_read_b64_tr_b16 v[112:113], v10 offset:192
    ds_read_b64_tr_b16 v[114:115], v10 offset:4800
    ds_read_b64_tr_b16 v[116:117], v10 offset:224
    ds_read_b64_tr_b16 v[118:119], v10 offset:4832
    ds_read_b64_tr_b16 v[120:121], v10 offset:256
    ds_read_b64_tr_b16 v[122:123], v10 offset:4864
    s_waitcnt lgkmcnt(11)
    v_mfma_f32_16x16x32_bf16 v[16:19], v[124:127], v[88:91], 0
    ds_read_b128 v[132:135], v12 offset:0
    v_mfma_f32_16x16x32_bf16 v[20:23], v[128:131], v[88:91], 0
    ds_read_b128 v[136:139], v12 offset:2048
    ds_read_b64_tr_b16 v[88:89], v10 offset:9216
    v_mfma_f32_16x16x32_bf16 v[24:27], v[124:127], v[92:95], 0
    ds_read_b64_tr_b16 v[90:91], v10 offset:13824
    v_mfma_f32_16x16x32_bf16 v[28:31], v[128:131], v[92:95], 0
    ds_read_b64_tr_b16 v[92:93], v10 offset:9248
    ds_read_b64_tr_b16 v[94:95], v10 offset:13856
    v_mfma_f32_16x16x32_bf16 v[32:35], v[124:127], v[96:99], 0
    v_mfma_f32_16x16x32_bf16 v[36:39], v[128:131], v[96:99], 0
    ds_read_b64_tr_b16 v[96:97], v10 offset:9280
    s_waitcnt lgkmcnt(11)
    v_mfma_f32_16x16x32_bf16 v[40:43], v[124:127], v[100:103], 0
    ds_read_b64_tr_b16 v[98:99], v10 offset:13888
    s_add_u32 s53, s53, 36864
    s_cmp_ge_u32 s53, 147456
    s_cselect_b32 s53, 0, s53
    v_mfma_f32_16x16x32_bf16 v[44:47], v[128:131], v[100:103], 0
    ds_read_b64_tr_b16 v[100:101], v10 offset:9312
    v_add_u32 v13, s53, v7
    v_mfma_f32_16x16x32_bf16 v[48:51], v[124:127], v[104:107], 0
    ds_read_b64_tr_b16 v[102:103], v10 offset:13920
    v_add_u32 v14, s53, v8
    v_mfma_f32_16x16x32_bf16 v[52:55], v[128:131], v[104:107], 0
    ds_read_b64_tr_b16 v[104:105], v10 offset:9344
    v_add_u32 v15, s53, v9
    v_mfma_f32_16x16x32_bf16 v[56:59], v[124:127], v[108:111], 0
    ds_read_b64_tr_b16 v[106:107], v10 offset:13952
    s_mov_b32 s54, 1
    v_mfma_f32_16x16x32_bf16 v[60:63], v[128:131], v[108:111], 0
    ds_read_b64_tr_b16 v[108:109], v10 offset:9376
    s_waitcnt lgkmcnt(11)
    v_mfma_f32_16x16x32_bf16 v[64:67], v[124:127], v[112:115], 0
    ds_read_b64_tr_b16 v[110:111], v10 offset:13984
    v_mfma_f32_16x16x32_bf16 v[68:71], v[128:131], v[112:115], 0
    ds_read_b64_tr_b16 v[112:113], v10 offset:9408
    v_mfma_f32_16x16x32_bf16 v[72:75], v[124:127], v[116:119], 0
    ds_read_b64_tr_b16 v[114:115], v10 offset:14016
    v_mfma_f32_16x16x32_bf16 v[76:79], v[128:131], v[116:119], 0
    ds_read_b64_tr_b16 v[116:117], v10 offset:9440
    v_mfma_f32_16x16x32_bf16 v[80:83], v[124:127], v[120:123], 0
    ds_read_b64_tr_b16 v[118:119], v10 offset:14048
    v_mfma_f32_16x16x32_bf16 v[84:87], v[128:131], v[120:123], 0
    ds_read_b64_tr_b16 v[120:121], v10 offset:9472
    ds_read_b64_tr_b16 v[122:123], v10 offset:14080
L_c_z2:
    s_barrier
    s_waitcnt lgkmcnt(11)
    v_mfma_f32_16x16x32_bf16 v[16:19], v[132:135], v[88:91], v[16:19]
    ds_read_b128 v[124:127], v14 offset:0
    v_mfma_f32_16x16x32_bf16 v[20:23], v[136:139], v[88:91], v[20:23]
    ds_read_b128 v[128:131], v14 offset:2048
    ds_read_b64_tr_b16 v[88:89], v13 offset:0
    v_mfma_f32_16x16x32_bf16 v[24:27], v[132:135], v[92:95], v[24:27]
    ds_read_b64_tr_b16 v[90:91], v13 offset:4608
    v_mfma_f32_16x16x32_bf16 v[28:31], v[136:139], v[92:95], v[28:31]
    ds_read_b64_tr_b16 v[92:93], v13 offset:32
    ds_read_b64_tr_b16 v[94:95], v13 offset:4640
    v_mfma_f32_16x16x32_bf16 v[32:35], v[132:135], v[96:99], v[32:35]
    v_mfma_f32_16x16x32_bf16 v[36:39], v[136:139], v[96:99], v[36:39]
    ds_read_b64_tr_b16 v[96:97], v13 offset:64
    s_waitcnt lgkmcnt(11)
    v_mfma_f32_16x16x32_bf16 v[40:43], v[132:135], v[100:103], v[40:43]
    ds_read_b64_tr_b16 v[98:99], v13 offset:4672
    v_mfma_f32_16x16x32_bf16 v[44:47], v[136:139], v[100:103], v[44:47]
    ds_read_b64_tr_b16 v[100:101], v13 offset:96
    v_mfma_f32_16x16x32_bf16 v[48:51], v[132:135], v[104:107], v[48:51]
    ds_read_b64_tr_b16 v[102:103], v13 offset:4704
    v_mfma_f32_16x16x32_bf16 v[52:55], v[136:139], v[104:107], v[52:55]
    ds_read_b64_tr_b16 v[104:105], v13 offset:128
    v_mfma_f32_16x16x32_bf16 v[56:59], v[132:135], v[108:111], v[56:59]
    ds_read_b64_tr_b16 v[106:107], v13 offset:4736
    v_mfma_f32_16x16x32_bf16 v[60:63], v[136:139], v[108:111], v[60:63]
    ds_read_b64_tr_b16 v[108:109], v13 offset:160
    s_waitcnt lgkmcnt(11)
    v_mfma_f32_16x16x32_bf16 v[64:67], v[132:135], v[112:115], v[64:67]
    ds_read_b64_tr_b16 v[110:111], v13 offset:4768
    v_mfma_f32_16x16x32_bf16 v[68:71], v[136:139], v[112:115], v[68:71]
    ds_read_b64_tr_b16 v[112:113], v13 offset:192
    v_mfma_f32_16x16x32_bf16 v[72:75], v[132:135], v[116:119], v[72:75]
    ds_read_b64_tr_b16 v[114:115], v13 offset:4800
    v_mfma_f32_16x16x32_bf16 v[76:79], v[136:139], v[116:119], v[76:79]
    ds_read_b64_tr_b16 v[116:117], v13 offset:224
    v_mfma_f32_16x16x32_bf16 v[80:83], v[132:135], v[120:123], v[80:83]
    ds_read_b64_tr_b16 v[118:119], v13 offset:4832
    v_mfma_f32_16x16x32_bf16 v[84:87], v[136:139], v[120:123], v[84:87]
    ds_read_b64_tr_b16 v[120:121], v13 offset:256
    ds_read_b64_tr_b16 v[122:123], v13 offset:4864
    s_waitcnt lgkmcnt(11)
    v_mfma_f32_16x16x32_bf16 v[16:19], v[124:127], v[88:91], v[16:19]
    ds_read_b128 v[132:135], v15 offset:0
    v_mfma_f32_16x16x32_bf16 v[20:23], v[128:131], v[88:91], v[20:23]
    ds_read_b128 v[136:139], v15 offset:2048
    ds_read_b64_tr_b16 v[88:89], v13 offset:9216
    v_mfma_f32_16x16x32_bf16 v[24:27], v[124:127], v[92:95], v[24:27]
    ds_read_b64_tr_b16 v[90:91], v13 offset:13824
    v_mfma_f32_16x16x32_bf16 v[28:31], v[128:131], v[92:95], v[28:31]
    ds_read_b64_tr_b16 v[92:93], v13 offset:9248
    ds_read_b64_tr_b16 v[94:95], v13 offset:13856
    v_mfma_f32_16x16x32_bf16 v[32:35], v[124:127], v[96:99], v[32:35]
    v_mfma_f32_16x16x32_bf16 v[36:39], v[128:131], v[96:99], v[36:39]
    ds_read_b64_tr_b16 v[96:97], v13 offset:9280
    s_waitcnt lgkmcnt(11)
    v_mfma_f32_16x16x32_bf16 v[40:43], v[124:127], v[100:103], v[40:43]
    ds_read_b64_tr_b16 v[98:99], v13 offset:13888
    s_add_u32 s53, s53, 36864
    s_cmp_ge_u32 s53, 147456
    s_cselect_b32 s53, 0, s53
    v_mfma_f32_16x16x32_bf16 v[44:47], v[128:131], v[100:103], v[44:47]
    ds_read_b64_tr_b16 v[100:101], v13 offset:9312
    v_add_u32 v10, s53, v7
    v_mfma_f32_16x16x32_bf16 v[48:51], v[124:127], v[104:107], v[48:51]
    ds_read_b64_tr_b16 v[102:103], v13 offset:13920
    v_add_u32 v11, s53, v8
    v_mfma_f32_16x16x32_bf16 v[52:55], v[128:131], v[104:107], v[52:55]
    ds_read_b64_tr_b16 v[104:105], v13 offset:9344
    v_add_u32 v12, s53, v9
    v_mfma_f32_16x16x32_bf16 v[56:59], v[124:127], v[108:111], v[56:59]
    ds_read_b64_tr_b16 v[106:107], v13 offset:13952
    s_add_u32 s54, s54, 1
    v_mfma_f32_16x16x32_bf16 v[60:63], v[128:131], v[108:111], v[60:63]
    ds_read_b64_tr_b16 v[108:109], v13 offset:9376
    s_waitcnt lgkmcnt(11)
    v_mfma_f32_16x16x32_bf16 v[64:67], v[124:127], v[112:115], v[64:67]
    ds_read_b64_tr_b16 v[110:111], v13 offset:13984
    v_mfma_f32_16x16x32_bf16 v[68:71], v[128:131], v[112:115], v[68:71]
    ds_read_b64_tr_b16 v[112:113], v13 offset:9408
    v_mfma_f32_16x16x32_bf16 v[72:75], v[124:127], v[116:119], v[72:75]
    ds_read_b64_tr_b16 v[114:115], v13 offset:14016
    v_mfma_f32_16x16x32_bf16 v[76:79], v[128:131], v[116:119], v[76:79]
    ds_read_b64_tr_b16 v[116:117], v13 offset:9440
    v_mfma_f32_16x16x32_bf16 v[80:83], v[124:127], v[120:123], v[80:83]
    ds_read_b64_tr_b16 v[118:119], v13 offset:14048
    v_mfma_f32_16x16x32_bf16 v[84:87], v[128:131], v[120:123], v[84:87]
    ds_read_b64_tr_b16 v[120:121], v13 offset:9472
    ds_read_b64_tr_b16 v[122:123], v13 offset:14080
    s_waitcnt lgkmcnt(0)
    s_barrier
    s_waitcnt lgkmcnt(11)
    v_mfma_f32_16x16x32_bf16 v[16:19], v[132:135], v[88:91], v[16:19]
    ds_read_b128 v[124:127], v11 offset:0
    v_mfma_f32_16x16x32_bf16 v[20:23], v[136:139], v[88:91], v[20:23]
    ds_read_b128 v[128:131], v11 offset:2048
    ds_read_b64_tr_b16 v[88:89], v10 offset:0
    v_mfma_f32_16x16x32_bf16 v[24:27], v[132:135], v[92:95], v[24:27]
    ds_read_b64_tr_b16 v[90:91], v10 offset:4608
    v_mfma_f32_16x16x32_bf16 v[28:31], v[136:139], v[92:95], v[28:31]
    ds_read_b64_tr_b16 v[92:93], v10 offset:32
    ds_read_b64_tr_b16 v[94:95], v10 offset:4640
    v_mfma_f32_16x16x32_bf16 v[32:35], v[132:135], v[96:99], v[32:35]
    v_mfma_f32_16x16x32_bf16 v[36:39], v[136:139], v[96:99], v[36:39]
    ds_read_b64_tr_b16 v[96:97], v10 offset:64
    s_waitcnt lgkmcnt(11)
    v_mfma_f32_16x16x32_bf16 v[40:43], v[132:135], v[100:103], v[40:43]
    ds_read_b64_tr_b16 v[98:99], v10 offset:4672
    v_mfma_f32_16x16x32_bf16 v[44:47], v[136:139], v[100:103], v[44:47]
    ds_read_b64_tr_b16 v[100:101], v10 offset:96
    v_mfma_f32_16x16x32_bf16 v[48:51], v[132:135], v[104:107], v[48:51]
    ds_read_b64_tr_b16 v[102:103], v10 offset:4704
    v_mfma_f32_16x16x32_bf16 v[52:55], v[136:139], v[104:107], v[52:55]
    ds_read_b64_tr_b16 v[104:105], v10 offset:128
    v_mfma_f32_16x16x32_bf16 v[56:59], v[132:135], v[108:111], v[56:59]
    ds_read_b64_tr_b16 v[106:107], v10 offset:4736
    v_mfma_f32_16x16x32_bf16 v[60:63], v[136:139], v[108:111], v[60:63]
    ds_read_b64_tr_b16 v[108:109], v10 offset:160
    s_waitcnt lgkmcnt(11)
    v_mfma_f32_16x16x32_bf16 v[64:67], v[132:135], v[112:115], v[64:67]
    ds_read_b64_tr_b16 v[110:111], v10 offset:4768
    v_mfma_f32_16x16x32_bf16 v[68:71], v[136:139], v[112:115], v[68:71]
    ds_read_b64_tr_b16 v[112:113], v10 offset:192
    v_mfma_f32_16x16x32_bf16 v[72:75], v[132:135], v[116:119], v[72:75]
    ds_read_b64_tr_b16 v[114:115], v10 offset:4800
    v_mfma_f32_16x16x32_bf16 v[76:79], v[136:139], v[116:119], v[76:79]
    ds_read_b64_tr_b16 v[116:117], v10 offset:224
    v_mfma_f32_16x16x32_bf16 v[80:83], v[132:135], v[120:123], v[80:83]
    ds_read_b64_tr_b16 v[118:119], v10 offset:4832
    v_mfma_f32_16x16x32_bf16 v[84:87], v[136:139], v[120:123], v[84:87]
    ds_read_b64_tr_b16 v[120:121], v10 offset:256
    ds_read_b64_tr_b16 v[122:123], v10 offset:4864
    s_waitcnt lgkmcnt(11)
    v_mfma_f32_16x16x32_bf16 v[16:19], v[124:127], v[88:91], v[16:19]
    ds_read_b128 v[132:135], v12 offset:0
    v_mfma_f32_16x16x32_bf16 v[20:23], v[128:131], v[88:91], v[20:23]
    ds_read_b128 v[136:139], v12 offset:2048
    ds_read_b64_tr_b16 v[88:89], v10 offset:9216
    v_mfma_f32_16x16x32_bf16 v[24:27], v[124:127], v[92:95], v[24:27]
    ds_read_b64_tr_b16 v[90:91], v10 offset:13824
    v_mfma_f32_16x16x32_bf16 v[28:31], v[128:131], v[92:95], v[28:31]
    ds_read_b64_tr_b16 v[92:93], v10 offset:9248
    ds_read_b64_tr_b16 v[94:95], v10 offset:13856
    v_mfma_f32_16x16x32_bf16 v[32:35], v[124:127], v[96:99], v[32:35]
    v_mfma_f32_16x16x32_bf16 v[36:39], v[128:131], v[96:99], v[36:39]
    ds_read_b64_tr_b16 v[96:97], v10 offset:9280
    s_waitcnt lgkmcnt(11)
    v_mfma_f32_16x16x32_bf16 v[40:43], v[124:127], v[100:103], v[40:43]
    ds_read_b64_tr_b16 v[98:99], v10 offset:13888
    s_add_u32 s53, s53, 36864
    s_cmp_ge_u32 s53, 147456
    s_cselect_b32 s53, 0, s53
    v_mfma_f32_16x16x32_bf16 v[44:47], v[128:131], v[100:103], v[44:47]
    ds_read_b64_tr_b16 v[100:101], v10 offset:9312
    v_add_u32 v13, s53, v7
    v_mfma_f32_16x16x32_bf16 v[48:51], v[124:127], v[104:107], v[48:51]
    ds_read_b64_tr_b16 v[102:103], v10 offset:13920
    v_add_u32 v14, s53, v8
    v_mfma_f32_16x16x32_bf16 v[52:55], v[128:131], v[104:107], v[52:55]
    ds_read_b64_tr_b16 v[104:105], v10 offset:9344
    v_add_u32 v15, s53, v9
    v_mfma_f32_16x16x32_bf16 v[56:59], v[124:127], v[108:111], v[56:59]
    ds_read_b64_tr_b16 v[106:107], v10 offset:13952
    s_add_u32 s54, s54, 1
    v_mfma_f32_16x16x32_bf16 v[60:63], v[128:131], v[108:111], v[60:63]
    ds_read_b64_tr_b16 v[108:109], v10 offset:9376
    s_cmp_lt_u32 s54, 9
    s_waitcnt lgkmcnt(11)
    v_mfma_f32_16x16x32_bf16 v[64:67], v[124:127], v[112:115], v[64:67]
    ds_read_b64_tr_b16 v[110:111], v10 offset:13984
    v_mfma_f32_16x16x32_bf16 v[68:71], v[128:131], v[112:115], v[68:71]
    ds_read_b64_tr_b16 v[112:113], v10 offset:9408
    v_mfma_f32_16x16x32_bf16 v[72:75], v[124:127], v[116:119], v[72:75]
    ds_read_b64_tr_b16 v[114:115], v10 offset:14016
    v_mfma_f32_16x16x32_bf16 v[76:79], v[128:131], v[116:119], v[76:79]
    ds_read_b64_tr_b16 v[116:117], v10 offset:9440
    v_mfma_f32_16x16x32_bf16 v[80:83], v[124:127], v[120:123], v[80:83]
    ds_read_b64_tr_b16 v[118:119], v10 offset:14048
    v_mfma_f32_16x16x32_bf16 v[84:87], v[128:131], v[120:123], v[84:87]
    ds_read_b64_tr_b16 v[120:121], v10 offset:9472
    ds_read_b64_tr_b16 v[122:123], v10 offset:14080
    s_cbranch_scc1 L_c_z2
    s_waitcnt lgkmcnt(15)
    v_mfma_f32_16x16x32_bf16 v[16:19], v[132:135], v[88:91], v[16:19]
    v_mfma_f32_16x16x32_bf16 v[20:23], v[136:139], v[88:91], v[20:23]
    s_waitcnt lgkmcnt(14)
    v_mfma_f32_16x16x32_bf16 v[24:27], v[132:135], v[92:95], v[24:27]
    v_mfma_f32_16x16x32_bf16 v[28:31], v[136:139], v[92:95], v[28:31]
    s_waitcnt lgkmcnt(12)
    v_mfma_f32_16x16x32_bf16 v[32:35], v[132:135], v[96:99], v[32:35]
    v_mfma_f32_16x16x32_bf16 v[36:39], v[136:139], v[96:99], v[36:39]
    s_waitcnt lgkmcnt(10)
    v_mfma_f32_16x16x32_bf16 v[40:43], v[132:135], v[100:103], v[40:43]
    v_mfma_f32_16x16x32_bf16 v[44:47], v[136:139], v[100:103], v[44:47]
    s_waitcnt lgkmcnt(8)
    v_mfma_f32_16x16x32_bf16 v[48:51], v[132:135], v[104:107], v[48:51]
    v_mfma_f32_16x16x32_bf16 v[52:55], v[136:139], v[104:107], v[52:55]
    s_waitcnt lgkmcnt(6)
    v_mfma_f32_16x16x32_bf16 v[56:59], v[132:135], v[108:111], v[56:59]
    v_mfma_f32_16x16x32_bf16 v[60:63], v[136:139], v[108:111], v[60:63]
    s_waitcnt lgkmcnt(4)
    v_mfma_f32_16x16x32_bf16 v[64:67], v[132:135], v[112:115], v[64:67]
    v_mfma_f32_16x16x32_bf16 v[68:71], v[136:139], v[112:115], v[68:71]
    s_waitcnt lgkmcnt(2)
    v_mfma_f32_16x16x32_bf16 v[72:75], v[132:135], v[116:119], v[72:75]
    v_mfma_f32_16x16x32_bf16 v[76:79], v[136:139], v[116:119], v[76:79]
    s_waitcnt lgkmcnt(0)
    v_mfma_f32_16x16x32_bf16 v[80:83], v[132:135], v[120:123], v[80:83]
    v_mfma_f32_16x16x32_bf16 v[84:87], v[136:139], v[120:123], v[84:87]
    buffer_load_dword v229, v230, s[48:51], 0 offen sc1
    buffer_load_dword v226, v214, s[36:39], s64 offen
    s_add_u32 s64, s64, 147456
    buffer_load_dword v226, v212, s[36:39], s64 offen
    s_mov_b32 s44, s4
    s_mov_b32 s45, s5
    s_mov_b32 s46, 0x800000
    s_mov_b32 s47, 0x00020000
    s_lshl_b32 s65, s17, 4
    s_add_u32 s65, s65, s16
    s_lshl_b32 s65, s65, 2
    s_add_u32 s65, s65, s21
    s_lshl_b32 s65, s65, 13
    v_lshrrev_b32 v211, 4, v3
    v_lshlrev_b32 v211, 12, v211
    v_and_b32 v15, 15, v3
    v_lshl_add_u32 v211, v15, 7, v211
    v_mov_b32 v15, 0x40000000
    v_cmp_gt_u32 vcc, 32, v3
    s_nop 1
    v_cndmask_b32 v211, v15, v211, vcc
    buffer_load_dword v226, v211, s[44:47], s65 offen
    v_mov_b32 v104, 0xc0135761
    v_mov_b32 v105, 0xc0135761
    v_mov_b32 v106, 0xbdd2d3e8
    v_mov_b32 v107, 0xbdd2d3e8
    v_mov_b32 v176, 0
    v_mov_b32 v177, 0
    v_mov_b32 v178, 0
    v_mov_b32 v179, 0
    v_mov_b32 v180, 0
    v_mov_b32 v181, 0
    v_mov_b32 v182, 0
    v_mov_b32 v183, 0
    v_mov_b32 v184, 0
    v_mov_b32 v185, 0
    v_mov_b32 v186, 0
    v_mov_b32 v187, 0
    v_mov_b32 v188, 0
    v_mov_b32 v189, 0
    v_mov_b32 v190, 0
    v_mov_b32 v191, 0
    v_pk_mul_f32 v[88:89], v[16:17], v[16:17]
    v_pk_mul_f32 v[90:91], v[18:19], v[18:19]
    v_pk_mul_f32 v[92:93], v[20:21], v[20:21]
    v_pk_mul_f32 v[94:95], v[22:23], v[22:23]
    v_pk_fma_f32 v[88:89], v[88:89], v[106:107], v[104:105]
    v_pk_fma_f32 v[90:91], v[90:91], v[106:107], v[104:105]
    v_pk_fma_f32 v[92:93], v[92:93], v[106:107], v[104:105]
    v_pk_fma_f32 v[94:95], v[94:95], v[106:107], v[104:105]
    v_pk_mul_f32 v[88:89], v[88:89], v[16:17]
    v_pk_mul_f32 v[90:91], v[90:91], v[18:19]
    v_pk_mul_f32 v[92:93], v[92:93], v[20:21]
    v_pk_mul_f32 v[94:95], v[94:95], v[22:23]
    v_exp_f32 v88, v88
    v_pk_mul_f32 v[96:97], v[24:25], v[24:25]
    v_exp_f32 v89, v89
    v_pk_mul_f32 v[98:99], v[26:27], v[26:27]
    v_exp_f32 v90, v90
    v_pk_mul_f32 v[100:101], v[28:29], v[28:29]
    v_exp_f32 v91, v91
    v_pk_mul_f32 v[102:103], v[30:31], v[30:31]
    v_pk_add_f32 v[88:89], v[88:89], 1.0 op_sel_hi:[1,0]
    v_exp_f32 v92, v92
    v_pk_fma_f32 v[96:97], v[96:97], v[106:107], v[104:105]
    v_exp_f32 v93, v93
    v_pk_fma_f32 v[98:99], v[98:99], v[106:107], v[104:105]
    v_pk_add_f32 v[90:91], v[90:91], 1.0 op_sel_hi:[1,0]
    v_exp_f32 v94, v94
    v_pk_fma_f32 v[100:101], v[100:101], v[106:107], v[104:105]
    v_exp_f32 v95, v95
    v_pk_fma_f32 v[102:103], v[102:103], v[106:107], v[104:105]
    v_pk_add_f32 v[92:93], v[92:93], 1.0 op_sel_hi:[1,0]
    v_pk_mul_f32 v[96:97], v[96:97], v[24:25]
    v_pk_add_f32 v[94:95], v[94:95], 1.0 op_sel_hi:[1,0]
    v_rcp_f32 v88, v88
    v_pk_mul_f32 v[98:99], v[98:99], v[26:27]
    v_rcp_f32 v89, v89
    v_pk_mul_f32 v[100:101], v[100:101], v[28:29]
    v_rcp_f32 v90, v90
    v_pk_mul_f32 v[102:103], v[102:103], v[30:31]
    v_rcp_f32 v91, v91
    v_pk_mul_f32 v[16:17], v[88:89], v[16:17]
    v_rcp_f32 v92, v92
    v_rcp_f32 v93, v93
    v_pk_mul_f32 v[18:19], v[90:91], v[18:19]
    v_rcp_f32 v94, v94
    v_rcp_f32 v95, v95
    v_pk_mul_f32 v[20:21], v[92:93], v[20:21]
    s_nop 0
    v_pk_mul_f32 v[22:23], v[94:95], v[22:23]
    v_exp_f32 v96, v96
    v_cvt_pk_bf16_f32 v140, v16, v17
    v_exp_f32 v97, v97
    v_cvt_pk_bf16_f32 v141, v18, v19
    v_exp_f32 v98, v98
    v_cvt_pk_bf16_f32 v142, v20, v21
    v_exp_f32 v99, v99
    v_cvt_pk_bf16_f32 v143, v22, v23
    v_pk_add_f32 v[96:97], v[96:97], 1.0 op_sel_hi:[1,0]
    v_exp_f32 v100, v100
    v_pk_add_f32 v[176:177], v[176:177], v[16:17]
    v_exp_f32 v101, v101
    v_pk_add_f32 v[178:179], v[178:179], v[18:19]
    v_pk_add_f32 v[98:99], v[98:99], 1.0 op_sel_hi:[1,0]
    v_exp_f32 v102, v102
    v_pk_add_f32 v[180:181], v[180:181], v[20:21]
    v_exp_f32 v103, v103
    v_pk_add_f32 v[182:183], v[182:183], v[22:23]
    v_pk_add_f32 v[100:101], v[100:101], 1.0 op_sel_hi:[1,0]
    v_pk_fma_f32 v[184:185], v[16:17], v[16:17], v[184:185]
    v_pk_add_f32 v[102:103], v[102:103], 1.0 op_sel_hi:[1,0]
    v_rcp_f32 v96, v96
    v_pk_fma_f32 v[186:187], v[18:19], v[18:19], v[186:187]
    v_rcp_f32 v97, v97
    v_pk_fma_f32 v[188:189], v[20:21], v[20:21], v[188:189]
    v_rcp_f32 v98, v98
    v_pk_fma_f32 v[190:191], v[22:23], v[22:23], v[190:191]
    v_rcp_f32 v99, v99
    v_pk_mul_f32 v[88:89], v[32:33], v[32:33]
    v_pk_mul_f32 v[24:25], v[96:97], v[24:25]
    v_rcp_f32 v100, v100
    v_pk_mul_f32 v[90:91], v[34:35], v[34:35]
    v_rcp_f32 v101, v101
    v_pk_mul_f32 v[92:93], v[36:37], v[36:37]
    v_pk_mul_f32 v[26:27], v[98:99], v[26:27]
    v_rcp_f32 v102, v102
    v_pk_mul_f32 v[94:95], v[38:39], v[38:39]
    v_rcp_f32 v103, v103
    v_pk_fma_f32 v[88:89], v[88:89], v[106:107], v[104:105]
    v_pk_mul_f32 v[28:29], v[100:101], v[28:29]
    v_pk_fma_f32 v[90:91], v[90:91], v[106:107], v[104:105]
    v_pk_fma_f32 v[92:93], v[92:93], v[106:107], v[104:105]
    v_pk_fma_f32 v[94:95], v[94:95], v[106:107], v[104:105]
    v_pk_mul_f32 v[88:89], v[88:89], v[32:33]
    v_pk_mul_f32 v[90:91], v[90:91], v[34:35]
    v_pk_mul_f32 v[92:93], v[92:93], v[36:37]
    v_pk_mul_f32 v[94:95], v[94:95], v[38:39]
    s_nop 0
    v_pk_mul_f32 v[30:31], v[102:103], v[30:31]
    v_exp_f32 v88, v88
    v_cvt_pk_bf16_f32 v144, v24, v25
    v_exp_f32 v89, v89
    v_cvt_pk_bf16_f32 v145, v26, v27
    v_exp_f32 v90, v90
    v_cvt_pk_bf16_f32 v146, v28, v29
    v_exp_f32 v91, v91
    v_cvt_pk_bf16_f32 v147, v30, v31
    v_pk_add_f32 v[88:89], v[88:89], 1.0 op_sel_hi:[1,0]
    v_exp_f32 v92, v92
    v_pk_add_f32 v[176:177], v[176:177], v[24:25]
    v_exp_f32 v93, v93
    v_pk_add_f32 v[178:179], v[178:179], v[26:27]
    v_pk_add_f32 v[90:91], v[90:91], 1.0 op_sel_hi:[1,0]
    v_exp_f32 v94, v94
    v_pk_add_f32 v[180:181], v[180:181], v[28:29]
    v_exp_f32 v95, v95
    v_pk_add_f32 v[182:183], v[182:183], v[30:31]
    v_pk_add_f32 v[92:93], v[92:93], 1.0 op_sel_hi:[1,0]
    v_pk_fma_f32 v[184:185], v[24:25], v[24:25], v[184:185]
    v_pk_add_f32 v[94:95], v[94:95], 1.0 op_sel_hi:[1,0]
    v_rcp_f32 v88, v88
    v_pk_fma_f32 v[186:187], v[26:27], v[26:27], v[186:187]
    v_rcp_f32 v89, v89
    v_pk_fma_f32 v[188:189], v[28:29], v[28:29], v[188:189]
    v_rcp_f32 v90, v90
    v_pk_fma_f32 v[190:191], v[30:31], v[30:31], v[190:191]
    v_rcp_f32 v91, v91
    v_pk_mul_f32 v[96:97], v[40:41], v[40:41]
    v_pk_mul_f32 v[32:33], v[88:89], v[32:33]
    v_rcp_f32 v92, v92
    v_pk_mul_f32 v[98:99], v[42:43], v[42:43]
    v_rcp_f32 v93, v93
    v_pk_mul_f32 v[100:101], v[44:45], v[44:45]
    v_pk_mul_f32 v[34:35], v[90:91], v[34:35]
    v_rcp_f32 v94, v94
    v_pk_mul_f32 v[102:103], v[46:47], v[46:47]
    v_rcp_f32 v95, v95
    v_pk_fma_f32 v[96:97], v[96:97], v[106:107], v[104:105]
    v_pk_mul_f32 v[36:37], v[92:93], v[36:37]
    v_pk_fma_f32 v[98:99], v[98:99], v[106:107], v[104:105]
    v_pk_fma_f32 v[100:101], v[100:101], v[106:107], v[104:105]
    v_pk_fma_f32 v[102:103], v[102:103], v[106:107], v[104:105]
    v_pk_mul_f32 v[96:97], v[96:97], v[40:41]
    v_pk_mul_f32 v[98:99], v[98:99], v[42:43]
    v_pk_mul_f32 v[100:101], v[100:101], v[44:45]
    v_pk_mul_f32 v[102:103], v[102:103], v[46:47]
    s_nop 0
    v_pk_mul_f32 v[38:39], v[94:95], v[38:39]
    v_exp_f32 v96, v96
    v_cvt_pk_bf16_f32 v148, v32, v33
    v_exp_f32 v97, v97
    v_cvt_pk_bf16_f32 v149, v34, v35
    v_exp_f32 v98, v98
    v_cvt_pk_bf16_f32 v150, v36, v37
    v_exp_f32 v99, v99
    v_cvt_pk_bf16_f32 v151, v38, v39
    v_pk_add_f32 v[96:97], v[96:97], 1.0 op_sel_hi:[1,0]
    v_exp_f32 v100, v100
    v_pk_add_f32 v[176:177], v[176:177], v[32:33]
    v_exp_f32 v101, v101
    v_pk_add_f32 v[178:179], v[178:179], v[34:35]
    v_pk_add_f32 v[98:99], v[98:99], 1.0 op_sel_hi:[1,0]
    v_exp_f32 v102, v102
    v_pk_add_f32 v[180:181], v[180:181], v[36:37]
    v_exp_f32 v103, v103
    v_pk_add_f32 v[182:183], v[182:183], v[38:39]
    v_pk_add_f32 v[100:101], v[100:101], 1.0 op_sel_hi:[1,0]
    v_pk_fma_f32 v[184:185], v[32:33], v[32:33], v[184:185]
    v_pk_add_f32 v[102:103], v[102:103], 1.0 op_sel_hi:[1,0]
    v_rcp_f32 v96, v96
    v_pk_fma_f32 v[186:187], v[34:35], v[34:35], v[186:187]
    v_rcp_f32 v97, v97
    v_pk_fma_f32 v[188:189], v[36:37], v[36:37], v[188:189]
    v_rcp_f32 v98, v98
    v_pk_fma_f32 v[190:191], v[38:39], v[38:39], v[190:191]
    v_rcp_f32 v99, v99
    v_pk_mul_f32 v[88:89], v[48:49], v[48:49]
    v_pk_mul_f32 v[40:41], v[96:97], v[40:41]
    v_rcp_f32 v100, v100
    v_pk_mul_f32 v[90:91], v[50:51], v[50:51]
    v_rcp_f32 v101, v101
    v_pk_mul_f32 v[92:93], v[52:53], v[52:53]
    v_pk_mul_f32 v[42:43], v[98:99], v[42:43]
    v_rcp_f32 v102, v102
    v_pk_mul_f32 v[94:95], v[54:55], v[54:55]
    v_rcp_f32 v103, v103
    v_pk_fma_f32 v[88:89], v[88:89], v[106:107], v[104:105]
    v_pk_mul_f32 v[44:45], v[100:101], v[44:45]
    v_pk_fma_f32 v[90:91], v[90:91], v[106:107], v[104:105]
    v_pk_fma_f32 v[92:93], v[92:93], v[106:107], v[104:105]
    v_pk_fma_f32 v[94:95], v[94:95], v[106:107], v[104:105]
    v_pk_mul_f32 v[88:89], v[88:89], v[48:49]
    v_pk_mul_f32 v[90:91], v[90:91], v[50:51]
    v_pk_mul_f32 v[92:93], v[92:93], v[52:53]
    v_pk_mul_f32 v[94:95], v[94:95], v[54:55]
    s_nop 0
    v_pk_mul_f32 v[46:47], v[102:103], v[46:47]
    v_exp_f32 v88, v88
    v_cvt_pk_bf16_f32 v152, v40, v41
    v_exp_f32 v89, v89
    v_cvt_pk_bf16_f32 v153, v42, v43
    v_exp_f32 v90, v90
    v_cvt_pk_bf16_f32 v154, v44, v45
    v_exp_f32 v91, v91
    v_cvt_pk_bf16_f32 v155, v46, v47
    v_pk_add_f32 v[88:89], v[88:89], 1.0 op_sel_hi:[1,0]
    v_exp_f32 v92, v92
    v_pk_add_f32 v[176:177], v[176:177], v[40:41]
    v_exp_f32 v93, v93
    v_pk_add_f32 v[178:179], v[178:179], v[42:43]
    v_pk_add_f32 v[90:91], v[90:91], 1.0 op_sel_hi:[1,0]
    v_exp_f32 v94, v94
    v_pk_add_f32 v[180:181], v[180:181], v[44:45]
    v_exp_f32 v95, v95
    v_pk_add_f32 v[182:183], v[182:183], v[46:47]
    v_pk_add_f32 v[92:93], v[92:93], 1.0 op_sel_hi:[1,0]
    v_pk_fma_f32 v[184:185], v[40:41], v[40:41], v[184:185]
    v_pk_add_f32 v[94:95], v[94:95], 1.0 op_sel_hi:[1,0]
    v_rcp_f32 v88, v88
    v_pk_fma_f32 v[186:187], v[42:43], v[42:43], v[186:187]
    v_rcp_f32 v89, v89
    v_pk_fma_f32 v[188:189], v[44:45], v[44:45], v[188:189]
    v_rcp_f32 v90, v90
    v_pk_fma_f32 v[190:191], v[46:47], v[46:47], v[190:191]
    v_rcp_f32 v91, v91
    v_pk_mul_f32 v[96:97], v[56:57], v[56:57]
    v_pk_mul_f32 v[48:49], v[88:89], v[48:49]
    v_rcp_f32 v92, v92
    v_pk_mul_f32 v[98:99], v[58:59], v[58:59]
    v_rcp_f32 v93, v93
    v_pk_mul_f32 v[100:101], v[60:61], v[60:61]
    v_pk_mul_f32 v[50:51], v[90:91], v[50:51]
    v_rcp_f32 v94, v94
    v_pk_mul_f32 v[102:103], v[62:63], v[62:63]
    v_rcp_f32 v95, v95
    v_pk_fma_f32 v[96:97], v[96:97], v[106:107], v[104:105]
    v_pk_mul_f32 v[52:53], v[92:93], v[52:53]
    v_pk_fma_f32 v[98:99], v[98:99], v[106:107], v[104:105]
    v_pk_fma_f32 v[100:101], v[100:101], v[106:107], v[104:105]
    v_pk_fma_f32 v[102:103], v[102:103], v[106:107], v[104:105]
    v_pk_mul_f32 v[96:97], v[96:97], v[56:57]
    v_pk_mul_f32 v[98:99], v[98:99], v[58:59]
    v_pk_mul_f32 v[100:101], v[100:101], v[60:61]
    v_pk_mul_f32 v[102:103], v[102:103], v[62:63]
    s_nop 0
    v_pk_mul_f32 v[54:55], v[94:95], v[54:55]
    v_exp_f32 v96, v96
    v_cvt_pk_bf16_f32 v156, v48, v49
    v_exp_f32 v97, v97
    v_cvt_pk_bf16_f32 v157, v50, v51
    v_exp_f32 v98, v98
    v_cvt_pk_bf16_f32 v158, v52, v53
    v_exp_f32 v99, v99
    v_cvt_pk_bf16_f32 v159, v54, v55
    v_pk_add_f32 v[96:97], v[96:97], 1.0 op_sel_hi:[1,0]
    v_exp_f32 v100, v100
    v_pk_add_f32 v[176:177], v[176:177], v[48:49]
    v_exp_f32 v101, v101
    v_pk_add_f32 v[178:179], v[178:179], v[50:51]
    v_pk_add_f32 v[98:99], v[98:99], 1.0 op_sel_hi:[1,0]
    v_exp_f32 v102, v102
    v_pk_add_f32 v[180:181], v[180:181], v[52:53]
    v_exp_f32 v103, v103
    v_pk_add_f32 v[182:183], v[182:183], v[54:55]
    v_pk_add_f32 v[100:101], v[100:101], 1.0 op_sel_hi:[1,0]
    v_pk_fma_f32 v[184:185], v[48:49], v[48:49], v[184:185]
    v_pk_add_f32 v[102:103], v[102:103], 1.0 op_sel_hi:[1,0]
    v_rcp_f32 v96, v96
    v_pk_fma_f32 v[186:187], v[50:51], v[50:51], v[186:187]
    v_rcp_f32 v97, v97
    v_pk_fma_f32 v[188:189], v[52:53], v[52:53], v[188:189]
    v_rcp_f32 v98, v98
    v_pk_fma_f32 v[190:191], v[54:55], v[54:55], v[190:191]
    v_rcp_f32 v99, v99
    v_pk_mul_f32 v[88:89], v[64:65], v[64:65]
    v_pk_mul_f32 v[56:57], v[96:97], v[56:57]
    v_rcp_f32 v100, v100
    v_pk_mul_f32 v[90:91], v[66:67], v[66:67]
    v_rcp_f32 v101, v101
    v_pk_mul_f32 v[92:93], v[68:69], v[68:69]
    v_pk_mul_f32 v[58:59], v[98:99], v[58:59]
    v_rcp_f32 v102, v102
    v_pk_mul_f32 v[94:95], v[70:71], v[70:71]
    v_rcp_f32 v103, v103
    v_pk_fma_f32 v[88:89], v[88:89], v[106:107], v[104:105]
    v_pk_mul_f32 v[60:61], v[100:101], v[60:61]
    v_pk_fma_f32 v[90:91], v[90:91], v[106:107], v[104:105]
    v_pk_fma_f32 v[92:93], v[92:93], v[106:107], v[104:105]
    v_pk_fma_f32 v[94:95], v[94:95], v[106:107], v[104:105]
    v_pk_mul_f32 v[88:89], v[88:89], v[64:65]
    v_pk_mul_f32 v[90:91], v[90:91], v[66:67]
    v_pk_mul_f32 v[92:93], v[92:93], v[68:69]
    v_pk_mul_f32 v[94:95], v[94:95], v[70:71]
    s_nop 0
    v_pk_mul_f32 v[62:63], v[102:103], v[62:63]
    v_exp_f32 v88, v88
    v_cvt_pk_bf16_f32 v160, v56, v57
    v_exp_f32 v89, v89
    v_cvt_pk_bf16_f32 v161, v58, v59
    v_exp_f32 v90, v90
    v_cvt_pk_bf16_f32 v162, v60, v61
    v_exp_f32 v91, v91
    v_cvt_pk_bf16_f32 v163, v62, v63
    v_pk_add_f32 v[88:89], v[88:89], 1.0 op_sel_hi:[1,0]
    v_exp_f32 v92, v92
    v_pk_add_f32 v[176:177], v[176:177], v[56:57]
    v_exp_f32 v93, v93
    v_pk_add_f32 v[178:179], v[178:179], v[58:59]
    v_pk_add_f32 v[90:91], v[90:91], 1.0 op_sel_hi:[1,0]
    v_exp_f32 v94, v94
    v_pk_add_f32 v[180:181], v[180:181], v[60:61]
    v_exp_f32 v95, v95
    v_pk_add_f32 v[182:183], v[182:183], v[62:63]
    v_pk_add_f32 v[92:93], v[92:93], 1.0 op_sel_hi:[1,0]
    v_pk_fma_f32 v[184:185], v[56:57], v[56:57], v[184:185]
    v_pk_add_f32 v[94:95], v[94:95], 1.0 op_sel_hi:[1,0]
    v_rcp_f32 v88, v88
    v_pk_fma_f32 v[186:187], v[58:59], v[58:59], v[186:187]
    v_rcp_f32 v89, v89
    v_pk_fma_f32 v[188:189], v[60:61], v[60:61], v[188:189]
    v_rcp_f32 v90, v90
    v_pk_fma_f32 v[190:191], v[62:63], v[62:63], v[190:191]
    v_rcp_f32 v91, v91
    v_pk_mul_f32 v[96:97], v[72:73], v[72:73]
    v_pk_mul_f32 v[64:65], v[88:89], v[64:65]
    v_rcp_f32 v92, v92
    v_pk_mul_f32 v[98:99], v[74:75], v[74:75]
    v_rcp_f32 v93, v93
    v_pk_mul_f32 v[100:101], v[76:77], v[76:77]
    v_pk_mul_f32 v[66:67], v[90:91], v[66:67]
    v_rcp_f32 v94, v94
    v_pk_mul_f32 v[102:103], v[78:79], v[78:79]
    v_rcp_f32 v95, v95
    v_pk_fma_f32 v[96:97], v[96:97], v[106:107], v[104:105]
    v_pk_mul_f32 v[68:69], v[92:93], v[68:69]
    v_pk_fma_f32 v[98:99], v[98:99], v[106:107], v[104:105]
    v_pk_fma_f32 v[100:101], v[100:101], v[106:107], v[104:105]
    v_pk_fma_f32 v[102:103], v[102:103], v[106:107], v[104:105]
    v_pk_mul_f32 v[96:97], v[96:97], v[72:73]
    v_pk_mul_f32 v[98:99], v[98:99], v[74:75]
    v_pk_mul_f32 v[100:101], v[100:101], v[76:77]
    v_pk_mul_f32 v[102:103], v[102:103], v[78:79]
    s_nop 0
    v_pk_mul_f32 v[70:71], v[94:95], v[70:71]
    v_exp_f32 v96, v96
    v_cvt_pk_bf16_f32 v164, v64, v65
    v_exp_f32 v97, v97
    v_cvt_pk_bf16_f32 v165, v66, v67
    v_exp_f32 v98, v98
    v_cvt_pk_bf16_f32 v166, v68, v69
    v_exp_f32 v99, v99
    v_cvt_pk_bf16_f32 v167, v70, v71
    v_pk_add_f32 v[96:97], v[96:97], 1.0 op_sel_hi:[1,0]
    v_exp_f32 v100, v100
    v_pk_add_f32 v[176:177], v[176:177], v[64:65]
    v_exp_f32 v101, v101
    v_pk_add_f32 v[178:179], v[178:179], v[66:67]
    v_pk_add_f32 v[98:99], v[98:99], 1.0 op_sel_hi:[1,0]
    v_exp_f32 v102, v102
    v_pk_add_f32 v[180:181], v[180:181], v[68:69]
    v_exp_f32 v103, v103
    v_pk_add_f32 v[182:183], v[182:183], v[70:71]
    v_pk_add_f32 v[100:101], v[100:101], 1.0 op_sel_hi:[1,0]
    v_pk_fma_f32 v[184:185], v[64:65], v[64:65], v[184:185]
    v_pk_add_f32 v[102:103], v[102:103], 1.0 op_sel_hi:[1,0]
    v_rcp_f32 v96, v96
    v_pk_fma_f32 v[186:187], v[66:67], v[66:67], v[186:187]
    v_rcp_f32 v97, v97
    v_pk_fma_f32 v[188:189], v[68:69], v[68:69], v[188:189]
    v_rcp_f32 v98, v98
    v_pk_fma_f32 v[190:191], v[70:71], v[70:71], v[190:191]
    v_rcp_f32 v99, v99
    v_pk_mul_f32 v[88:89], v[80:81], v[80:81]
    v_pk_mul_f32 v[72:73], v[96:97], v[72:73]
    v_rcp_f32 v100, v100
    v_pk_mul_f32 v[90:91], v[82:83], v[82:83]
    v_rcp_f32 v101, v101
    v_pk_mul_f32 v[92:93], v[84:85], v[84:85]
    v_pk_mul_f32 v[74:75], v[98:99], v[74:75]
    v_rcp_f32 v102, v102
    v_pk_mul_f32 v[94:95], v[86:87], v[86:87]
    v_rcp_f32 v103, v103
    v_pk_fma_f32 v[88:89], v[88:89], v[106:107], v[104:105]
    v_pk_mul_f32 v[76:77], v[100:101], v[76:77]
    v_pk_fma_f32 v[90:91], v[90:91], v[106:107], v[104:105]
    v_pk_fma_f32 v[92:93], v[92:93], v[106:107], v[104:105]
    v_pk_fma_f32 v[94:95], v[94:95], v[106:107], v[104:105]
    v_pk_mul_f32 v[88:89], v[88:89], v[80:81]
    v_pk_mul_f32 v[90:91], v[90:91], v[82:83]
    v_pk_mul_f32 v[92:93], v[92:93], v[84:85]
    v_pk_mul_f32 v[94:95], v[94:95], v[86:87]
    s_nop 0
    v_pk_mul_f32 v[78:79], v[102:103], v[78:79]
    v_exp_f32 v88, v88
    v_cvt_pk_bf16_f32 v168, v72, v73
    v_exp_f32 v89, v89
    v_cvt_pk_bf16_f32 v169, v74, v75
    v_exp_f32 v90, v90
    v_cvt_pk_bf16_f32 v170, v76, v77
    v_exp_f32 v91, v91
    v_cvt_pk_bf16_f32 v171, v78, v79
    v_pk_add_f32 v[88:89], v[88:89], 1.0 op_sel_hi:[1,0]
    v_exp_f32 v92, v92
    v_pk_add_f32 v[176:177], v[176:177], v[72:73]
    v_exp_f32 v93, v93
    v_pk_add_f32 v[178:179], v[178:179], v[74:75]
    v_pk_add_f32 v[90:91], v[90:91], 1.0 op_sel_hi:[1,0]
    v_exp_f32 v94, v94
    v_pk_add_f32 v[180:181], v[180:181], v[76:77]
    v_exp_f32 v95, v95
    v_pk_add_f32 v[182:183], v[182:183], v[78:79]
    v_pk_add_f32 v[92:93], v[92:93], 1.0 op_sel_hi:[1,0]
    v_pk_fma_f32 v[184:185], v[72:73], v[72:73], v[184:185]
    v_pk_add_f32 v[94:95], v[94:95], 1.0 op_sel_hi:[1,0]
    v_rcp_f32 v88, v88
    v_pk_fma_f32 v[186:187], v[74:75], v[74:75], v[186:187]
    v_rcp_f32 v89, v89
    v_pk_fma_f32 v[188:189], v[76:77], v[76:77], v[188:189]
    v_rcp_f32 v90, v90
    v_pk_fma_f32 v[190:191], v[78:79], v[78:79], v[190:191]
    v_rcp_f32 v91, v91
    v_pk_mul_f32 v[80:81], v[88:89], v[80:81]
    v_rcp_f32 v92, v92
    v_rcp_f32 v93, v93
    v_pk_mul_f32 v[82:83], v[90:91], v[82:83]
    v_rcp_f32 v94, v94
    v_rcp_f32 v95, v95
    v_pk_mul_f32 v[84:85], v[92:93], v[84:85]
    s_nop 0
    v_pk_mul_f32 v[86:87], v[94:95], v[86:87]
    v_cvt_pk_bf16_f32 v172, v80, v81
    v_cvt_pk_bf16_f32 v173, v82, v83
    v_cvt_pk_bf16_f32 v174, v84, v85
    v_cvt_pk_bf16_f32 v175, v86, v87
    v_pk_add_f32 v[176:177], v[176:177], v[80:81]
    v_pk_add_f32 v[178:179], v[178:179], v[82:83]
    v_pk_add_f32 v[180:181], v[180:181], v[84:85]
    v_pk_add_f32 v[182:183], v[182:183], v[86:87]
    v_pk_fma_f32 v[184:185], v[80:81], v[80:81], v[184:185]
    v_pk_fma_f32 v[186:187], v[82:83], v[82:83], v[186:187]
    v_pk_fma_f32 v[188:189], v[84:85], v[84:85], v[188:189]
    v_pk_fma_f32 v[190:191], v[86:87], v[86:87], v[190:191]
    v_add_f32_dpp v176, v176, v176 row_ror:8 row_mask:0xf bank_mask:0xf
    v_add_f32_dpp v177, v177, v177 row_ror:8 row_mask:0xf bank_mask:0xf
    v_add_f32_dpp v178, v178, v178 row_ror:8 row_mask:0xf bank_mask:0xf
    v_add_f32_dpp v179, v179, v179 row_ror:8 row_mask:0xf bank_mask:0xf
    v_add_f32_dpp v180, v180, v180 row_ror:8 row_mask:0xf bank_mask:0xf
    v_add_f32_dpp v181, v181, v181 row_ror:8 row_mask:0xf bank_mask:0xf
    v_add_f32_dpp v182, v182, v182 row_ror:8 row_mask:0xf bank_mask:0xf
    v_add_f32_dpp v183, v183, v183 row_ror:8 row_mask:0xf bank_mask:0xf
    v_add_f32_dpp v184, v184, v184 row_ror:8 row_mask:0xf bank_mask:0xf
    v_add_f32_dpp v185, v185, v185 row_ror:8 row_mask:0xf bank_mask:0xf
    v_add_f32_dpp v186, v186, v186 row_ror:8 row_mask:0xf bank_mask:0xf
    v_add_f32_dpp v187, v187, v187 row_ror:8 row_mask:0xf bank_mask:0xf
    v_add_f32_dpp v188, v188, v188 row_ror:8 row_mask:0xf bank_mask:0xf
    v_add_f32_dpp v189, v189, v189 row_ror:8 row_mask:0xf bank_mask:0xf
    v_add_f32_dpp v190, v190, v190 row_ror:8 row_mask:0xf bank_mask:0xf
    v_add_f32_dpp v191, v191, v191 row_ror:8 row_mask:0xf bank_mask:0xf
    v_add_f32_dpp v176, v176, v176 row_ror:4 row_mask:0xf bank_mask:0xf
    v_add_f32_dpp v177, v177, v177 row_ror:4 row_mask:0xf bank_mask:0xf
    v_add_f32_dpp v178, v178, v178 row_ror:4 row_mask:0xf bank_mask:0xf
    v_add_f32_dpp v179, v179, v179 row_ror:4 row_mask:0xf bank_mask:0xf
    v_add_f32_dpp v180, v180, v180 row_ror:4 row_mask:0xf bank_mask:0xf
    v_add_f32_dpp v181, v181, v181 row_ror:4 row_mask:0xf bank_mask:0xf
    v_add_f32_dpp v182, v182, v182 row_ror:4 row_mask:0xf bank_mask:0xf
    v_add_f32_dpp v183, v183, v183 row_ror:4 row_mask:0xf bank_mask:0xf
    v_add_f32_dpp v184, v184, v184 row_ror:4 row_mask:0xf bank_mask:0xf
    v_add_f32_dpp v185, v185, v185 row_ror:4 row_mask:0xf bank_mask:0xf
    v_add_f32_dpp v186, v186, v186 row_ror:4 row_mask:0xf bank_mask:0xf
    v_add_f32_dpp v187, v187, v187 row_ror:4 row_mask:0xf bank_mask:0xf
    v_add_f32_dpp v188, v188, v188 row_ror:4 row_mask:0xf bank_mask:0xf
    v_add_f32_dpp v189, v189, v189 row_ror:4 row_mask:0xf bank_mask:0xf
    v_add_f32_dpp v190, v190, v190 row_ror:4 row_mask:0xf bank_mask:0xf
    v_add_f32_dpp v191, v191, v191 row_ror:4 row_mask:0xf bank_mask:0xf
    v_add_f32_dpp v176, v176, v176 row_ror:2 row_mask:0xf bank_mask:0xf
    v_add_f32_dpp v177, v177, v177 row_ror:2 row_mask:0xf bank_mask:0xf
    v_add_f32_dpp v178, v178, v178 row_ror:2 row_mask:0xf bank_mask:0xf
    v_add_f32_dpp v179, v179, v179 row_ror:2 row_mask:0xf bank_mask:0xf
    v_add_f32_dpp v180, v180, v180 row_ror:2 row_mask:0xf bank_mask:0xf
    v_add_f32_dpp v181, v181, v181 row_ror:2 row_mask:0xf bank_mask:0xf
    v_add_f32_dpp v182, v182, v182 row_ror:2 row_mask:0xf bank_mask:0xf
    v_add_f32_dpp v183, v183, v183 row_ror:2 row_mask:0xf bank_mask:0xf
    v_add_f32_dpp v184, v184, v184 row_ror:2 row_mask:0xf bank_mask:0xf
    v_add_f32_dpp v185, v185, v185 row_ror:2 row_mask:0xf bank_mask:0xf
    v_add_f32_dpp v186, v186, v186 row_ror:2 row_mask:0xf bank_mask:0xf
    v_add_f32_dpp v187, v187, v187 row_ror:2 row_mask:0xf bank_mask:0xf
    v_add_f32_dpp v188, v188, v188 row_ror:2 row_mask:0xf bank_mask:0xf
    v_add_f32_dpp v189, v189, v189 row_ror:2 row_mask:0xf bank_mask:0xf
    v_add_f32_dpp v190, v190, v190 row_ror:2 row_mask:0xf bank_mask:0xf
    v_add_f32_dpp v191, v191, v191 row_ror:2 row_mask:0xf bank_mask:0xf
    v_add_f32_dpp v176, v176, v176 row_ror:1 row_mask:0xf bank_mask:0xf
    v_add_f32_dpp v177, v177, v177 row_ror:1 row_mask:0xf bank_mask:0xf
    v_add_f32_dpp v178, v178, v178 row_ror:1 row_mask:0xf bank_mask:0xf
    v_add_f32_dpp v179, v179, v179 row_ror:1 row_mask:0xf bank_mask:0xf
    v_add_f32_dpp v180, v180, v180 row_ror:1 row_mask:0xf bank_mask:0xf
    v_add_f32_dpp v181, v181, v181 row_ror:1 row_mask:0xf bank_mask:0xf
    v_add_f32_dpp v182, v182, v182 row_ror:1 row_mask:0xf bank_mask:0xf
    v_add_f32_dpp v183, v183, v183 row_ror:1 row_mask:0xf bank_mask:0xf
    v_add_f32_dpp v184, v184, v184 row_ror:1 row_mask:0xf bank_mask:0xf
    v_add_f32_dpp v185, v185, v185 row_ror:1 row_mask:0xf bank_mask:0xf
    v_add_f32_dpp v186, v186, v186 row_ror:1 row_mask:0xf bank_mask:0xf
    v_add_f32_dpp v187, v187, v187 row_ror:1 row_mask:0xf bank_mask:0xf
    v_add_f32_dpp v188, v188, v188 row_ror:1 row_mask:0xf bank_mask:0xf
    v_add_f32_dpp v189, v189, v189 row_ror:1 row_mask:0xf bank_mask:0xf
    v_add_f32_dpp v190, v190, v190 row_ror:1 row_mask:0xf bank_mask:0xf
    v_add_f32_dpp v191, v191, v191 row_ror:1 row_mask:0xf bank_mask:0xf
    s_lshl_b32 s63, s60, 12
    s_add_u32 s63, s63, 39845888
    s_lshl_b32 s55, s16, 8
    s_add_u32 s55, s55, s63
    v_and_b32 v15, 3, v3
    v_cmp_eq_u32 vcc, 1, v15
    v_cmp_eq_u32 s[56:57], 2, v15
    v_cmp_eq_u32 s[58:59], 3, v15
    v_lshrrev_b32 v14, 4, v3
    v_lshlrev_b32 v14, 6, v14
    v_lshl_add_u32 v14, v15, 4, v14
    v_cndmask_b32 v176, v176, v180, vcc
    v_cndmask_b32 v177, v177, v181, vcc
    v_cndmask_b32 v178, v178, v182, vcc
    v_cndmask_b32 v179, v179, v183, vcc
    v_cndmask_b32 v176, v176, v184, s[56:57]
    v_cndmask_b32 v177, v177, v185, s[56:57]
    v_cndmask_b32 v178, v178, v186, s[56:57]
    v_cndmask_b32 v179, v179, v187, s[56:57]
    v_cndmask_b32 v176, v176, v188, s[58:59]
    v_cndmask_b32 v177, v177, v189, s[58:59]
    v_cndmask_b32 v178, v178, v190, s[58:59]
    v_cndmask_b32 v179, v179, v191, s[58:59]
    v_and_b32 v15, 12, v3
    v_cmp_eq_u32 vcc, 0, v15
    s_and_saveexec_b64 s[58:59], vcc
    buffer_store_dwordx4 v[176:179], v14, s[40:43], s55 offen sc1
    s_mov_b64 exec, -1
    s_mov_b32 s59, 0
    v_mov_b32 v230, 0
L_nn_c:
    s_waitcnt vmcnt(0)
    v_readfirstlane_b32 s52, v229
    s_add_u32 s59, s59, 1
    s_nop 2
    s_cmp_lg_u32 s52, 0
    s_cbranch_scc1 L_nnd_c
    s_sleep 2
    buffer_load_dword v229, v230, s[48:51], 0 offen sc1
    s_cmp_lt_u32 s59, 0x20000
    s_cbranch_scc1 L_nn_c
L_nnd_c:
    s_mul_i32 s58, s60, 256
    s_lshl_b32 s55, s16, 2
    s_add_u32 s58, s58, s55
    s_add_u32 s58, s58, 40370176
    v_mov_b32 v230, 0
    v_mov_b32 v231, s52
    s_mov_b64 exec, 1
    buffer_store_dword v231, v230, s[40:43], s58 offen sc1
    s_mov_b64 exec, -1
    s_barrier
    v_lshrrev_b32 v14, 4, v3
    v_lshlrev_b32 v14, 2, v14
    v_bfe_u32 v15, v3, 2, 2
    v_add_u32 v14, v14, v15
    v_mul_u32_u24 v14, 288, v14
    v_and_b32 v15, 3, v3
    v_lshl_add_u32 v7, v15, 3, v14
    v_and_b32 v14, 15, v3
    v_lshlrev_b32 v14, 7, v14
    v_bfe_u32 v15, v3, 1, 3
    v_lshrrev_b32 v13, 4, v3
    v_xor_b32 v15, v15, v13
    v_lshl_add_u32 v14, v15, 4, v14
    s_lshl_b32 s55, s21, 12
    s_add_u32 s55, s55, 18432
    v_add_u32 v8, s55, v14
    v_xor_b32 v9, 64, v8
    v_add_u32 v10, s53, v7
    v_add_u32 v11, s53, v8
    v_add_u32 v12, s53, v9
    ds_read_b128 v[124:127], v11 offset:0
    ds_read_b128 v[128:131], v11 offset:2048
    ds_read_b64_tr_b16 v[88:89], v10 offset:0
    ds_read_b64_tr_b16 v[90:91], v10 offset:4608
    ds_read_b64_tr_b16 v[92:93], v10 offset:32
    ds_read_b64_tr_b16 v[94:95], v10 offset:4640
    ds_read_b64_tr_b16 v[96:97], v10 offset:64
    ds_read_b64_tr_b16 v[98:99], v10 offset:4672
    ds_read_b64_tr_b16 v[100:101], v10 offset:96
    ds_read_b64_tr_b16 v[102:103], v10 offset:4704
    ds_read_b64_tr_b16 v[104:105], v10 offset:128
    ds_read_b64_tr_b16 v[106:107], v10 offset:4736
    ds_read_b64_tr_b16 v[108:109], v10 offset:160
    ds_read_b64_tr_b16 v[110:111], v10 offset:4768
    ds_read_b64_tr_b16 v[112:113], v10 offset:192
    ds_read_b64_tr_b16 v[114:115], v10 offset:4800
    ds_read_b64_tr_b16 v[116:117], v10 offset:224
    ds_read_b64_tr_b16 v[118:119], v10 offset:4832
    ds_read_b64_tr_b16 v[120:121], v10 offset:256
    ds_read_b64_tr_b16 v[122:123], v10 offset:4864
    s_waitcnt lgkmcnt(11)
    v_mfma_f32_16x16x32_bf16 v[16:19], v[88:91], v[124:127], 0
    ds_read_b128 v[132:135], v12 offset:0
    v_mfma_f32_16x16x32_bf16 v[20:23], v[88:91], v[128:131], 0
    ds_read_b128 v[136:139], v12 offset:2048
    ds_read_b64_tr_b16 v[88:89], v10 offset:9216
    v_mfma_f32_16x16x32_bf16 v[24:27], v[92:95], v[124:127], 0
    ds_read_b64_tr_b16 v[90:91], v10 offset:13824
    v_mfma_f32_16x16x32_bf16 v[28:31], v[92:95], v[128:131], 0
    ds_read_b64_tr_b16 v[92:93], v10 offset:9248
    ds_read_b64_tr_b16 v[94:95], v10 offset:13856
    v_mfma_f32_16x16x32_bf16 v[32:35], v[96:99], v[124:127], 0
    v_mfma_f32_16x16x32_bf16 v[36:39], v[96:99], v[128:131], 0
    ds_read_b64_tr_b16 v[96:97], v10 offset:9280
    s_waitcnt lgkmcnt(11)
    v_mfma_f32_16x16x32_bf16 v[40:43], v[100:103], v[124:127], 0
    ds_read_b64_tr_b16 v[98:99], v10 offset:13888
    s_add_u32 s53, s53, 36864
    s_cmp_ge_u32 s53, 147456
    s_cselect_b32 s53, 0, s53
    v_mfma_f32_16x16x32_bf16 v[44:47], v[100:103], v[128:131], 0
    ds_read_b64_tr_b16 v[100:101], v10 offset:9312
    v_add_u32 v13, s53, v7
    v_mfma_f32_16x16x32_bf16 v[48:51], v[104:107], v[124:127], 0
    ds_read_b64_tr_b16 v[102:103], v10 offset:13920
    v_add_u32 v14, s53, v8
    v_mfma_f32_16x16x32_bf16 v[52:55], v[104:107], v[128:131], 0
    ds_read_b64_tr_b16 v[104:105], v10 offset:9344
    v_add_u32 v15, s53, v9
    v_mfma_f32_16x16x32_bf16 v[56:59], v[108:111], v[124:127], 0
    ds_read_b64_tr_b16 v[106:107], v10 offset:13952
    s_mov_b32 s54, 1
    v_mfma_f32_16x16x32_bf16 v[60:63], v[108:111], v[128:131], 0
    ds_read_b64_tr_b16 v[108:109], v10 offset:9376
    s_waitcnt lgkmcnt(11)
    v_mfma_f32_16x16x32_bf16 v[64:67], v[112:115], v[124:127], 0
    ds_read_b64_tr_b16 v[110:111], v10 offset:13984
    v_mfma_f32_16x16x32_bf16 v[68:71], v[112:115], v[128:131], 0
    ds_read_b64_tr_b16 v[112:113], v10 offset:9408
    v_mfma_f32_16x16x32_bf16 v[72:75], v[116:119], v[124:127], 0
    ds_read_b64_tr_b16 v[114:115], v10 offset:14016
    v_mfma_f32_16x16x32_bf16 v[76:79], v[116:119], v[128:131], 0
    ds_read_b64_tr_b16 v[116:117], v10 offset:9440
    v_mfma_f32_16x16x32_bf16 v[80:83], v[120:123], v[124:127], 0
    ds_read_b64_tr_b16 v[118:119], v10 offset:14048
    v_mfma_f32_16x16x32_bf16 v[84:87], v[120:123], v[128:131], 0
    ds_read_b64_tr_b16 v[120:121], v10 offset:9472
    ds_read_b64_tr_b16 v[122:123], v10 offset:14080
    s_waitcnt lgkmcnt(11)
    v_mfma_f32_16x16x32_bf16 v[16:19], v[88:91], v[132:135], v[16:19]
    ds_read_b128 v[124:127], v14 offset:0
    v_mfma_f32_16x16x32_bf16 v[20:23], v[88:91], v[136:139], v[20:23]
    ds_read_b128 v[128:131], v14 offset:2048
    ds_read_b64_tr_b16 v[88:89], v13 offset:0
    v_mfma_f32_16x16x32_bf16 v[24:27], v[92:95], v[132:135], v[24:27]
    ds_read_b64_tr_b16 v[90:91], v13 offset:4608
    v_mfma_f32_16x16x32_bf16 v[28:31], v[92:95], v[136:139], v[28:31]
    ds_read_b64_tr_b16 v[92:93], v13 offset:32
    ds_read_b64_tr_b16 v[94:95], v13 offset:4640
    v_mfma_f32_16x16x32_bf16 v[32:35], v[96:99], v[132:135], v[32:35]
    v_mfma_f32_16x16x32_bf16 v[36:39], v[96:99], v[136:139], v[36:39]
    ds_read_b64_tr_b16 v[96:97], v13 offset:64
    s_waitcnt lgkmcnt(11)
    v_mfma_f32_16x16x32_bf16 v[40:43], v[100:103], v[132:135], v[40:43]
    ds_read_b64_tr_b16 v[98:99], v13 offset:4672
    v_mfma_f32_16x16x32_bf16 v[44:47], v[100:103], v[136:139], v[44:47]
    ds_read_b64_tr_b16 v[100:101], v13 offset:96
    v_mfma_f32_16x16x32_bf16 v[48:51], v[104:107], v[132:135], v[48:51]
    ds_read_b64_tr_b16 v[102:103], v13 offset:4704
    v_mfma_f32_16x16x32_bf16 v[52:55], v[104:107], v[136:139], v[52:55]
    ds_read_b64_tr_b16 v[104:105], v13 offset:128
    v_mfma_f32_16x16x32_bf16 v[56:59], v[108:111], v[132:135], v[56:59]
    ds_read_b64_tr_b16 v[106:107], v13 offset:4736
    v_mfma_f32_16x16x32_bf16 v[60:63], v[108:111], v[136:139], v[60:63]
    ds_read_b64_tr_b16 v[108:109], v13 offset:160
    s_waitcnt lgkmcnt(11)
    v_mfma_f32_16x16x32_bf16 v[64:67], v[112:115], v[132:135], v[64:67]
    ds_read_b64_tr_b16 v[110:111], v13 offset:4768
    v_mfma_f32_16x16x32_bf16 v[68:71], v[112:115], v[136:139], v[68:71]
    ds_read_b64_tr_b16 v[112:113], v13 offset:192
    v_mfma_f32_16x16x32_bf16 v[72:75], v[116:119], v[132:135], v[72:75]
    ds_read_b64_tr_b16 v[114:115], v13 offset:4800
    v_mfma_f32_16x16x32_bf16 v[76:79], v[116:119], v[136:139], v[76:79]
    ds_read_b64_tr_b16 v[116:117], v13 offset:224
    v_mfma_f32_16x16x32_bf16 v[80:83], v[120:123], v[132:135], v[80:83]
    ds_read_b64_tr_b16 v[118:119], v13 offset:4832
    v_mfma_f32_16x16x32_bf16 v[84:87], v[120:123], v[136:139], v[84:87]
    ds_read_b64_tr_b16 v[120:121], v13 offset:256
    ds_read_b64_tr_b16 v[122:123], v13 offset:4864
    s_waitcnt lgkmcnt(11)
    v_mfma_f32_16x16x32_bf16 v[16:19], v[88:91], v[124:127], v[16:19]
    ds_read_b128 v[132:135], v15 offset:0
    v_mfma_f32_16x16x32_bf16 v[20:23], v[88:91], v[128:131], v[20:23]
    ds_read_b128 v[136:139], v15 offset:2048
    ds_read_b64_tr_b16 v[88:89], v13 offset:9216
    v_mfma_f32_16x16x32_bf16 v[24:27], v[92:95], v[124:127], v[24:27]
    ds_read_b64_tr_b16 v[90:91], v13 offset:13824
    v_mfma_f32_16x16x32_bf16 v[28:31], v[92:95], v[128:131], v[28:31]
    ds_read_b64_tr_b16 v[92:93], v13 offset:9248
    ds_read_b64_tr_b16 v[94:95], v13 offset:13856
    v_mfma_f32_16x16x32_bf16 v[32:35], v[96:99], v[124:127], v[32:35]
    v_mfma_f32_16x16x32_bf16 v[36:39], v[96:99], v[128:131], v[36:39]
    ds_read_b64_tr_b16 v[96:97], v13 offset:9280
    s_waitcnt lgkmcnt(11)
    v_mfma_f32_16x16x32_bf16 v[40:43], v[100:103], v[124:127], v[40:43]
    ds_read_b64_tr_b16 v[98:99], v13 offset:13888
    s_add_u32 s53, s53, 36864
    s_cmp_ge_u32 s53, 147456
    s_cselect_b32 s53, 0, s53
    v_mfma_f32_16x16x32_bf16 v[44:47], v[100:103], v[128:131], v[44:47]
    ds_read_b64_tr_b16 v[100:101], v13 offset:9312
    v_mfma_f32_16x16x32_bf16 v[48:51], v[104:107], v[124:127], v[48:51]
    ds_read_b64_tr_b16 v[102:103], v13 offset:13920
    v_mfma_f32_16x16x32_bf16 v[52:55], v[104:107], v[128:131], v[52:55]
    ds_read_b64_tr_b16 v[104:105], v13 offset:9344
    v_mfma_f32_16x16x32_bf16 v[56:59], v[108:111], v[124:127], v[56:59]
    ds_read_b64_tr_b16 v[106:107], v13 offset:13952
    v_mfma_f32_16x16x32_bf16 v[60:63], v[108:111], v[128:131], v[60:63]
    ds_read_b64_tr_b16 v[108:109], v13 offset:9376
    s_waitcnt lgkmcnt(11)
    v_mfma_f32_16x16x32_bf16 v[64:67], v[112:115], v[124:127], v[64:67]
    ds_read_b64_tr_b16 v[110:111], v13 offset:13984
    v_mfma_f32_16x16x32_bf16 v[68:71], v[112:115], v[128:131], v[68:71]
    ds_read_b64_tr_b16 v[112:113], v13 offset:9408
    v_mfma_f32_16x16x32_bf16 v[72:75], v[116:119], v[124:127], v[72:75]
    ds_read_b64_tr_b16 v[114:115], v13 offset:14016
    v_mfma_f32_16x16x32_bf16 v[76:79], v[116:119], v[128:131], v[76:79]
    ds_read_b64_tr_b16 v[116:117], v13 offset:9440
    v_mfma_f32_16x16x32_bf16 v[80:83], v[120:123], v[124:127], v[80:83]
    ds_read_b64_tr_b16 v[118:119], v13 offset:14048
    v_mfma_f32_16x16x32_bf16 v[84:87], v[120:123], v[128:131], v[84:87]
    ds_read_b64_tr_b16 v[120:121], v13 offset:9472
    ds_read_b64_tr_b16 v[122:123], v13 offset:14080
    s_waitcnt lgkmcnt(15)
    v_mfma_f32_16x16x32_bf16 v[16:19], v[88:91], v[132:135], v[16:19]
    v_mfma_f32_16x16x32_bf16 v[20:23], v[88:91], v[136:139], v[20:23]
    s_waitcnt lgkmcnt(14)
    v_mfma_f32_16x16x32_bf16 v[24:27], v[92:95], v[132:135], v[24:27]
    v_mfma_f32_16x16x32_bf16 v[28:31], v[92:95], v[136:139], v[28:31]
    s_waitcnt lgkmcnt(12)
    v_mfma_f32_16x16x32_bf16 v[32:35], v[96:99], v[132:135], v[32:35]
    v_mfma_f32_16x16x32_bf16 v[36:39], v[96:99], v[136:139], v[36:39]
    s_waitcnt lgkmcnt(10)
    v_mfma_f32_16x16x32_bf16 v[40:43], v[100:103], v[132:135], v[40:43]
    v_mfma_f32_16x16x32_bf16 v[44:47], v[100:103], v[136:139], v[44:47]
    s_waitcnt lgkmcnt(8)
    v_mfma_f32_16x16x32_bf16 v[48:51], v[104:107], v[132:135], v[48:51]
    v_mfma_f32_16x16x32_bf16 v[52:55], v[104:107], v[136:139], v[52:55]
    s_waitcnt lgkmcnt(6)
    v_mfma_f32_16x16x32_bf16 v[56:59], v[108:111], v[132:135], v[56:59]
    v_mfma_f32_16x16x32_bf16 v[60:63], v[108:111], v[136:139], v[60:63]
    s_waitcnt lgkmcnt(4)
    v_mfma_f32_16x16x32_bf16 v[64:67], v[112:115], v[132:135], v[64:67]
    v_mfma_f32_16x16x32_bf16 v[68:71], v[112:115], v[136:139], v[68:71]
    s_waitcnt lgkmcnt(2)
    v_mfma_f32_16x16x32_bf16 v[72:75], v[116:119], v[132:135], v[72:75]
    v_mfma_f32_16x16x32_bf16 v[76:79], v[116:119], v[136:139], v[76:79]
    s_waitcnt lgkmcnt(0)
    v_mfma_f32_16x16x32_bf16 v[80:83], v[120:123], v[132:135], v[80:83]
    v_mfma_f32_16x16x32_bf16 v[84:87], v[120:123], v[136:139], v[84:87]
    s_mul_i32 s58, s60, 256
    s_add_u32 s58, s58, 40370176
    v_and_b32 v8, 15, v3
    v_lshlrev_b32 v8, 2, v8
    s_mov_b32 s59, 0
L_poll_f0:
    buffer_load_dword v4, v8, s[40:43], s58 offen sc1
    s_waitcnt vmcnt(0)
    v_cmp_ne_u32 vcc, s52, v4
    s_add_u32 s59, s59, 1
    s_nop 1
    s_cbranch_vccz L_polled_f0
    s_sleep 1
    s_cmp_lt_u32 s59, 0x20000
    s_cbranch_scc1 L_poll_f0
L_polled_f0:
    buffer_load_dwordx4 v[88:91], v1, s[40:43], s63 offen offset:0 sc1
    buffer_load_dwordx4 v[92:95], v1, s[40:43], s63 offen offset:1024 sc1
    buffer_load_dwordx4 v[96:99], v1, s[40:43], s63 offen offset:2048 sc1
    buffer_load_dwordx4 v[100:103], v1, s[40:43], s63 offen offset:3072 sc1
    s_lshl_b32 s55, s21, 8
    s_add_u32 s55, s55, 162816
    v_and_b32 v14, 0xf0, v1
    v_add_u32 v14, s55, v14
    v_lshrrev_b32 v15, 4, v3
    v_lshl_add_u32 v15, v15, 6, s55
    s_waitcnt vmcnt(0)
    v_add_f32 v88, v88, v92
    v_add_f32 v96, v96, v100
    v_add_f32 v89, v89, v93
    v_add_f32 v97, v97, v101
    v_add_f32 v90, v90, v94
    v_add_f32 v98, v98, v102
    v_add_f32 v91, v91, v95
    v_add_f32 v99, v99, v103
    v_add_f32 v88, v88, v96
    v_add_f32 v89, v89, v97
    v_add_f32 v90, v90, v98
    v_add_f32 v91, v91, v99
    v_mov_b32 v92, v88
    s_nop 1
    v_permlane32_swap_b32 v88, v92
    s_nop 1
    v_add_f32 v88, v88, v92
    v_mov_b32 v92, v88
    s_nop 1
    v_permlane16_swap_b32 v88, v92
    s_nop 1
    v_add_f32 v88, v88, v92
    v_mov_b32 v92, v89
    s_nop 1
    v_permlane32_swap_b32 v89, v92
    s_nop 1
    v_add_f32 v89, v89, v92
    v_mov_b32 v92, v89
    s_nop 1
    v_permlane16_swap_b32 v89, v92
    s_nop 1
    v_add_f32 v89, v89, v92
    v_mov_b32 v92, v90
    s_nop 1
    v_permlane32_swap_b32 v90, v92
    s_nop 1
    v_add_f32 v90, v90, v92
    v_mov_b32 v92, v90
    s_nop 1
    v_permlane16_swap_b32 v90, v92
    s_nop 1
    v_add_f32 v90, v90, v92
    v_mov_b32 v92, v91
    s_nop 1
    v_permlane32_swap_b32 v91, v92
    s_nop 1
    v_add_f32 v91, v91, v92
    v_mov_b32 v92, v91
    s_nop 1
    v_permlane16_swap_b32 v91, v92
    s_nop 1
    v_add_f32 v91, v91, v92
    ds_write_b128 v14, v[88:91]
    s_waitcnt lgkmcnt(0)
    ds_read_b128 v[120:123], v15 offset:0
    ds_read_b128 v[124:127], v15 offset:16
    ds_read_b128 v[128:131], v15 offset:32
    ds_read_b128 v[132:135], v15 offset:48
    s_mov_b32 s56, 0x39e38e39
    s_mov_b32 s57, 0x3727c5ac
    s_lshl_b32 s55, s16, 6
    s_add_u32 s55, s55, s60
    s_mul_i32 s58, s16, 256
    s_lshl_b32 s59, s60, 2
    s_add_u32 s58, s58, s59
    s_add_u32 s58, s58, 40386816
    s_mul_i32 s55, s55, 9216
    s_add_u32 s55, s55, 0
    s_waitcnt lgkmcnt(0)
    v_mul_f32 v120, s56, v120
    v_mul_f32 v121, s56, v121
    v_mul_f32 v122, s56, v122
    v_mul_f32 v123, s56, v123
    v_mul_f32 v124, s56, v124
    v_mul_f32 v125, s56, v125
    v_mul_f32 v126, s56, v126
    v_mul_f32 v127, s56, v127
    v_mul_f32 v128, s56, v128
    v_mul_f32 v129, s56, v129
    v_mul_f32 v130, s56, v130
    v_mul_f32 v131, s56, v131
    v_mul_f32 v132, s56, v132
    v_mul_f32 v133, s56, v133
    v_mul_f32 v134, s56, v134
    v_mul_f32 v135, s56, v135
    v_fma_f32 v128, -v120, v120, v128
    v_fma_f32 v129, -v121, v121, v129
    v_fma_f32 v130, -v122, v122, v130
    v_fma_f32 v131, -v123, v123, v131
    v_fma_f32 v132, -v124, v124, v132
    v_fma_f32 v133, -v125, v125, v133
    v_fma_f32 v134, -v126, v126, v134
    v_fma_f32 v135, -v127, v127, v135
    v_max_f32 v128, 0, v128
    v_max_f32 v129, 0, v129
    v_max_f32 v130, 0, v130
    v_max_f32 v131, 0, v131
    v_max_f32 v132, 0, v132
    v_max_f32 v133, 0, v133
    v_max_f32 v134, 0, v134
    v_max_f32 v135, 0, v135
    v_add_f32 v128, s57, v128
    v_add_f32 v129, s57, v129
    v_add_f32 v130, s57, v130
    v_add_f32 v131, s57, v131
    v_add_f32 v132, s57, v132
    v_add_f32 v133, s57, v133
    v_add_f32 v134, s57, v134
    v_add_f32 v135, s57, v135
    v_rsq_f32 v128, v128
    v_rsq_f32 v129, v129
    v_rsq_f32 v130, v130
    v_rsq_f32 v131, v131
    v_rsq_f32 v132, v132
    v_rsq_f32 v133, v133
    v_rsq_f32 v134, v134
    v_rsq_f32 v135, v135
    s_nop 0
    v_mul_f32 v120, v120, v128
    v_mul_f32 v121, v121, v129
    v_mul_f32 v122, v122, v130
    v_mul_f32 v123, v123, v131
    v_mul_f32 v124, v124, v132
    v_mul_f32 v125, v125, v133
    v_mul_f32 v126, v126, v134
    v_mul_f32 v127, v127, v135
    v_lshlrev_b32 v176, 16, v140
    v_and_b32 v177, 0xffff0000, v140
    v_lshlrev_b32 v178, 16, v141
    v_and_b32 v179, 0xffff0000, v141
    v_lshlrev_b32 v180, 16, v142
    v_and_b32 v181, 0xffff0000, v142
    v_lshlrev_b32 v182, 16, v143
    v_and_b32 v183, 0xffff0000, v143
    v_pk_fma_f32 v[176:177], v[176:177], v[128:129], v[120:121] neg_lo:[0,0,1] neg_hi:[0,0,1]
    v_pk_fma_f32 v[178:179], v[178:179], v[130:131], v[122:123] neg_lo:[0,0,1] neg_hi:[0,0,1]
    v_pk_fma_f32 v[180:181], v[180:181], v[132:133], v[124:125] neg_lo:[0,0,1] neg_hi:[0,0,1]
    v_pk_fma_f32 v[182:183], v[182:183], v[134:135], v[126:127] neg_lo:[0,0,1] neg_hi:[0,0,1]
    v_cvt_pk_bf16_f32 v184, v176, v177
    v_cvt_pk_bf16_f32 v185, v178, v179
    v_cvt_pk_bf16_f32 v186, v180, v181
    v_cvt_pk_bf16_f32 v187, v182, v183
    s_add_u32 s56, s55, 0
    buffer_store_dwordx4 v[184:187], v1, s[40:43], s56 offen sc1
    v_lshlrev_b32 v188, 16, v144
    v_and_b32 v189, 0xffff0000, v144
    v_lshlrev_b32 v190, 16, v145
    v_and_b32 v191, 0xffff0000, v145
    v_lshlrev_b32 v192, 16, v146
    v_and_b32 v193, 0xffff0000, v146
    v_lshlrev_b32 v194, 16, v147
    v_and_b32 v195, 0xffff0000, v147
    v_pk_fma_f32 v[188:189], v[188:189], v[128:129], v[120:121] neg_lo:[0,0,1] neg_hi:[0,0,1]
    v_pk_fma_f32 v[190:191], v[190:191], v[130:131], v[122:123] neg_lo:[0,0,1] neg_hi:[0,0,1]
    v_pk_fma_f32 v[192:193], v[192:193], v[132:133], v[124:125] neg_lo:[0,0,1] neg_hi:[0,0,1]
    v_pk_fma_f32 v[194:195], v[194:195], v[134:135], v[126:127] neg_lo:[0,0,1] neg_hi:[0,0,1]
    v_cvt_pk_bf16_f32 v196, v188, v189
    v_cvt_pk_bf16_f32 v197, v190, v191
    v_cvt_pk_bf16_f32 v198, v192, v193
    v_cvt_pk_bf16_f32 v199, v194, v195
    s_add_u32 s56, s55, 1024
    buffer_store_dwordx4 v[196:199], v1, s[40:43], s56 offen sc1
    v_lshlrev_b32 v176, 16, v148
    v_and_b32 v177, 0xffff0000, v148
    v_lshlrev_b32 v178, 16, v149
    v_and_b32 v179, 0xffff0000, v149
    v_lshlrev_b32 v180, 16, v150
    v_and_b32 v181, 0xffff0000, v150
    v_lshlrev_b32 v182, 16, v151
    v_and_b32 v183, 0xffff0000, v151
    v_pk_fma_f32 v[176:177], v[176:177], v[128:129], v[120:121] neg_lo:[0,0,1] neg_hi:[0,0,1]
    v_pk_fma_f32 v[178:179], v[178:179], v[130:131], v[122:123] neg_lo:[0,0,1] neg_hi:[0,0,1]
    v_pk_fma_f32 v[180:181], v[180:181], v[132:133], v[124:125] neg_lo:[0,0,1] neg_hi:[0,0,1]
    v_pk_fma_f32 v[182:183], v[182:183], v[134:135], v[126:127] neg_lo:[0,0,1] neg_hi:[0,0,1]
    v_cvt_pk_bf16_f32 v184, v176, v177
    v_cvt_pk_bf16_f32 v185, v178, v179
    v_cvt_pk_bf16_f32 v186, v180, v181
    v_cvt_pk_bf16_f32 v187, v182, v183
    s_add_u32 s56, s55, 2048
    buffer_store_dwordx4 v[184:187], v1, s[40:43], s56 offen sc1
    v_lshlrev_b32 v188, 16, v152
    v_and_b32 v189, 0xffff0000, v152
    v_lshlrev_b32 v190, 16, v153
    v_and_b32 v191, 0xffff0000, v153
    v_lshlrev_b32 v192, 16, v154
    v_and_b32 v193, 0xffff0000, v154
    v_lshlrev_b32 v194, 16, v155
    v_and_b32 v195, 0xffff0000, v155
    v_pk_fma_f32 v[188:189], v[188:189], v[128:129], v[120:121] neg_lo:[0,0,1] neg_hi:[0,0,1]
    v_pk_fma_f32 v[190:191], v[190:191], v[130:131], v[122:123] neg_lo:[0,0,1] neg_hi:[0,0,1]
    v_pk_fma_f32 v[192:193], v[192:193], v[132:133], v[124:125] neg_lo:[0,0,1] neg_hi:[0,0,1]
    v_pk_fma_f32 v[194:195], v[194:195], v[134:135], v[126:127] neg_lo:[0,0,1] neg_hi:[0,0,1]
    v_cvt_pk_bf16_f32 v196, v188, v189
    v_cvt_pk_bf16_f32 v197, v190, v191
    v_cvt_pk_bf16_f32 v198, v192, v193
    v_cvt_pk_bf16_f32 v199, v194, v195
    s_add_u32 s56, s55, 3072
    buffer_store_dwordx4 v[196:199], v1, s[40:43], s56 offen sc1
    v_lshlrev_b32 v176, 16, v156
    v_and_b32 v177, 0xffff0000, v156
    v_lshlrev_b32 v178, 16, v157
    v_and_b32 v179, 0xffff0000, v157
    v_lshlrev_b32 v180, 16, v158
    v_and_b32 v181, 0xffff0000, v158
    v_lshlrev_b32 v182, 16, v159
    v_and_b32 v183, 0xffff0000, v159
    v_pk_fma_f32 v[176:177], v[176:177], v[128:129], v[120:121] neg_lo:[0,0,1] neg_hi:[0,0,1]
    v_pk_fma_f32 v[178:179], v[178:179], v[130:131], v[122:123] neg_lo:[0,0,1] neg_hi:[0,0,1]
    v_pk_fma_f32 v[180:181], v[180:181], v[132:133], v[124:125] neg_lo:[0,0,1] neg_hi:[0,0,1]
    v_pk_fma_f32 v[182:183], v[182:183], v[134:135], v[126:127] neg_lo:[0,0,1] neg_hi:[0,0,1]
    v_cvt_pk_bf16_f32 v184, v176, v177
    v_cvt_pk_bf16_f32 v185, v178, v179
    v_cvt_pk_bf16_f32 v186, v180, v181
    v_cvt_pk_bf16_f32 v187, v182, v183
    s_add_u32 s56, s55, 4096
    buffer_store_dwordx4 v[184:187], v1, s[40:43], s56 offen sc1
    v_lshlrev_b32 v188, 16, v160
    v_and_b32 v189, 0xffff0000, v160
    v_lshlrev_b32 v190, 16, v161
    v_and_b32 v191, 0xffff0000, v161
    v_lshlrev_b32 v192, 16, v162
    v_and_b32 v193, 0xffff0000, v162
    v_lshlrev_b32 v194, 16, v163
    v_and_b32 v195, 0xffff0000, v163
    v_pk_fma_f32 v[188:189], v[188:189], v[128:129], v[120:121] neg_lo:[0,0,1] neg_hi:[0,0,1]
    v_pk_fma_f32 v[190:191], v[190:191], v[130:131], v[122:123] neg_lo:[0,0,1] neg_hi:[0,0,1]
    v_pk_fma_f32 v[192:193], v[192:193], v[132:133], v[124:125] neg_lo:[0,0,1] neg_hi:[0,0,1]
    v_pk_fma_f32 v[194:195], v[194:195], v[134:135], v[126:127] neg_lo:[0,0,1] neg_hi:[0,0,1]
    v_cvt_pk_bf16_f32 v196, v188, v189
    v_cvt_pk_bf16_f32 v197, v190, v191
    v_cvt_pk_bf16_f32 v198, v192, v193
    v_cvt_pk_bf16_f32 v199, v194, v195
    s_add_u32 s56, s55, 5120
    buffer_store_dwordx4 v[196:199], v1, s[40:43], s56 offen sc1
    v_lshlrev_b32 v176, 16, v164
    v_and_b32 v177, 0xffff0000, v164
    v_lshlrev_b32 v178, 16, v165
    v_and_b32 v179, 0xffff0000, v165
    v_lshlrev_b32 v180, 16, v166
    v_and_b32 v181, 0xffff0000, v166
    v_lshlrev_b32 v182, 16, v167
    v_and_b32 v183, 0xffff0000, v167
    v_pk_fma_f32 v[176:177], v[176:177], v[128:129], v[120:121] neg_lo:[0,0,1] neg_hi:[0,0,1]
    v_pk_fma_f32 v[178:179], v[178:179], v[130:131], v[122:123] neg_lo:[0,0,1] neg_hi:[0,0,1]
    v_pk_fma_f32 v[180:181], v[180:181], v[132:133], v[124:125] neg_lo:[0,0,1] neg_hi:[0,0,1]
    v_pk_fma_f32 v[182:183], v[182:183], v[134:135], v[126:127] neg_lo:[0,0,1] neg_hi:[0,0,1]
    v_cvt_pk_bf16_f32 v184, v176, v177
    v_cvt_pk_bf16_f32 v185, v178, v179
    v_cvt_pk_bf16_f32 v186, v180, v181
    v_cvt_pk_bf16_f32 v187, v182, v183
    s_add_u32 s56, s55, 6144
    buffer_store_dwordx4 v[184:187], v1, s[40:43], s56 offen sc1
    v_lshlrev_b32 v188, 16, v168
    v_and_b32 v189, 0xffff0000, v168
    v_lshlrev_b32 v190, 16, v169
    v_and_b32 v191, 0xffff0000, v169
    v_lshlrev_b32 v192, 16, v170
    v_and_b32 v193, 0xffff0000, v170
    v_lshlrev_b32 v194, 16, v171
    v_and_b32 v195, 0xffff0000, v171
    v_pk_fma_f32 v[188:189], v[188:189], v[128:129], v[120:121] neg_lo:[0,0,1] neg_hi:[0,0,1]
    v_pk_fma_f32 v[190:191], v[190:191], v[130:131], v[122:123] neg_lo:[0,0,1] neg_hi:[0,0,1]
    v_pk_fma_f32 v[192:193], v[192:193], v[132:133], v[124:125] neg_lo:[0,0,1] neg_hi:[0,0,1]
    v_pk_fma_f32 v[194:195], v[194:195], v[134:135], v[126:127] neg_lo:[0,0,1] neg_hi:[0,0,1]
    v_cvt_pk_bf16_f32 v196, v188, v189
    v_cvt_pk_bf16_f32 v197, v190, v191
    v_cvt_pk_bf16_f32 v198, v192, v193
    v_cvt_pk_bf16_f32 v199, v194, v195
    s_add_u32 s56, s55, 7168
    buffer_store_dwordx4 v[196:199], v1, s[40:43], s56 offen sc1
    v_lshlrev_b32 v176, 16, v172
    v_and_b32 v177, 0xffff0000, v172
    v_lshlrev_b32 v178, 16, v173
    v_and_b32 v179, 0xffff0000, v173
    v_lshlrev_b32 v180, 16, v174
    v_and_b32 v181, 0xffff0000, v174
    v_lshlrev_b32 v182, 16, v175
    v_and_b32 v183, 0xffff0000, v175
    v_pk_fma_f32 v[176:177], v[176:177], v[128:129], v[120:121] neg_lo:[0,0,1] neg_hi:[0,0,1]
    v_pk_fma_f32 v[178:179], v[178:179], v[130:131], v[122:123] neg_lo:[0,0,1] neg_hi:[0,0,1]
    v_pk_fma_f32 v[180:181], v[180:181], v[132:133], v[124:125] neg_lo:[0,0,1] neg_hi:[0,0,1]
    v_pk_fma_f32 v[182:183], v[182:183], v[134:135], v[126:127] neg_lo:[0,0,1] neg_hi:[0,0,1]
    v_cvt_pk_bf16_f32 v184, v176, v177
    v_cvt_pk_bf16_f32 v185, v178, v179
    v_cvt_pk_bf16_f32 v186, v180, v181
    v_cvt_pk_bf16_f32 v187, v182, v183
    s_add_u32 s56, s55, 8192
    buffer_store_dwordx4 v[184:187], v1, s[40:43], s56 offen sc1
    s_mov_b32 s44, s4
    s_mov_b32 s45, s5
    s_mov_b32 s46, 0x800000
    s_mov_b32 s47, 0x00020000
    s_lshl_b32 s64, s17, 4
    s_add_u32 s64, s64, s16
    s_lshl_b32 s64, s64, 2
    s_add_u32 s64, s64, s21
    s_lshl_b32 s64, s64, 13
    v_mov_b32 v214, v213
    s_add_u32 s64, s64, 2048
    v_mov_b32 v214, v211
    s_mov_b32 s48, s6
    s_mov_b32 s49, s7
    s_mov_b32 s50, 0x1000
    s_mov_b32 s51, 0x00020000
    v_bfe_u32 v5, v3, 2, 2
    v_lshlrev_b32 v5, 3, v5
    v_and_b32 v4, 3, v3
    v_add_lshl_u32 v5, v5, v4, 1
    s_lshl_b32 s55, s60, 6
    buffer_load_ushort v227, v5, s[48:51], s55 offen
    buffer_load_ushort v228, v5, s[48:51], s55 offen offset:8
    v_lshrrev_b32 v14, 4, v3
    v_lshlrev_b32 v14, 2, v14
    v_bfe_u32 v15, v3, 2, 2
    v_add_u32 v14, v14, v15
    v_mul_u32_u24 v14, 288, v14
    v_and_b32 v15, 3, v3
    v_lshl_add_u32 v7, v15, 3, v14
    v_and_b32 v14, 15, v3
    v_lshlrev_b32 v14, 7, v14
    v_bfe_u32 v15, v3, 1, 3
    v_lshrrev_b32 v13, 4, v3
    v_xor_b32 v15, v15, v13
    v_lshl_add_u32 v14, v15, 4, v14
    s_lshl_b32 s55, s21, 12
    s_add_u32 s55, s55, 18432
    v_add_u32 v8, s55, v14
    v_xor_b32 v9, 64, v8
    v_add_u32 v10, s53, v7
    v_add_u32 v11, s53, v8
    v_add_u32 v12, s53, v9
    s_barrier
    ds_read_b128 v[124:127], v11 offset:0
    ds_read_b128 v[128:131], v11 offset:2048
    ds_read_b64_tr_b16 v[88:89], v10 offset:0
    ds_read_b64_tr_b16 v[90:91], v10 offset:4608
    ds_read_b64_tr_b16 v[92:93], v10 offset:32
    ds_read_b64_tr_b16 v[94:95], v10 offset:4640
    ds_read_b64_tr_b16 v[96:97], v10 offset:64
    ds_read_b64_tr_b16 v[98:99], v10 offset:4672
    ds_read_b64_tr_b16 v[100:101], v10 offset:96
    ds_read_b64_tr_b16 v[102:103], v10 offset:4704
    ds_read_b64_tr_b16 v[104:105], v10 offset:128
    ds_read_b64_tr_b16 v[106:107], v10 offset:4736
    ds_read_b64_tr_b16 v[108:109], v10 offset:160
    ds_read_b64_tr_b16 v[110:111], v10 offset:4768
    ds_read_b64_tr_b16 v[112:113], v10 offset:192
    ds_read_b64_tr_b16 v[114:115], v10 offset:4800
    ds_read_b64_tr_b16 v[116:117], v10 offset:224
    ds_read_b64_tr_b16 v[118:119], v10 offset:4832
    ds_read_b64_tr_b16 v[120:121], v10 offset:256
    ds_read_b64_tr_b16 v[122:123], v10 offset:4864
    s_waitcnt lgkmcnt(11)
    v_mfma_f32_16x16x32_bf16 v[16:19], v[88:91], v[124:127], v[16:19]
    ds_read_b128 v[132:135], v12 offset:0
    v_mfma_f32_16x16x32_bf16 v[20:23], v[88:91], v[128:131], v[20:23]
    ds_read_b128 v[136:139], v12 offset:2048
    ds_read_b64_tr_b16 v[88:89], v10 offset:9216
    v_mfma_f32_16x16x32_bf16 v[24:27], v[92:95], v[124:127], v[24:27]
    ds_read_b64_tr_b16 v[90:91], v10 offset:13824
    v_mfma_f32_16x16x32_bf16 v[28:31], v[92:95], v[128:131], v[28:31]
    ds_read_b64_tr_b16 v[92:93], v10 offset:9248
    ds_read_b64_tr_b16 v[94:95], v10 offset:13856
    v_mfma_f32_16x16x32_bf16 v[32:35], v[96:99], v[124:127], v[32:35]
    v_mfma_f32_16x16x32_bf16 v[36:39], v[96:99], v[128:131], v[36:39]
    ds_read_b64_tr_b16 v[96:97], v10 offset:9280
    s_waitcnt lgkmcnt(11)
    v_mfma_f32_16x16x32_bf16 v[40:43], v[100:103], v[124:127], v[40:43]
    ds_read_b64_tr_b16 v[98:99], v10 offset:13888
    s_add_u32 s53, s53, 36864
    s_cmp_ge_u32 s53, 147456
    s_cselect_b32 s53, 0, s53
    v_mfma_f32_16x16x32_bf16 v[44:47], v[100:103], v[128:131], v[44:47]
    ds_read_b64_tr_b16 v[100:101], v10 offset:9312
    v_add_u32 v13, s53, v7
    v_mfma_f32_16x16x32_bf16 v[48:51], v[104:107], v[124:127], v[48:51]
    ds_read_b64_tr_b16 v[102:103], v10 offset:13920
    v_add_u32 v14, s53, v8
    v_mfma_f32_16x16x32_bf16 v[52:55], v[104:107], v[128:131], v[52:55]
    ds_read_b64_tr_b16 v[104:105], v10 offset:9344
    v_add_u32 v15, s53, v9
    v_mfma_f32_16x16x32_bf16 v[56:59], v[108:111], v[124:127], v[56:59]
    ds_read_b64_tr_b16 v[106:107], v10 offset:13952
    s_mov_b32 s54, 1
    v_mfma_f32_16x16x32_bf16 v[60:63], v[108:111], v[128:131], v[60:63]
    ds_read_b64_tr_b16 v[108:109], v10 offset:9376
    s_waitcnt lgkmcnt(11)
    v_mfma_f32_16x16x32_bf16 v[64:67], v[112:115], v[124:127], v[64:67]
    ds_read_b64_tr_b16 v[110:111], v10 offset:13984
    v_mfma_f32_16x16x32_bf16 v[68:71], v[112:115], v[128:131], v[68:71]
    ds_read_b64_tr_b16 v[112:113], v10 offset:9408
    v_mfma_f32_16x16x32_bf16 v[72:75], v[116:119], v[124:127], v[72:75]
    ds_read_b64_tr_b16 v[114:115], v10 offset:14016
    v_mfma_f32_16x16x32_bf16 v[76:79], v[116:119], v[128:131], v[76:79]
    ds_read_b64_tr_b16 v[116:117], v10 offset:9440
    v_mfma_f32_16x16x32_bf16 v[80:83], v[120:123], v[124:127], v[80:83]
    ds_read_b64_tr_b16 v[118:119], v10 offset:14048
    v_mfma_f32_16x16x32_bf16 v[84:87], v[120:123], v[128:131], v[84:87]
    ds_read_b64_tr_b16 v[120:121], v10 offset:9472
    ds_read_b64_tr_b16 v[122:123], v10 offset:14080
L_c_z1:
    s_barrier
    s_waitcnt lgkmcnt(11)
    v_mfma_f32_16x16x32_bf16 v[16:19], v[88:91], v[132:135], v[16:19]
    ds_read_b128 v[124:127], v14 offset:0
    v_mfma_f32_16x16x32_bf16 v[20:23], v[88:91], v[136:139], v[20:23]
    ds_read_b128 v[128:131], v14 offset:2048
    ds_read_b64_tr_b16 v[88:89], v13 offset:0
    v_mfma_f32_16x16x32_bf16 v[24:27], v[92:95], v[132:135], v[24:27]
    ds_read_b64_tr_b16 v[90:91], v13 offset:4608
    v_mfma_f32_16x16x32_bf16 v[28:31], v[92:95], v[136:139], v[28:31]
    ds_read_b64_tr_b16 v[92:93], v13 offset:32
    ds_read_b64_tr_b16 v[94:95], v13 offset:4640
    v_mfma_f32_16x16x32_bf16 v[32:35], v[96:99], v[132:135], v[32:35]
    v_mfma_f32_16x16x32_bf16 v[36:39], v[96:99], v[136:139], v[36:39]
    ds_read_b64_tr_b16 v[96:97], v13 offset:64
    s_waitcnt lgkmcnt(11)
    v_mfma_f32_16x16x32_bf16 v[40:43], v[100:103], v[132:135], v[40:43]
    ds_read_b64_tr_b16 v[98:99], v13 offset:4672
    v_mfma_f32_16x16x32_bf16 v[44:47], v[100:103], v[136:139], v[44:47]
    ds_read_b64_tr_b16 v[100:101], v13 offset:96
    v_mfma_f32_16x16x32_bf16 v[48:51], v[104:107], v[132:135], v[48:51]
    ds_read_b64_tr_b16 v[102:103], v13 offset:4704
    v_mfma_f32_16x16x32_bf16 v[52:55], v[104:107], v[136:139], v[52:55]
    ds_read_b64_tr_b16 v[104:105], v13 offset:128
    v_mfma_f32_16x16x32_bf16 v[56:59], v[108:111], v[132:135], v[56:59]
    ds_read_b64_tr_b16 v[106:107], v13 offset:4736
    v_mfma_f32_16x16x32_bf16 v[60:63], v[108:111], v[136:139], v[60:63]
    ds_read_b64_tr_b16 v[108:109], v13 offset:160
    s_waitcnt lgkmcnt(11)
    v_mfma_f32_16x16x32_bf16 v[64:67], v[112:115], v[132:135], v[64:67]
    ds_read_b64_tr_b16 v[110:111], v13 offset:4768
    v_mfma_f32_16x16x32_bf16 v[68:71], v[112:115], v[136:139], v[68:71]
    ds_read_b64_tr_b16 v[112:113], v13 offset:192
    v_mfma_f32_16x16x32_bf16 v[72:75], v[116:119], v[132:135], v[72:75]
    ds_read_b64_tr_b16 v[114:115], v13 offset:4800
    v_mfma_f32_16x16x32_bf16 v[76:79], v[116:119], v[136:139], v[76:79]
    ds_read_b64_tr_b16 v[116:117], v13 offset:224
    v_mfma_f32_16x16x32_bf16 v[80:83], v[120:123], v[132:135], v[80:83]
    ds_read_b64_tr_b16 v[118:119], v13 offset:4832
    v_mfma_f32_16x16x32_bf16 v[84:87], v[120:123], v[136:139], v[84:87]
    ds_read_b64_tr_b16 v[120:121], v13 offset:256
    ds_read_b64_tr_b16 v[122:123], v13 offset:4864
    s_cmp_lg_u32 s54, 3
    s_cbranch_scc1 L_c_x1_0
    s_waitcnt vmcnt(0)
    v_mov_b32 v230, 0
    v_mov_b32 v231, s52
    s_mov_b64 exec, 1
    buffer_store_dword v231, v230, s[40:43], s58 offen sc1
    s_mov_b64 exec, -1
L_c_x1_0:
    s_cmp_lg_u32 s54, 6
    s_cbranch_scc1 L_c_x2_0
    buffer_load_dword v226, v214, s[44:47], s64 offen
L_c_x2_0:
    s_waitcnt lgkmcnt(11)
    v_mfma_f32_16x16x32_bf16 v[16:19], v[88:91], v[124:127], v[16:19]
    ds_read_b128 v[132:135], v15 offset:0
    v_mfma_f32_16x16x32_bf16 v[20:23], v[88:91], v[128:131], v[20:23]
    ds_read_b128 v[136:139], v15 offset:2048
    ds_read_b64_tr_b16 v[88:89], v13 offset:9216
    v_mfma_f32_16x16x32_bf16 v[24:27], v[92:95], v[124:127], v[24:27]
    ds_read_b64_tr_b16 v[90:91], v13 offset:13824
    v_mfma_f32_16x16x32_bf16 v[28:31], v[92:95], v[128:131], v[28:31]
    ds_read_b64_tr_b16 v[92:93], v13 offset:9248
    ds_read_b64_tr_b16 v[94:95], v13 offset:13856
    v_mfma_f32_16x16x32_bf16 v[32:35], v[96:99], v[124:127], v[32:35]
    v_mfma_f32_16x16x32_bf16 v[36:39], v[96:99], v[128:131], v[36:39]
    ds_read_b64_tr_b16 v[96:97], v13 offset:9280
    s_waitcnt lgkmcnt(11)
    v_mfma_f32_16x16x32_bf16 v[40:43], v[100:103], v[124:127], v[40:43]
    ds_read_b64_tr_b16 v[98:99], v13 offset:13888
    s_add_u32 s53, s53, 36864
    s_cmp_ge_u32 s53, 147456
    s_cselect_b32 s53, 0, s53
    v_mfma_f32_16x16x32_bf16 v[44:47], v[100:103], v[128:131], v[44:47]
    ds_read_b64_tr_b16 v[100:101], v13 offset:9312
    v_add_u32 v10, s53, v7
    v_mfma_f32_16x16x32_bf16 v[48:51], v[104:107], v[124:127], v[48:51]
    ds_read_b64_tr_b16 v[102:103], v13 offset:13920
    v_add_u32 v11, s53, v8
    v_mfma_f32_16x16x32_bf16 v[52:55], v[104:107], v[128:131], v[52:55]
    ds_read_b64_tr_b16 v[104:105], v13 offset:9344
    v_add_u32 v12, s53, v9
    v_mfma_f32_16x16x32_bf16 v[56:59], v[108:111], v[124:127], v[56:59]
    ds_read_b64_tr_b16 v[106:107], v13 offset:13952
    s_add_u32 s54, s54, 1
    v_mfma_f32_16x16x32_bf16 v[60:63], v[108:111], v[128:131], v[60:63]
    ds_read_b64_tr_b16 v[108:109], v13 offset:9376
    s_waitcnt lgkmcnt(11)
    v_mfma_f32_16x16x32_bf16 v[64:67], v[112:115], v[124:127], v[64:67]
    ds_read_b64_tr_b16 v[110:111], v13 offset:13984
    v_mfma_f32_16x16x32_bf16 v[68:71], v[112:115], v[128:131], v[68:71]
    ds_read_b64_tr_b16 v[112:113], v13 offset:9408
    v_mfma_f32_16x16x32_bf16 v[72:75], v[116:119], v[124:127], v[72:75]
    ds_read_b64_tr_b16 v[114:115], v13 offset:14016
    v_mfma_f32_16x16x32_bf16 v[76:79], v[116:119], v[128:131], v[76:79]
    ds_read_b64_tr_b16 v[116:117], v13 offset:9440
    v_mfma_f32_16x16x32_bf16 v[80:83], v[120:123], v[124:127], v[80:83]
    ds_read_b64_tr_b16 v[118:119], v13 offset:14048
    v_mfma_f32_16x16x32_bf16 v[84:87], v[120:123], v[128:131], v[84:87]
    ds_read_b64_tr_b16 v[120:121], v13 offset:9472
    ds_read_b64_tr_b16 v[122:123], v13 offset:14080
    s_barrier
    s_waitcnt lgkmcnt(11)
    v_mfma_f32_16x16x32_bf16 v[16:19], v[88:91], v[132:135], v[16:19]
    ds_read_b128 v[124:127], v11 offset:0
    v_mfma_f32_16x16x32_bf16 v[20:23], v[88:91], v[136:139], v[20:23]
    ds_read_b128 v[128:131], v11 offset:2048
    ds_read_b64_tr_b16 v[88:89], v10 offset:0
    v_mfma_f32_16x16x32_bf16 v[24:27], v[92:95], v[132:135], v[24:27]
    ds_read_b64_tr_b16 v[90:91], v10 offset:4608
    v_mfma_f32_16x16x32_bf16 v[28:31], v[92:95], v[136:139], v[28:31]
    ds_read_b64_tr_b16 v[92:93], v10 offset:32
    ds_read_b64_tr_b16 v[94:95], v10 offset:4640
    v_mfma_f32_16x16x32_bf16 v[32:35], v[96:99], v[132:135], v[32:35]
    v_mfma_f32_16x16x32_bf16 v[36:39], v[96:99], v[136:139], v[36:39]
    ds_read_b64_tr_b16 v[96:97], v10 offset:64
    s_waitcnt lgkmcnt(11)
    v_mfma_f32_16x16x32_bf16 v[40:43], v[100:103], v[132:135], v[40:43]
    ds_read_b64_tr_b16 v[98:99], v10 offset:4672
    v_mfma_f32_16x16x32_bf16 v[44:47], v[100:103], v[136:139], v[44:47]
    ds_read_b64_tr_b16 v[100:101], v10 offset:96
    v_mfma_f32_16x16x32_bf16 v[48:51], v[104:107], v[132:135], v[48:51]
    ds_read_b64_tr_b16 v[102:103], v10 offset:4704
    v_mfma_f32_16x16x32_bf16 v[52:55], v[104:107], v[136:139], v[52:55]
    ds_read_b64_tr_b16 v[104:105], v10 offset:128
    v_mfma_f32_16x16x32_bf16 v[56:59], v[108:111], v[132:135], v[56:59]
    ds_read_b64_tr_b16 v[106:107], v10 offset:4736
    v_mfma_f32_16x16x32_bf16 v[60:63], v[108:111], v[136:139], v[60:63]
    ds_read_b64_tr_b16 v[108:109], v10 offset:160
    s_waitcnt lgkmcnt(11)
    v_mfma_f32_16x16x32_bf16 v[64:67], v[112:115], v[132:135], v[64:67]
    ds_read_b64_tr_b16 v[110:111], v10 offset:4768
    v_mfma_f32_16x16x32_bf16 v[68:71], v[112:115], v[136:139], v[68:71]
    ds_read_b64_tr_b16 v[112:113], v10 offset:192
    v_mfma_f32_16x16x32_bf16 v[72:75], v[116:119], v[132:135], v[72:75]
    ds_read_b64_tr_b16 v[114:115], v10 offset:4800
    v_mfma_f32_16x16x32_bf16 v[76:79], v[116:119], v[136:139], v[76:79]
    ds_read_b64_tr_b16 v[116:117], v10 offset:224
    v_mfma_f32_16x16x32_bf16 v[80:83], v[120:123], v[132:135], v[80:83]
    ds_read_b64_tr_b16 v[118:119], v10 offset:4832
    v_mfma_f32_16x16x32_bf16 v[84:87], v[120:123], v[136:139], v[84:87]
    ds_read_b64_tr_b16 v[120:121], v10 offset:256
    ds_read_b64_tr_b16 v[122:123], v10 offset:4864
    s_cmp_lg_u32 s54, 3
    s_cbranch_scc1 L_c_x1_1
    s_waitcnt vmcnt(0)
    v_mov_b32 v230, 0
    v_mov_b32 v231, s52
    s_mov_b64 exec, 1
    buffer_store_dword v231, v230, s[40:43], s58 offen sc1
    s_mov_b64 exec, -1
L_c_x1_1:
    s_cmp_lg_u32 s54, 6
    s_cbranch_scc1 L_c_x2_1
    buffer_load_dword v226, v214, s[44:47], s64 offen
L_c_x2_1:
    s_waitcnt lgkmcnt(11)
    v_mfma_f32_16x16x32_bf16 v[16:19], v[88:91], v[124:127], v[16:19]
    ds_read_b128 v[132:135], v12 offset:0
    v_mfma_f32_16x16x32_bf16 v[20:23], v[88:91], v[128:131], v[20:23]
    ds_read_b128 v[136:139], v12 offset:2048
    ds_read_b64_tr_b16 v[88:89], v10 offset:9216
    v_mfma_f32_16x16x32_bf16 v[24:27], v[92:95], v[124:127], v[24:27]
    ds_read_b64_tr_b16 v[90:91], v10 offset:13824
    v_mfma_f32_16x16x32_bf16 v[28:31], v[92:95], v[128:131], v[28:31]
    ds_read_b64_tr_b16 v[92:93], v10 offset:9248
    ds_read_b64_tr_b16 v[94:95], v10 offset:13856
    v_mfma_f32_16x16x32_bf16 v[32:35], v[96:99], v[124:127], v[32:35]
    v_mfma_f32_16x16x32_bf16 v[36:39], v[96:99], v[128:131], v[36:39]
    ds_read_b64_tr_b16 v[96:97], v10 offset:9280
    s_waitcnt lgkmcnt(11)
    v_mfma_f32_16x16x32_bf16 v[40:43], v[100:103], v[124:127], v[40:43]
    ds_read_b64_tr_b16 v[98:99], v10 offset:13888
    s_add_u32 s53, s53, 36864
    s_cmp_ge_u32 s53, 147456
    s_cselect_b32 s53, 0, s53
    v_mfma_f32_16x16x32_bf16 v[44:47], v[100:103], v[128:131], v[44:47]
    ds_read_b64_tr_b16 v[100:101], v10 offset:9312
    v_add_u32 v13, s53, v7
    v_mfma_f32_16x16x32_bf16 v[48:51], v[104:107], v[124:127], v[48:51]
    ds_read_b64_tr_b16 v[102:103], v10 offset:13920
    v_add_u32 v14, s53, v8
    v_mfma_f32_16x16x32_bf16 v[52:55], v[104:107], v[128:131], v[52:55]
    ds_read_b64_tr_b16 v[104:105], v10 offset:9344
    v_add_u32 v15, s53, v9
    v_mfma_f32_16x16x32_bf16 v[56:59], v[108:111], v[124:127], v[56:59]
    ds_read_b64_tr_b16 v[106:107], v10 offset:13952
    s_add_u32 s54, s54, 1
    v_mfma_f32_16x16x32_bf16 v[60:63], v[108:111], v[128:131], v[60:63]
    ds_read_b64_tr_b16 v[108:109], v10 offset:9376
    s_cmp_lt_u32 s54, 7
    s_waitcnt lgkmcnt(11)
    v_mfma_f32_16x16x32_bf16 v[64:67], v[112:115], v[124:127], v[64:67]
    ds_read_b64_tr_b16 v[110:111], v10 offset:13984
    v_mfma_f32_16x16x32_bf16 v[68:71], v[112:115], v[128:131], v[68:71]
    ds_read_b64_tr_b16 v[112:113], v10 offset:9408
    v_mfma_f32_16x16x32_bf16 v[72:75], v[116:119], v[124:127], v[72:75]
    ds_read_b64_tr_b16 v[114:115], v10 offset:14016
    v_mfma_f32_16x16x32_bf16 v[76:79], v[116:119], v[128:131], v[76:79]
    ds_read_b64_tr_b16 v[116:117], v10 offset:9440
    v_mfma_f32_16x16x32_bf16 v[80:83], v[120:123], v[124:127], v[80:83]
    ds_read_b64_tr_b16 v[118:119], v10 offset:14048
    v_mfma_f32_16x16x32_bf16 v[84:87], v[120:123], v[128:131], v[84:87]
    ds_read_b64_tr_b16 v[120:121], v10 offset:9472
    ds_read_b64_tr_b16 v[122:123], v10 offset:14080
    s_cbranch_scc1 L_c_z1
    s_waitcnt lgkmcnt(15)
    v_mfma_f32_16x16x32_bf16 v[16:19], v[88:91], v[132:135], v[16:19]
    v_mfma_f32_16x16x32_bf16 v[20:23], v[88:91], v[136:139], v[20:23]
    s_waitcnt lgkmcnt(14)
    v_mfma_f32_16x16x32_bf16 v[24:27], v[92:95], v[132:135], v[24:27]
    v_mfma_f32_16x16x32_bf16 v[28:31], v[92:95], v[136:139], v[28:31]
    s_waitcnt lgkmcnt(12)
    v_mfma_f32_16x16x32_bf16 v[32:35], v[96:99], v[132:135], v[32:35]
    v_mfma_f32_16x16x32_bf16 v[36:39], v[96:99], v[136:139], v[36:39]
    s_waitcnt lgkmcnt(10)
    v_mfma_f32_16x16x32_bf16 v[40:43], v[100:103], v[132:135], v[40:43]
    v_mfma_f32_16x16x32_bf16 v[44:47], v[100:103], v[136:139], v[44:47]
    s_waitcnt lgkmcnt(8)
    v_mfma_f32_16x16x32_bf16 v[48:51], v[104:107], v[132:135], v[48:51]
    v_mfma_f32_16x16x32_bf16 v[52:55], v[104:107], v[136:139], v[52:55]
    s_waitcnt lgkmcnt(6)
    v_mfma_f32_16x16x32_bf16 v[56:59], v[108:111], v[132:135], v[56:59]
    v_mfma_f32_16x16x32_bf16 v[60:63], v[108:111], v[136:139], v[60:63]
    s_waitcnt lgkmcnt(4)
    v_mfma_f32_16x16x32_bf16 v[64:67], v[112:115], v[132:135], v[64:67]
    v_mfma_f32_16x16x32_bf16 v[68:71], v[112:115], v[136:139], v[68:71]
    s_waitcnt lgkmcnt(2)
    v_mfma_f32_16x16x32_bf16 v[72:75], v[116:119], v[132:135], v[72:75]
    v_mfma_f32_16x16x32_bf16 v[76:79], v[116:119], v[136:139], v[76:79]
    s_waitcnt lgkmcnt(0)
    v_mfma_f32_16x16x32_bf16 v[80:83], v[120:123], v[132:135], v[80:83]
    v_mfma_f32_16x16x32_bf16 v[84:87], v[120:123], v[136:139], v[84:87]
    v_mov_b32 v104, 0xc0135761
    v_mov_b32 v105, 0xc0135761
    v_mov_b32 v106, 0xbdd2d3e8
    v_mov_b32 v107, 0xbdd2d3e8
    v_pk_mul_f32 v[88:89], v[16:17], v[16:17]
    v_pk_mul_f32 v[90:91], v[18:19], v[18:19]
    v_pk_mul_f32 v[92:93], v[20:21], v[20:21]
    v_pk_mul_f32 v[94:95], v[22:23], v[22:23]
    v_pk_fma_f32 v[88:89], v[88:89], v[106:107], v[104:105]
    v_pk_fma_f32 v[90:91], v[90:91], v[106:107], v[104:105]
    v_pk_fma_f32 v[92:93], v[92:93], v[106:107], v[104:105]
    v_pk_fma_f32 v[94:95], v[94:95], v[106:107], v[104:105]
    v_pk_mul_f32 v[88:89], v[88:89], v[16:17]
    v_pk_mul_f32 v[90:91], v[90:91], v[18:19]
    v_pk_mul_f32 v[92:93], v[92:93], v[20:21]
    v_pk_mul_f32 v[94:95], v[94:95], v[22:23]
    v_exp_f32 v88, v88
    v_pk_mul_f32 v[96:97], v[24:25], v[24:25]
    v_exp_f32 v89, v89
    v_pk_mul_f32 v[98:99], v[26:27], v[26:27]
    v_exp_f32 v90, v90
    v_pk_mul_f32 v[100:101], v[28:29], v[28:29]
    v_exp_f32 v91, v91
    v_pk_mul_f32 v[102:103], v[30:31], v[30:31]
    v_pk_add_f32 v[88:89], v[88:89], 1.0 op_sel_hi:[1,0]
    v_exp_f32 v92, v92
    v_pk_fma_f32 v[96:97], v[96:97], v[106:107], v[104:105]
    v_exp_f32 v93, v93
    v_pk_fma_f32 v[98:99], v[98:99], v[106:107], v[104:105]
    v_pk_add_f32 v[90:91], v[90:91], 1.0 op_sel_hi:[1,0]
    v_exp_f32 v94, v94
    v_pk_fma_f32 v[100:101], v[100:101], v[106:107], v[104:105]
    v_exp_f32 v95, v95
    v_pk_fma_f32 v[102:103], v[102:103], v[106:107], v[104:105]
    v_pk_add_f32 v[92:93], v[92:93], 1.0 op_sel_hi:[1,0]
    v_pk_mul_f32 v[96:97], v[96:97], v[24:25]
    v_pk_add_f32 v[94:95], v[94:95], 1.0 op_sel_hi:[1,0]
    v_rcp_f32 v88, v88
    v_pk_mul_f32 v[98:99], v[98:99], v[26:27]
    v_rcp_f32 v89, v89
    v_pk_mul_f32 v[100:101], v[100:101], v[28:29]
    v_rcp_f32 v90, v90
    v_pk_mul_f32 v[102:103], v[102:103], v[30:31]
    v_rcp_f32 v91, v91
    v_pk_mul_f32 v[16:17], v[88:89], v[16:17]
    v_rcp_f32 v92, v92
    v_rcp_f32 v93, v93
    v_pk_mul_f32 v[18:19], v[90:91], v[18:19]
    v_rcp_f32 v94, v94
    v_rcp_f32 v95, v95
    v_pk_mul_f32 v[20:21], v[92:93], v[20:21]
    s_nop 0
    v_pk_mul_f32 v[22:23], v[94:95], v[22:23]
    v_exp_f32 v96, v96
    v_cvt_pk_bf16_f32 v140, v16, v17
    v_exp_f32 v97, v97
    v_cvt_pk_bf16_f32 v141, v18, v19
    v_exp_f32 v98, v98
    v_cvt_pk_bf16_f32 v142, v20, v21
    v_exp_f32 v99, v99
    v_cvt_pk_bf16_f32 v143, v22, v23
    v_pk_add_f32 v[96:97], v[96:97], 1.0 op_sel_hi:[1,0]
    v_exp_f32 v100, v100
    v_pk_mul_f32 v[88:89], v[32:33], v[32:33]
    v_exp_f32 v101, v101
    v_pk_mul_f32 v[90:91], v[34:35], v[34:35]
    v_pk_add_f32 v[98:99], v[98:99], 1.0 op_sel_hi:[1,0]
    v_exp_f32 v102, v102
    v_pk_mul_f32 v[92:93], v[36:37], v[36:37]
    v_exp_f32 v103, v103
    v_pk_mul_f32 v[94:95], v[38:39], v[38:39]
    v_pk_add_f32 v[100:101], v[100:101], 1.0 op_sel_hi:[1,0]
    v_pk_fma_f32 v[88:89], v[88:89], v[106:107], v[104:105]
    v_pk_add_f32 v[102:103], v[102:103], 1.0 op_sel_hi:[1,0]
    v_rcp_f32 v96, v96
    v_pk_fma_f32 v[90:91], v[90:91], v[106:107], v[104:105]
    v_rcp_f32 v97, v97
    v_pk_fma_f32 v[92:93], v[92:93], v[106:107], v[104:105]
    v_rcp_f32 v98, v98
    v_pk_fma_f32 v[94:95], v[94:95], v[106:107], v[104:105]
    v_rcp_f32 v99, v99
    v_pk_mul_f32 v[88:89], v[88:89], v[32:33]
    v_pk_mul_f32 v[24:25], v[96:97], v[24:25]
    v_rcp_f32 v100, v100
    v_pk_mul_f32 v[90:91], v[90:91], v[34:35]
    v_rcp_f32 v101, v101
    v_pk_mul_f32 v[92:93], v[92:93], v[36:37]
    v_pk_mul_f32 v[26:27], v[98:99], v[26:27]
    v_rcp_f32 v102, v102
    v_pk_mul_f32 v[94:95], v[94:95], v[38:39]
    v_rcp_f32 v103, v103
    v_pk_mul_f32 v[28:29], v[100:101], v[28:29]
    s_nop 0
    v_pk_mul_f32 v[30:31], v[102:103], v[30:31]
    v_exp_f32 v88, v88
    v_cvt_pk_bf16_f32 v144, v24, v25
    v_exp_f32 v89, v89
    v_cvt_pk_bf16_f32 v145, v26, v27
    v_exp_f32 v90, v90
    v_cvt_pk_bf16_f32 v146, v28, v29
    v_exp_f32 v91, v91
    v_cvt_pk_bf16_f32 v147, v30, v31
    v_pk_add_f32 v[88:89], v[88:89], 1.0 op_sel_hi:[1,0]
    v_exp_f32 v92, v92
    v_pk_mul_f32 v[96:97], v[40:41], v[40:41]
    v_exp_f32 v93, v93
    v_pk_mul_f32 v[98:99], v[42:43], v[42:43]
    v_pk_add_f32 v[90:91], v[90:91], 1.0 op_sel_hi:[1,0]
    v_exp_f32 v94, v94
    v_pk_mul_f32 v[100:101], v[44:45], v[44:45]
    v_exp_f32 v95, v95
    v_pk_mul_f32 v[102:103], v[46:47], v[46:47]
    v_pk_add_f32 v[92:93], v[92:93], 1.0 op_sel_hi:[1,0]
    v_pk_fma_f32 v[96:97], v[96:97], v[106:107], v[104:105]
    v_pk_add_f32 v[94:95], v[94:95], 1.0 op_sel_hi:[1,0]
    v_rcp_f32 v88, v88
    v_pk_fma_f32 v[98:99], v[98:99], v[106:107], v[104:105]
    v_rcp_f32 v89, v89
    v_pk_fma_f32 v[100:101], v[100:101], v[106:107], v[104:105]
    v_rcp_f32 v90, v90
    v_pk_fma_f32 v[102:103], v[102:103], v[106:107], v[104:105]
    v_rcp_f32 v91, v91
    v_pk_mul_f32 v[96:97], v[96:97], v[40:41]
    v_pk_mul_f32 v[32:33], v[88:89], v[32:33]
    v_rcp_f32 v92, v92
    v_pk_mul_f32 v[98:99], v[98:99], v[42:43]
    v_rcp_f32 v93, v93
    v_pk_mul_f32 v[100:101], v[100:101], v[44:45]
    v_pk_mul_f32 v[34:35], v[90:91], v[34:35]
    v_rcp_f32 v94, v94
    v_pk_mul_f32 v[102:103], v[102:103], v[46:47]
    v_rcp_f32 v95, v95
    v_pk_mul_f32 v[36:37], v[92:93], v[36:37]
    s_nop 0
    v_pk_mul_f32 v[38:39], v[94:95], v[38:39]
    v_exp_f32 v96, v96
    v_cvt_pk_bf16_f32 v148, v32, v33
    v_exp_f32 v97, v97
    v_cvt_pk_bf16_f32 v149, v34, v35
    v_exp_f32 v98, v98
    v_cvt_pk_bf16_f32 v150, v36, v37
    v_exp_f32 v99, v99
    v_cvt_pk_bf16_f32 v151, v38, v39
    v_pk_add_f32 v[96:97], v[96:97], 1.0 op_sel_hi:[1,0]
    v_exp_f32 v100, v100
    v_pk_mul_f32 v[88:89], v[48:49], v[48:49]
    v_exp_f32 v101, v101
    v_pk_mul_f32 v[90:91], v[50:51], v[50:51]
    v_pk_add_f32 v[98:99], v[98:99], 1.0 op_sel_hi:[1,0]
    v_exp_f32 v102, v102
    v_pk_mul_f32 v[92:93], v[52:53], v[52:53]
    v_exp_f32 v103, v103
    v_pk_mul_f32 v[94:95], v[54:55], v[54:55]
    v_pk_add_f32 v[100:101], v[100:101], 1.0 op_sel_hi:[1,0]
    v_pk_fma_f32 v[88:89], v[88:89], v[106:107], v[104:105]
    v_pk_add_f32 v[102:103], v[102:103], 1.0 op_sel_hi:[1,0]
    v_rcp_f32 v96, v96
    v_pk_fma_f32 v[90:91], v[90:91], v[106:107], v[104:105]
    v_rcp_f32 v97, v97
    v_pk_fma_f32 v[92:93], v[92:93], v[106:107], v[104:105]
    v_rcp_f32 v98, v98
    v_pk_fma_f32 v[94:95], v[94:95], v[106:107], v[104:105]
    v_rcp_f32 v99, v99
    v_pk_mul_f32 v[88:89], v[88:89], v[48:49]
    v_pk_mul_f32 v[40:41], v[96:97], v[40:41]
    v_rcp_f32 v100, v100
    v_pk_mul_f32 v[90:91], v[90:91], v[50:51]
    v_rcp_f32 v101, v101
    v_pk_mul_f32 v[92:93], v[92:93], v[52:53]
    v_pk_mul_f32 v[42:43], v[98:99], v[42:43]
    v_rcp_f32 v102, v102
    v_pk_mul_f32 v[94:95], v[94:95], v[54:55]
    v_rcp_f32 v103, v103
    v_pk_mul_f32 v[44:45], v[100:101], v[44:45]
    s_nop 0
    v_pk_mul_f32 v[46:47], v[102:103], v[46:47]
    v_exp_f32 v88, v88
    v_cvt_pk_bf16_f32 v152, v40, v41
    v_exp_f32 v89, v89
    v_cvt_pk_bf16_f32 v153, v42, v43
    v_exp_f32 v90, v90
    v_cvt_pk_bf16_f32 v154, v44, v45
    v_exp_f32 v91, v91
    v_cvt_pk_bf16_f32 v155, v46, v47
    v_pk_add_f32 v[88:89], v[88:89], 1.0 op_sel_hi:[1,0]
    v_exp_f32 v92, v92
    v_pk_mul_f32 v[96:97], v[56:57], v[56:57]
    v_exp_f32 v93, v93
    v_pk_mul_f32 v[98:99], v[58:59], v[58:59]
    v_pk_add_f32 v[90:91], v[90:91], 1.0 op_sel_hi:[1,0]
    v_exp_f32 v94, v94
    v_pk_mul_f32 v[100:101], v[60:61], v[60:61]
    v_exp_f32 v95, v95
    v_pk_mul_f32 v[102:103], v[62:63], v[62:63]
    v_pk_add_f32 v[92:93], v[92:93], 1.0 op_sel_hi:[1,0]
    v_pk_fma_f32 v[96:97], v[96:97], v[106:107], v[104:105]
    v_pk_add_f32 v[94:95], v[94:95], 1.0 op_sel_hi:[1,0]
    v_rcp_f32 v88, v88
    v_pk_fma_f32 v[98:99], v[98:99], v[106:107], v[104:105]
    v_rcp_f32 v89, v89
    v_pk_fma_f32 v[100:101], v[100:101], v[106:107], v[104:105]
    v_rcp_f32 v90, v90
    v_pk_fma_f32 v[102:103], v[102:103], v[106:107], v[104:105]
    v_rcp_f32 v91, v91
    v_pk_mul_f32 v[96:97], v[96:97], v[56:57]
    v_pk_mul_f32 v[48:49], v[88:89], v[48:49]
    v_rcp_f32 v92, v92
    v_pk_mul_f32 v[98:99], v[98:99], v[58:59]
    v_rcp_f32 v93, v93
    v_pk_mul_f32 v[100:101], v[100:101], v[60:61]
    v_pk_mul_f32 v[50:51], v[90:91], v[50:51]
    v_rcp_f32 v94, v94
    v_pk_mul_f32 v[102:103], v[102:103], v[62:63]
    v_rcp_f32 v95, v95
    v_pk_mul_f32 v[52:53], v[92:93], v[52:53]
    s_nop 0
    v_pk_mul_f32 v[54:55], v[94:95], v[54:55]
    v_exp_f32 v96, v96
    v_cvt_pk_bf16_f32 v156, v48, v49
    v_exp_f32 v97, v97
    v_cvt_pk_bf16_f32 v157, v50, v51
    v_exp_f32 v98, v98
    v_cvt_pk_bf16_f32 v158, v52, v53
    v_exp_f32 v99, v99
    v_cvt_pk_bf16_f32 v159, v54, v55
    v_pk_add_f32 v[96:97], v[96:97], 1.0 op_sel_hi:[1,0]
    v_exp_f32 v100, v100
    v_pk_mul_f32 v[88:89], v[64:65], v[64:65]
    v_exp_f32 v101, v101
    v_pk_mul_f32 v[90:91], v[66:67], v[66:67]
    v_pk_add_f32 v[98:99], v[98:99], 1.0 op_sel_hi:[1,0]
    v_exp_f32 v102, v102
    v_pk_mul_f32 v[92:93], v[68:69], v[68:69]
    v_exp_f32 v103, v103
    v_pk_mul_f32 v[94:95], v[70:71], v[70:71]
    v_pk_add_f32 v[100:101], v[100:101], 1.0 op_sel_hi:[1,0]
    v_pk_fma_f32 v[88:89], v[88:89], v[106:107], v[104:105]
    v_pk_add_f32 v[102:103], v[102:103], 1.0 op_sel_hi:[1,0]
    v_rcp_f32 v96, v96
    v_pk_fma_f32 v[90:91], v[90:91], v[106:107], v[104:105]
    v_rcp_f32 v97, v97
    v_pk_fma_f32 v[92:93], v[92:93], v[106:107], v[104:105]
    v_rcp_f32 v98, v98
    v_pk_fma_f32 v[94:95], v[94:95], v[106:107], v[104:105]
    v_rcp_f32 v99, v99
    v_pk_mul_f32 v[88:89], v[88:89], v[64:65]
    v_pk_mul_f32 v[56:57], v[96:97], v[56:57]
    v_rcp_f32 v100, v100
    v_pk_mul_f32 v[90:91], v[90:91], v[66:67]
    v_rcp_f32 v101, v101
    v_pk_mul_f32 v[92:93], v[92:93], v[68:69]
    v_pk_mul_f32 v[58:59], v[98:99], v[58:59]
    v_rcp_f32 v102, v102
    v_pk_mul_f32 v[94:95], v[94:95], v[70:71]
    v_rcp_f32 v103, v103
    v_pk_mul_f32 v[60:61], v[100:101], v[60:61]
    s_nop 0
    v_pk_mul_f32 v[62:63], v[102:103], v[62:63]
    v_exp_f32 v88, v88
    v_cvt_pk_bf16_f32 v160, v56, v57
    v_exp_f32 v89, v89
    v_cvt_pk_bf16_f32 v161, v58, v59
    v_exp_f32 v90, v90
    v_cvt_pk_bf16_f32 v162, v60, v61
    v_exp_f32 v91, v91
    v_cvt_pk_bf16_f32 v163, v62, v63
    v_pk_add_f32 v[88:89], v[88:89], 1.0 op_sel_hi:[1,0]
    v_exp_f32 v92, v92
    v_pk_mul_f32 v[96:97], v[72:73], v[72:73]
    v_exp_f32 v93, v93
    v_pk_mul_f32 v[98:99], v[74:75], v[74:75]
    v_pk_add_f32 v[90:91], v[90:91], 1.0 op_sel_hi:[1,0]
    v_exp_f32 v94, v94
    v_pk_mul_f32 v[100:101], v[76:77], v[76:77]
    v_exp_f32 v95, v95
    v_pk_mul_f32 v[102:103], v[78:79], v[78:79]
    v_pk_add_f32 v[92:93], v[92:93], 1.0 op_sel_hi:[1,0]
    v_pk_fma_f32 v[96:97], v[96:97], v[106:107], v[104:105]
    v_pk_add_f32 v[94:95], v[94:95], 1.0 op_sel_hi:[1,0]
    v_rcp_f32 v88, v88
    v_pk_fma_f32 v[98:99], v[98:99], v[106:107], v[104:105]
    v_rcp_f32 v89, v89
    v_pk_fma_f32 v[100:101], v[100:101], v[106:107], v[104:105]
    v_rcp_f32 v90, v90
    v_pk_fma_f32 v[102:103], v[102:103], v[106:107], v[104:105]
    v_rcp_f32 v91, v91
    v_pk_mul_f32 v[96:97], v[96:97], v[72:73]
    v_pk_mul_f32 v[64:65], v[88:89], v[64:65]
    v_rcp_f32 v92, v92
    v_pk_mul_f32 v[98:99], v[98:99], v[74:75]
    v_rcp_f32 v93, v93
    v_pk_mul_f32 v[100:101], v[100:101], v[76:77]
    v_pk_mul_f32 v[66:67], v[90:91], v[66:67]
    v_rcp_f32 v94, v94
    v_pk_mul_f32 v[102:103], v[102:103], v[78:79]
    v_rcp_f32 v95, v95
    v_pk_mul_f32 v[68:69], v[92:93], v[68:69]
    s_nop 0
    v_pk_mul_f32 v[70:71], v[94:95], v[70:71]
    v_exp_f32 v96, v96
    v_cvt_pk_bf16_f32 v164, v64, v65
    v_exp_f32 v97, v97
    v_cvt_pk_bf16_f32 v165, v66, v67
    v_exp_f32 v98, v98
    v_cvt_pk_bf16_f32 v166, v68, v69
    v_exp_f32 v99, v99
    v_cvt_pk_bf16_f32 v167, v70, v71
    v_pk_add_f32 v[96:97], v[96:97], 1.0 op_sel_hi:[1,0]
    v_exp_f32 v100, v100
    v_pk_mul_f32 v[88:89], v[80:81], v[80:81]
    v_exp_f32 v101, v101
    v_pk_mul_f32 v[90:91], v[82:83], v[82:83]
    v_pk_add_f32 v[98:99], v[98:99], 1.0 op_sel_hi:[1,0]
    v_exp_f32 v102, v102
    v_pk_mul_f32 v[92:93], v[84:85], v[84:85]
    v_exp_f32 v103, v103
    v_pk_mul_f32 v[94:95], v[86:87], v[86:87]
    v_pk_add_f32 v[100:101], v[100:101], 1.0 op_sel_hi:[1,0]
    v_pk_fma_f32 v[88:89], v[88:89], v[106:107], v[104:105]
    v_pk_add_f32 v[102:103], v[102:103], 1.0 op_sel_hi:[1,0]
    v_rcp_f32 v96, v96
    v_pk_fma_f32 v[90:91], v[90:91], v[106:107], v[104:105]
    v_rcp_f32 v97, v97
    v_pk_fma_f32 v[92:93], v[92:93], v[106:107], v[104:105]
    v_rcp_f32 v98, v98
    v_pk_fma_f32 v[94:95], v[94:95], v[106:107], v[104:105]
    v_rcp_f32 v99, v99
    v_pk_mul_f32 v[88:89], v[88:89], v[80:81]
    v_pk_mul_f32 v[72:73], v[96:97], v[72:73]
    v_rcp_f32 v100, v100
    v_pk_mul_f32 v[90:91], v[90:91], v[82:83]
    v_rcp_f32 v101, v101
    v_pk_mul_f32 v[92:93], v[92:93], v[84:85]
    v_pk_mul_f32 v[74:75], v[98:99], v[74:75]
    v_rcp_f32 v102, v102
    v_pk_mul_f32 v[94:95], v[94:95], v[86:87]
    v_rcp_f32 v103, v103
    v_pk_mul_f32 v[76:77], v[100:101], v[76:77]
    s_nop 0
    v_pk_mul_f32 v[78:79], v[102:103], v[78:79]
    v_exp_f32 v88, v88
    v_cvt_pk_bf16_f32 v168, v72, v73
    v_exp_f32 v89, v89
    v_cvt_pk_bf16_f32 v169, v74, v75
    v_exp_f32 v90, v90
    v_cvt_pk_bf16_f32 v170, v76, v77
    v_exp_f32 v91, v91
    v_cvt_pk_bf16_f32 v171, v78, v79
    v_pk_add_f32 v[88:89], v[88:89], 1.0 op_sel_hi:[1,0]
    v_exp_f32 v92, v92
    v_exp_f32 v93, v93
    v_pk_add_f32 v[90:91], v[90:91], 1.0 op_sel_hi:[1,0]
    v_exp_f32 v94, v94
    v_exp_f32 v95, v95
    v_pk_add_f32 v[92:93], v[92:93], 1.0 op_sel_hi:[1,0]
    s_nop 0
    v_pk_add_f32 v[94:95], v[94:95], 1.0 op_sel_hi:[1,0]
    v_rcp_f32 v88, v88
    v_rcp_f32 v89, v89
    v_rcp_f32 v90, v90
    v_rcp_f32 v91, v91
    v_pk_mul_f32 v[80:81], v[88:89], v[80:81]
    v_rcp_f32 v92, v92
    v_rcp_f32 v93, v93
    v_pk_mul_f32 v[82:83], v[90:91], v[82:83]
    v_rcp_f32 v94, v94
    v_rcp_f32 v95, v95
    v_pk_mul_f32 v[84:85], v[92:93], v[84:85]
    s_nop 0
    v_pk_mul_f32 v[86:87], v[94:95], v[86:87]
    v_cvt_pk_bf16_f32 v172, v80, v81
    v_cvt_pk_bf16_f32 v173, v82, v83
    v_cvt_pk_bf16_f32 v174, v84, v85
    v_cvt_pk_bf16_f32 v175, v86, v87
    s_lshl_b32 s55, s17, 1
    s_lshr_b32 s56, s21, 1
    s_add_u32 s55, s55, s56
    s_mul_i32 s64, s55, 72
    s_mul_i32 s56, s16, 9
    s_lshr_b32 s56, s56, 1
    s_add_u32 s64, s64, s56
    s_lshl_b32 s64, s64, 12
    s_and_b32 s56, s21, 1
    s_lshl_b32 s56, s56, 11
    s_add_u32 s64, s64, s56
    s_add_u32 s64, s64, 27262976
    s_bitcmp1_b32 s16, 0
    s_cselect_b32 s56, 0, 16384
    s_add_u32 s64, s64, s56
    v_mov_b32 v15, 0x40000000
    v_cmp_gt_u32 vcc, 16, v3
    s_nop 1
    v_cndmask_b32 v212, v15, v213, vcc
    v_lshlrev_b32 v13, 16, v227
    v_lshlrev_b32 v14, 16, v228
    v_mov_b32 v176, v13
    v_mov_b32 v177, v13
    v_mov_b32 v178, v13
    v_mov_b32 v179, v13
    v_mov_b32 v180, v14
    v_mov_b32 v181, v14
    v_mov_b32 v182, v14
    v_mov_b32 v183, v14
    v_and_b32 v14, 15, v3
    v_lshlrev_b32 v14, 7, v14
    v_bfe_u32 v15, v3, 1, 3
    v_lshrrev_b32 v13, 4, v3
    v_xor_b32 v15, v15, v13
    v_lshl_add_u32 v14, v15, 4, v14
    s_lshl_b32 s55, s21, 12
    s_add_u32 s55, s55, 18432
    v_add_u32 v8, s55, v14
    v_xor_b32 v9, 64, v8
    v_add_u32 v10, s53, v1
    v_add_u32 v11, s53, v8
    v_add_u32 v12, s53, v9
    s_barrier
    ds_read_b128 v[124:127], v11 offset:0
    ds_read_b128 v[128:131], v11 offset:2048
    ds_read_b128 v[88:91], v10 offset:0
    ds_read_b128 v[92:95], v10 offset:1024
    ds_read_b128 v[96:99], v10 offset:2048
    ds_read_b128 v[100:103], v10 offset:3072
    ds_read_b128 v[104:107], v10 offset:4096
    ds_read_b128 v[108:111], v10 offset:5120
    ds_read_b128 v[112:115], v10 offset:6144
    ds_read_b128 v[116:119], v10 offset:7168
    ds_read_b128 v[120:123], v10 offset:8192
    ds_read_b128 v[132:135], v12 offset:0
    ds_read_b128 v[136:139], v12 offset:2048
    s_waitcnt lgkmcnt(8)
    v_mfma_f32_16x16x32_bf16 v[16:19], v[88:91], v[124:127], v[176:179]
    v_mfma_f32_16x16x32_bf16 v[20:23], v[88:91], v[128:131], v[180:183]
    ds_read_b128 v[88:91], v10 offset:9216
    v_mfma_f32_16x16x32_bf16 v[24:27], v[92:95], v[124:127], v[176:179]
    v_mfma_f32_16x16x32_bf16 v[28:31], v[92:95], v[128:131], v[180:183]
    ds_read_b128 v[92:95], v10 offset:10240
    v_mfma_f32_16x16x32_bf16 v[32:35], v[96:99], v[124:127], v[176:179]
    v_mfma_f32_16x16x32_bf16 v[36:39], v[96:99], v[128:131], v[180:183]
    ds_read_b128 v[96:99], v10 offset:11264
    s_waitcnt lgkmcnt(8)
    v_mfma_f32_16x16x32_bf16 v[40:43], v[100:103], v[124:127], v[176:179]
    v_mfma_f32_16x16x32_bf16 v[44:47], v[100:103], v[128:131], v[180:183]
    ds_read_b128 v[100:103], v10 offset:12288
    v_mfma_f32_16x16x32_bf16 v[48:51], v[104:107], v[124:127], v[176:179]
    v_mfma_f32_16x16x32_bf16 v[52:55], v[104:107], v[128:131], v[180:183]
    ds_read_b128 v[104:107], v10 offset:13312
    v_mfma_f32_16x16x32_bf16 v[56:59], v[108:111], v[124:127], v[176:179]
    v_mfma_f32_16x16x32_bf16 v[60:63], v[108:111], v[128:131], v[180:183]
    ds_read_b128 v[108:111], v10 offset:14336
    s_waitcnt lgkmcnt(8)
    v_mfma_f32_16x16x32_bf16 v[64:67], v[112:115], v[124:127], v[176:179]
    v_mfma_f32_16x16x32_bf16 v[68:71], v[112:115], v[128:131], v[180:183]
    ds_read_b128 v[112:115], v10 offset:15360
    v_mfma_f32_16x16x32_bf16 v[72:75], v[116:119], v[124:127], v[176:179]
    v_mfma_f32_16x16x32_bf16 v[76:79], v[116:119], v[128:131], v[180:183]
    ds_read_b128 v[116:119], v10 offset:16384
    v_mfma_f32_16x16x32_bf16 v[80:83], v[120:123], v[124:127], v[176:179]
    v_mfma_f32_16x16x32_bf16 v[84:87], v[120:123], v[128:131], v[180:183]
    ds_read_b128 v[120:123], v10 offset:17408
    v_add_u32 v224, 73728, v1
    v_add_u32 v225, 73728, v8
    v_add_u32 v229, 73728, v9
    s_mov_b32 s54, 0
L_c_g2:
    s_barrier
    s_waitcnt lgkmcnt(6)
    v_mfma_f32_16x16x32_bf16 v[16:19], v[88:91], v[132:135], v[16:19]
    ds_read_b128 v[124:127], v225 offset:36864
    v_mfma_f32_16x16x32_bf16 v[20:23], v[88:91], v[136:139], v[20:23]
    ds_read_b128 v[128:131], v225 offset:38912
    ds_read_b128 v[88:91], v224 offset:36864
    v_mfma_f32_16x16x32_bf16 v[24:27], v[92:95], v[132:135], v[24:27]
    v_mfma_f32_16x16x32_bf16 v[28:31], v[92:95], v[136:139], v[28:31]
    ds_read_b128 v[92:95], v224 offset:37888
    v_mfma_f32_16x16x32_bf16 v[32:35], v[96:99], v[132:135], v[32:35]
    v_mfma_f32_16x16x32_bf16 v[36:39], v[96:99], v[136:139], v[36:39]
    ds_read_b128 v[96:99], v224 offset:38912
    s_waitcnt lgkmcnt(8)
    v_mfma_f32_16x16x32_bf16 v[40:43], v[100:103], v[132:135], v[40:43]
    v_mfma_f32_16x16x32_bf16 v[44:47], v[100:103], v[136:139], v[44:47]
    ds_read_b128 v[100:103], v224 offset:39936
    v_mfma_f32_16x16x32_bf16 v[48:51], v[104:107], v[132:135], v[48:51]
    v_mfma_f32_16x16x32_bf16 v[52:55], v[104:107], v[136:139], v[52:55]
    ds_read_b128 v[104:107], v224 offset:40960
    v_mfma_f32_16x16x32_bf16 v[56:59], v[108:111], v[132:135], v[56:59]
    v_mfma_f32_16x16x32_bf16 v[60:63], v[108:111], v[136:139], v[60:63]
    ds_read_b128 v[108:111], v224 offset:41984
    s_waitcnt lgkmcnt(8)
    v_mfma_f32_16x16x32_bf16 v[64:67], v[112:115], v[132:135], v[64:67]
    v_mfma_f32_16x16x32_bf16 v[68:71], v[112:115], v[136:139], v[68:71]
    ds_read_b128 v[112:115], v224 offset:43008
    v_mfma_f32_16x16x32_bf16 v[72:75], v[116:119], v[132:135], v[72:75]
    v_mfma_f32_16x16x32_bf16 v[76:79], v[116:119], v[136:139], v[76:79]
    ds_read_b128 v[116:119], v224 offset:44032
    v_mfma_f32_16x16x32_bf16 v[80:83], v[120:123], v[132:135], v[80:83]
    v_mfma_f32_16x16x32_bf16 v[84:87], v[120:123], v[136:139], v[84:87]
    ds_read_b128 v[120:123], v224 offset:45056
    s_waitcnt lgkmcnt(6)
    v_mfma_f32_16x16x32_bf16 v[16:19], v[88:91], v[124:127], v[16:19]
    ds_read_b128 v[132:135], v229 offset:36864
    v_mfma_f32_16x16x32_bf16 v[20:23], v[88:91], v[128:131], v[20:23]
    ds_read_b128 v[136:139], v229 offset:38912
    ds_read_b128 v[88:91], v224 offset:46080
    v_mfma_f32_16x16x32_bf16 v[24:27], v[92:95], v[124:127], v[24:27]
    v_mfma_f32_16x16x32_bf16 v[28:31], v[92:95], v[128:131], v[28:31]
    ds_read_b128 v[92:95], v224 offset:47104
    v_mfma_f32_16x16x32_bf16 v[32:35], v[96:99], v[124:127], v[32:35]
    v_mfma_f32_16x16x32_bf16 v[36:39], v[96:99], v[128:131], v[36:39]
    ds_read_b128 v[96:99], v224 offset:48128
    s_waitcnt lgkmcnt(8)
    v_mfma_f32_16x16x32_bf16 v[40:43], v[100:103], v[124:127], v[40:43]
    v_mfma_f32_16x16x32_bf16 v[44:47], v[100:103], v[128:131], v[44:47]
    ds_read_b128 v[100:103], v224 offset:49152
    v_mfma_f32_16x16x32_bf16 v[48:51], v[104:107], v[124:127], v[48:51]
    v_mfma_f32_16x16x32_bf16 v[52:55], v[104:107], v[128:131], v[52:55]
    ds_read_b128 v[104:107], v224 offset:50176
    v_mfma_f32_16x16x32_bf16 v[56:59], v[108:111], v[124:127], v[56:59]
    v_mfma_f32_16x16x32_bf16 v[60:63], v[108:111], v[128:131], v[60:63]
    ds_read_b128 v[108:111], v224 offset:51200
    s_waitcnt lgkmcnt(8)
    v_mfma_f32_16x16x32_bf16 v[64:67], v[112:115], v[124:127], v[64:67]
    v_mfma_f32_16x16x32_bf16 v[68:71], v[112:115], v[128:131], v[68:71]
    ds_read_b128 v[112:115], v224 offset:52224
    v_mfma_f32_16x16x32_bf16 v[72:75], v[116:119], v[124:127], v[72:75]
    v_mfma_f32_16x16x32_bf16 v[76:79], v[116:119], v[128:131], v[76:79]
    ds_read_b128 v[116:119], v224 offset:53248
    v_mfma_f32_16x16x32_bf16 v[80:83], v[120:123], v[124:127], v[80:83]
    v_mfma_f32_16x16x32_bf16 v[84:87], v[120:123], v[128:131], v[84:87]
    ds_read_b128 v[120:123], v224 offset:54272
    s_barrier
    s_waitcnt lgkmcnt(6)
    v_mfma_f32_16x16x32_bf16 v[16:19], v[88:91], v[132:135], v[16:19]
    ds_read_b128 v[124:127], v8 offset:0
    v_mfma_f32_16x16x32_bf16 v[20:23], v[88:91], v[136:139], v[20:23]
    ds_read_b128 v[128:131], v8 offset:2048
    ds_read_b128 v[88:91], v1 offset:0
    v_mfma_f32_16x16x32_bf16 v[24:27], v[92:95], v[132:135], v[24:27]
    v_mfma_f32_16x16x32_bf16 v[28:31], v[92:95], v[136:139], v[28:31]
    ds_read_b128 v[92:95], v1 offset:1024
    v_mfma_f32_16x16x32_bf16 v[32:35], v[96:99], v[132:135], v[32:35]
    v_mfma_f32_16x16x32_bf16 v[36:39], v[96:99], v[136:139], v[36:39]
    ds_read_b128 v[96:99], v1 offset:2048
    s_waitcnt lgkmcnt(8)
    v_mfma_f32_16x16x32_bf16 v[40:43], v[100:103], v[132:135], v[40:43]
    v_mfma_f32_16x16x32_bf16 v[44:47], v[100:103], v[136:139], v[44:47]
    ds_read_b128 v[100:103], v1 offset:3072
    v_mfma_f32_16x16x32_bf16 v[48:51], v[104:107], v[132:135], v[48:51]
    v_mfma_f32_16x16x32_bf16 v[52:55], v[104:107], v[136:139], v[52:55]
    ds_read_b128 v[104:107], v1 offset:4096
    v_mfma_f32_16x16x32_bf16 v[56:59], v[108:111], v[132:135], v[56:59]
    v_mfma_f32_16x16x32_bf16 v[60:63], v[108:111], v[136:139], v[60:63]
    ds_read_b128 v[108:111], v1 offset:5120
    s_waitcnt lgkmcnt(8)
    v_mfma_f32_16x16x32_bf16 v[64:67], v[112:115], v[132:135], v[64:67]
    v_mfma_f32_16x16x32_bf16 v[68:71], v[112:115], v[136:139], v[68:71]
    ds_read_b128 v[112:115], v1 offset:6144
    v_mfma_f32_16x16x32_bf16 v[72:75], v[116:119], v[132:135], v[72:75]
    v_mfma_f32_16x16x32_bf16 v[76:79], v[116:119], v[136:139], v[76:79]
    ds_read_b128 v[116:119], v1 offset:7168
    v_mfma_f32_16x16x32_bf16 v[80:83], v[120:123], v[132:135], v[80:83]
    v_mfma_f32_16x16x32_bf16 v[84:87], v[120:123], v[136:139], v[84:87]
    ds_read_b128 v[120:123], v1 offset:8192
    s_waitcnt lgkmcnt(6)
    v_mfma_f32_16x16x32_bf16 v[16:19], v[88:91], v[124:127], v[16:19]
    ds_read_b128 v[132:135], v9 offset:0
    v_mfma_f32_16x16x32_bf16 v[20:23], v[88:91], v[128:131], v[20:23]
    ds_read_b128 v[136:139], v9 offset:2048
    ds_read_b128 v[88:91], v1 offset:9216
    v_mfma_f32_16x16x32_bf16 v[24:27], v[92:95], v[124:127], v[24:27]
    v_mfma_f32_16x16x32_bf16 v[28:31], v[92:95], v[128:131], v[28:31]
    ds_read_b128 v[92:95], v1 offset:10240
    v_mfma_f32_16x16x32_bf16 v[32:35], v[96:99], v[124:127], v[32:35]
    v_mfma_f32_16x16x32_bf16 v[36:39], v[96:99], v[128:131], v[36:39]
    ds_read_b128 v[96:99], v1 offset:11264
    s_waitcnt lgkmcnt(8)
    v_mfma_f32_16x16x32_bf16 v[40:43], v[100:103], v[124:127], v[40:43]
    v_mfma_f32_16x16x32_bf16 v[44:47], v[100:103], v[128:131], v[44:47]
    ds_read_b128 v[100:103], v1 offset:12288
    v_mfma_f32_16x16x32_bf16 v[48:51], v[104:107], v[124:127], v[48:51]
    v_mfma_f32_16x16x32_bf16 v[52:55], v[104:107], v[128:131], v[52:55]
    ds_read_b128 v[104:107], v1 offset:13312
    v_mfma_f32_16x16x32_bf16 v[56:59], v[108:111], v[124:127], v[56:59]
    v_mfma_f32_16x16x32_bf16 v[60:63], v[108:111], v[128:131], v[60:63]
    ds_read_b128 v[108:111], v1 offset:14336
    s_waitcnt lgkmcnt(8)
    v_mfma_f32_16x16x32_bf16 v[64:67], v[112:115], v[124:127], v[64:67]
    v_mfma_f32_16x16x32_bf16 v[68:71], v[112:115], v[128:131], v[68:71]
    ds_read_b128 v[112:115], v1 offset:15360
    v_mfma_f32_16x16x32_bf16 v[72:75], v[116:119], v[124:127], v[72:75]
    v_mfma_f32_16x16x32_bf16 v[76:79], v[116:119], v[128:131], v[76:79]
    ds_read_b128 v[116:119], v1 offset:16384
    v_mfma_f32_16x16x32_bf16 v[80:83], v[120:123], v[124:127], v[80:83]
    v_mfma_f32_16x16x32_bf16 v[84:87], v[120:123], v[128:131], v[84:87]
    ds_read_b128 v[120:123], v1 offset:17408
    s_barrier
    s_waitcnt lgkmcnt(6)
    v_mfma_f32_16x16x32_bf16 v[16:19], v[88:91], v[132:135], v[16:19]
    ds_read_b128 v[124:127], v8 offset:36864
    v_mfma_f32_16x16x32_bf16 v[20:23], v[88:91], v[136:139], v[20:23]
    ds_read_b128 v[128:131], v8 offset:38912
    ds_read_b128 v[88:91], v1 offset:36864
    v_mfma_f32_16x16x32_bf16 v[24:27], v[92:95], v[132:135], v[24:27]
    v_mfma_f32_16x16x32_bf16 v[28:31], v[92:95], v[136:139], v[28:31]
    ds_read_b128 v[92:95], v1 offset:37888
    v_mfma_f32_16x16x32_bf16 v[32:35], v[96:99], v[132:135], v[32:35]
    v_mfma_f32_16x16x32_bf16 v[36:39], v[96:99], v[136:139], v[36:39]
    ds_read_b128 v[96:99], v1 offset:38912
    s_waitcnt lgkmcnt(8)
    v_mfma_f32_16x16x32_bf16 v[40:43], v[100:103], v[132:135], v[40:43]
    v_mfma_f32_16x16x32_bf16 v[44:47], v[100:103], v[136:139], v[44:47]
    ds_read_b128 v[100:103], v1 offset:39936
    v_mfma_f32_16x16x32_bf16 v[48:51], v[104:107], v[132:135], v[48:51]
    v_mfma_f32_16x16x32_bf16 v[52:55], v[104:107], v[136:139], v[52:55]
    ds_read_b128 v[104:107], v1 offset:40960
    v_mfma_f32_16x16x32_bf16 v[56:59], v[108:111], v[132:135], v[56:59]
    v_mfma_f32_16x16x32_bf16 v[60:63], v[108:111], v[136:139], v[60:63]
    ds_read_b128 v[108:111], v1 offset:41984
    s_waitcnt lgkmcnt(8)
    v_mfma_f32_16x16x32_bf16 v[64:67], v[112:115], v[132:135], v[64:67]
    v_mfma_f32_16x16x32_bf16 v[68:71], v[112:115], v[136:139], v[68:71]
    ds_read_b128 v[112:115], v1 offset:43008
    v_mfma_f32_16x16x32_bf16 v[72:75], v[116:119], v[132:135], v[72:75]
    v_mfma_f32_16x16x32_bf16 v[76:79], v[116:119], v[136:139], v[76:79]
    ds_read_b128 v[116:119], v1 offset:44032
    v_mfma_f32_16x16x32_bf16 v[80:83], v[120:123], v[132:135], v[80:83]
    v_mfma_f32_16x16x32_bf16 v[84:87], v[120:123], v[136:139], v[84:87]
    ds_read_b128 v[120:123], v1 offset:45056
    s_waitcnt lgkmcnt(6)
    v_mfma_f32_16x16x32_bf16 v[16:19], v[88:91], v[124:127], v[16:19]
    ds_read_b128 v[132:135], v9 offset:36864
    v_mfma_f32_16x16x32_bf16 v[20:23], v[88:91], v[128:131], v[20:23]
    ds_read_b128 v[136:139], v9 offset:38912
    ds_read_b128 v[88:91], v1 offset:46080
    v_mfma_f32_16x16x32_bf16 v[24:27], v[92:95], v[124:127], v[24:27]
    v_mfma_f32_16x16x32_bf16 v[28:31], v[92:95], v[128:131], v[28:31]
    ds_read_b128 v[92:95], v1 offset:47104
    v_mfma_f32_16x16x32_bf16 v[32:35], v[96:99], v[124:127], v[32:35]
    v_mfma_f32_16x16x32_bf16 v[36:39], v[96:99], v[128:131], v[36:39]
    ds_read_b128 v[96:99], v1 offset:48128
    s_waitcnt lgkmcnt(8)
    v_mfma_f32_16x16x32_bf16 v[40:43], v[100:103], v[124:127], v[40:43]
    v_mfma_f32_16x16x32_bf16 v[44:47], v[100:103], v[128:131], v[44:47]
    ds_read_b128 v[100:103], v1 offset:49152
    v_mfma_f32_16x16x32_bf16 v[48:51], v[104:107], v[124:127], v[48:51]
    v_mfma_f32_16x16x32_bf16 v[52:55], v[104:107], v[128:131], v[52:55]
    ds_read_b128 v[104:107], v1 offset:50176
    v_mfma_f32_16x16x32_bf16 v[56:59], v[108:111], v[124:127], v[56:59]
    v_mfma_f32_16x16x32_bf16 v[60:63], v[108:111], v[128:131], v[60:63]
    ds_read_b128 v[108:111], v1 offset:51200
    s_waitcnt lgkmcnt(8)
    v_mfma_f32_16x16x32_bf16 v[64:67], v[112:115], v[124:127], v[64:67]
    v_mfma_f32_16x16x32_bf16 v[68:71], v[112:115], v[128:131], v[68:71]
    ds_read_b128 v[112:115], v1 offset:52224
    v_mfma_f32_16x16x32_bf16 v[72:75], v[116:119], v[124:127], v[72:75]
    v_mfma_f32_16x16x32_bf16 v[76:79], v[116:119], v[128:131], v[76:79]
    ds_read_b128 v[116:119], v1 offset:53248
    v_mfma_f32_16x16x32_bf16 v[80:83], v[120:123], v[124:127], v[80:83]
    v_mfma_f32_16x16x32_bf16 v[84:87], v[120:123], v[128:131], v[84:87]
    ds_read_b128 v[120:123], v1 offset:54272
    s_barrier
    s_waitcnt lgkmcnt(6)
    v_mfma_f32_16x16x32_bf16 v[16:19], v[88:91], v[132:135], v[16:19]
    ds_read_b128 v[124:127], v225 offset:0
    v_mfma_f32_16x16x32_bf16 v[20:23], v[88:91], v[136:139], v[20:23]
    ds_read_b128 v[128:131], v225 offset:2048
    ds_read_b128 v[88:91], v224 offset:0
    v_mfma_f32_16x16x32_bf16 v[24:27], v[92:95], v[132:135], v[24:27]
    v_mfma_f32_16x16x32_bf16 v[28:31], v[92:95], v[136:139], v[28:31]
    ds_read_b128 v[92:95], v224 offset:1024
    v_mfma_f32_16x16x32_bf16 v[32:35], v[96:99], v[132:135], v[32:35]
    v_mfma_f32_16x16x32_bf16 v[36:39], v[96:99], v[136:139], v[36:39]
    ds_read_b128 v[96:99], v224 offset:2048
    s_waitcnt lgkmcnt(8)
    v_mfma_f32_16x16x32_bf16 v[40:43], v[100:103], v[132:135], v[40:43]
    v_mfma_f32_16x16x32_bf16 v[44:47], v[100:103], v[136:139], v[44:47]
    ds_read_b128 v[100:103], v224 offset:3072
    v_mfma_f32_16x16x32_bf16 v[48:51], v[104:107], v[132:135], v[48:51]
    v_mfma_f32_16x16x32_bf16 v[52:55], v[104:107], v[136:139], v[52:55]
    ds_read_b128 v[104:107], v224 offset:4096
    v_mfma_f32_16x16x32_bf16 v[56:59], v[108:111], v[132:135], v[56:59]
    v_mfma_f32_16x16x32_bf16 v[60:63], v[108:111], v[136:139], v[60:63]
    ds_read_b128 v[108:111], v224 offset:5120
    s_waitcnt lgkmcnt(8)
    v_mfma_f32_16x16x32_bf16 v[64:67], v[112:115], v[132:135], v[64:67]
    v_mfma_f32_16x16x32_bf16 v[68:71], v[112:115], v[136:139], v[68:71]
    ds_read_b128 v[112:115], v224 offset:6144
    v_mfma_f32_16x16x32_bf16 v[72:75], v[116:119], v[132:135], v[72:75]
    v_mfma_f32_16x16x32_bf16 v[76:79], v[116:119], v[136:139], v[76:79]
    ds_read_b128 v[116:119], v224 offset:7168
    v_mfma_f32_16x16x32_bf16 v[80:83], v[120:123], v[132:135], v[80:83]
    v_mfma_f32_16x16x32_bf16 v[84:87], v[120:123], v[136:139], v[84:87]
    ds_read_b128 v[120:123], v224 offset:8192
    s_waitcnt lgkmcnt(6)
    v_mfma_f32_16x16x32_bf16 v[16:19], v[88:91], v[124:127], v[16:19]
    ds_read_b128 v[132:135], v229 offset:0
    v_mfma_f32_16x16x32_bf16 v[20:23], v[88:91], v[128:131], v[20:23]
    ds_read_b128 v[136:139], v229 offset:2048
    ds_read_b128 v[88:91], v224 offset:9216
    v_mfma_f32_16x16x32_bf16 v[24:27], v[92:95], v[124:127], v[24:27]
    v_mfma_f32_16x16x32_bf16 v[28:31], v[92:95], v[128:131], v[28:31]
    ds_read_b128 v[92:95], v224 offset:10240
    v_mfma_f32_16x16x32_bf16 v[32:35], v[96:99], v[124:127], v[32:35]
    v_mfma_f32_16x16x32_bf16 v[36:39], v[96:99], v[128:131], v[36:39]
    ds_read_b128 v[96:99], v224 offset:11264
    s_waitcnt lgkmcnt(8)
    v_mfma_f32_16x16x32_bf16 v[40:43], v[100:103], v[124:127], v[40:43]
    v_mfma_f32_16x16x32_bf16 v[44:47], v[100:103], v[128:131], v[44:47]
    ds_read_b128 v[100:103], v224 offset:12288
    v_mfma_f32_16x16x32_bf16 v[48:51], v[104:107], v[124:127], v[48:51]
    v_mfma_f32_16x16x32_bf16 v[52:55], v[104:107], v[128:131], v[52:55]
    ds_read_b128 v[104:107], v224 offset:13312
    v_mfma_f32_16x16x32_bf16 v[56:59], v[108:111], v[124:127], v[56:59]
    v_mfma_f32_16x16x32_bf16 v[60:63], v[108:111], v[128:131], v[60:63]
    ds_read_b128 v[108:111], v224 offset:14336
    s_waitcnt lgkmcnt(8)
    v_mfma_f32_16x16x32_bf16 v[64:67], v[112:115], v[124:127], v[64:67]
    v_mfma_f32_16x16x32_bf16 v[68:71], v[112:115], v[128:131], v[68:71]
    ds_read_b128 v[112:115], v224 offset:15360
    v_mfma_f32_16x16x32_bf16 v[72:75], v[116:119], v[124:127], v[72:75]
    v_mfma_f32_16x16x32_bf16 v[76:79], v[116:119], v[128:131], v[76:79]
    ds_read_b128 v[116:119], v224 offset:16384
    s_add_u32 s54, s54, 1
    s_cmp_lt_u32 s54, 7
    v_mfma_f32_16x16x32_bf16 v[80:83], v[120:123], v[124:127], v[80:83]
    v_mfma_f32_16x16x32_bf16 v[84:87], v[120:123], v[128:131], v[84:87]
    ds_read_b128 v[120:123], v224 offset:17408
    s_cbranch_scc1 L_c_g2
    s_barrier
    s_waitcnt lgkmcnt(6)
    v_mfma_f32_16x16x32_bf16 v[16:19], v[88:91], v[132:135], v[16:19]
    ds_read_b128 v[124:127], v225 offset:36864
    v_mfma_f32_16x16x32_bf16 v[20:23], v[88:91], v[136:139], v[20:23]
    ds_read_b128 v[128:131], v225 offset:38912
    ds_read_b128 v[88:91], v224 offset:36864
    v_mfma_f32_16x16x32_bf16 v[24:27], v[92:95], v[132:135], v[24:27]
    v_mfma_f32_16x16x32_bf16 v[28:31], v[92:95], v[136:139], v[28:31]
    ds_read_b128 v[92:95], v224 offset:37888
    v_mfma_f32_16x16x32_bf16 v[32:35], v[96:99], v[132:135], v[32:35]
    v_mfma_f32_16x16x32_bf16 v[36:39], v[96:99], v[136:139], v[36:39]
    ds_read_b128 v[96:99], v224 offset:38912
    s_waitcnt lgkmcnt(8)
    v_mfma_f32_16x16x32_bf16 v[40:43], v[100:103], v[132:135], v[40:43]
    v_mfma_f32_16x16x32_bf16 v[44:47], v[100:103], v[136:139], v[44:47]
    ds_read_b128 v[100:103], v224 offset:39936
    v_mfma_f32_16x16x32_bf16 v[48:51], v[104:107], v[132:135], v[48:51]
    v_mfma_f32_16x16x32_bf16 v[52:55], v[104:107], v[136:139], v[52:55]
    ds_read_b128 v[104:107], v224 offset:40960
    v_mfma_f32_16x16x32_bf16 v[56:59], v[108:111], v[132:135], v[56:59]
    v_mfma_f32_16x16x32_bf16 v[60:63], v[108:111], v[136:139], v[60:63]
    ds_read_b128 v[108:111], v224 offset:41984
    s_waitcnt lgkmcnt(8)
    v_mfma_f32_16x16x32_bf16 v[64:67], v[112:115], v[132:135], v[64:67]
    v_mfma_f32_16x16x32_bf16 v[68:71], v[112:115], v[136:139], v[68:71]
    ds_read_b128 v[112:115], v224 offset:43008
    v_mfma_f32_16x16x32_bf16 v[72:75], v[116:119], v[132:135], v[72:75]
    v_mfma_f32_16x16x32_bf16 v[76:79], v[116:119], v[136:139], v[76:79]
    ds_read_b128 v[116:119], v224 offset:44032
    v_mfma_f32_16x16x32_bf16 v[80:83], v[120:123], v[132:135], v[80:83]
    v_mfma_f32_16x16x32_bf16 v[84:87], v[120:123], v[136:139], v[84:87]
    ds_read_b128 v[120:123], v224 offset:45056
    s_waitcnt lgkmcnt(6)
    v_mfma_f32_16x16x32_bf16 v[16:19], v[88:91], v[124:127], v[16:19]
    ds_read_b128 v[132:135], v229 offset:36864
    v_mfma_f32_16x16x32_bf16 v[20:23], v[88:91], v[128:131], v[20:23]
    ds_read_b128 v[136:139], v229 offset:38912
    ds_read_b128 v[88:91], v224 offset:46080
    v_mfma_f32_16x16x32_bf16 v[24:27], v[92:95], v[124:127], v[24:27]
    v_mfma_f32_16x16x32_bf16 v[28:31], v[92:95], v[128:131], v[28:31]
    ds_read_b128 v[92:95], v224 offset:47104
    v_mfma_f32_16x16x32_bf16 v[32:35], v[96:99], v[124:127], v[32:35]
    v_mfma_f32_16x16x32_bf16 v[36:39], v[96:99], v[128:131], v[36:39]
    ds_read_b128 v[96:99], v224 offset:48128
    s_waitcnt lgkmcnt(8)
    v_mfma_f32_16x16x32_bf16 v[40:43], v[100:103], v[124:127], v[40:43]
    v_mfma_f32_16x16x32_bf16 v[44:47], v[100:103], v[128:131], v[44:47]
    ds_read_b128 v[100:103], v224 offset:49152
    v_mfma_f32_16x16x32_bf16 v[48:51], v[104:107], v[124:127], v[48:51]
    v_mfma_f32_16x16x32_bf16 v[52:55], v[104:107], v[128:131], v[52:55]
    ds_read_b128 v[104:107], v224 offset:50176
    v_mfma_f32_16x16x32_bf16 v[56:59], v[108:111], v[124:127], v[56:59]
    v_mfma_f32_16x16x32_bf16 v[60:63], v[108:111], v[128:131], v[60:63]
    ds_read_b128 v[108:111], v224 offset:51200
    s_waitcnt lgkmcnt(8)
    v_mfma_f32_16x16x32_bf16 v[64:67], v[112:115], v[124:127], v[64:67]
    v_mfma_f32_16x16x32_bf16 v[68:71], v[112:115], v[128:131], v[68:71]
    ds_read_b128 v[112:115], v224 offset:52224
    v_mfma_f32_16x16x32_bf16 v[72:75], v[116:119], v[124:127], v[72:75]
    v_mfma_f32_16x16x32_bf16 v[76:79], v[116:119], v[128:131], v[76:79]
    ds_read_b128 v[116:119], v224 offset:53248
    v_mfma_f32_16x16x32_bf16 v[80:83], v[120:123], v[124:127], v[80:83]
    v_mfma_f32_16x16x32_bf16 v[84:87], v[120:123], v[128:131], v[84:87]
    ds_read_b128 v[120:123], v224 offset:54272
    s_mov_b32 s53, 110592
    s_lshl_b32 s55, s17, 1
    s_lshr_b32 s56, s21, 1
    s_add_u32 s55, s55, s56
    s_lshl_b32 s58, s16, 1
    s_and_b32 s56, s21, 1
    s_add_u32 s58, s58, s56
    s_lshl_b32 s58, s58, 2
    s_mul_i32 s56, s55, 256
    s_add_u32 s58, s58, s56
    s_add_u32 s58, s58, 40391168
    s_mul_i32 s62, s55, 72
    s_mul_i32 s56, s16, 9
    s_lshr_b32 s56, s56, 1
    s_add_u32 s62, s62, s56
    s_lshl_b32 s62, s62, 12
    s_and_b32 s56, s21, 1
    s_lshl_b32 s56, s56, 11
    s_add_u32 s62, s62, s56
    s_add_u32 s62, s62, 27262976
    s_add_u32 s53, s53, 36864
    s_cmp_ge_u32 s53, 147456
    s_cselect_b32 s53, 0, s53
    v_add_u32 v10, s53, v1
    v_add_u32 v11, s53, v8
    v_add_u32 v12, s53, v9
    s_barrier
    ds_read_b128 v[176:179], v11 offset:0
    ds_read_b128 v[180:183], v11 offset:2048
    ds_read_b128 v[184:187], v12 offset:0
    ds_read_b128 v[188:191], v12 offset:2048
    s_waitcnt lgkmcnt(12)
    v_mfma_f32_16x16x32_bf16 v[16:19], v[88:91], v[132:135], v[16:19]
    v_mfma_f32_16x16x32_bf16 v[20:23], v[88:91], v[136:139], v[20:23]
    s_waitcnt lgkmcnt(11)
    v_mfma_f32_16x16x32_bf16 v[24:27], v[92:95], v[132:135], v[24:27]
    v_mfma_f32_16x16x32_bf16 v[28:31], v[92:95], v[136:139], v[28:31]
    s_waitcnt lgkmcnt(10)
    v_mfma_f32_16x16x32_bf16 v[32:35], v[96:99], v[132:135], v[32:35]
    v_mfma_f32_16x16x32_bf16 v[36:39], v[96:99], v[136:139], v[36:39]
    s_waitcnt lgkmcnt(9)
    v_mfma_f32_16x16x32_bf16 v[40:43], v[100:103], v[132:135], v[40:43]
    v_mfma_f32_16x16x32_bf16 v[44:47], v[100:103], v[136:139], v[44:47]
    s_waitcnt lgkmcnt(8)
    v_mfma_f32_16x16x32_bf16 v[48:51], v[104:107], v[132:135], v[48:51]
    v_mfma_f32_16x16x32_bf16 v[52:55], v[104:107], v[136:139], v[52:55]
    s_waitcnt lgkmcnt(7)
    v_mfma_f32_16x16x32_bf16 v[56:59], v[108:111], v[132:135], v[56:59]
    v_mfma_f32_16x16x32_bf16 v[60:63], v[108:111], v[136:139], v[60:63]
    s_waitcnt lgkmcnt(6)
    v_mfma_f32_16x16x32_bf16 v[64:67], v[112:115], v[132:135], v[64:67]
    v_mfma_f32_16x16x32_bf16 v[68:71], v[112:115], v[136:139], v[68:71]
    s_waitcnt lgkmcnt(5)
    v_mfma_f32_16x16x32_bf16 v[72:75], v[116:119], v[132:135], v[72:75]
    v_mfma_f32_16x16x32_bf16 v[76:79], v[116:119], v[136:139], v[76:79]
    s_waitcnt lgkmcnt(4)
    v_mfma_f32_16x16x32_bf16 v[80:83], v[120:123], v[132:135], v[80:83]
    v_mfma_f32_16x16x32_bf16 v[84:87], v[120:123], v[136:139], v[84:87]
    v_mov_b32 v13, v10
    s_add_u32 s53, s53, 36864
    s_cmp_ge_u32 s53, 147456
    s_cselect_b32 s53, 0, s53
    v_add_u32 v10, s53, v1
    v_add_u32 v11, s53, v8
    v_add_u32 v12, s53, v9
    s_barrier
    ds_read_b128 v[192:195], v11 offset:0
    ds_read_b128 v[196:199], v11 offset:2048
    ds_read_b128 v[200:203], v12 offset:0
    ds_read_b128 v[204:207], v12 offset:2048
    s_add_u32 s53, s53, 36864
    s_cmp_ge_u32 s53, 147456
    s_cselect_b32 s53, 0, s53
    s_bitcmp1_b32 s16, 0
    s_cbranch_scc1 L_c_odd
    ds_read_b128 v[88:91], v13 offset:8192
    ds_read_b128 v[92:95], v13 offset:17408
    ds_read_b128 v[96:99], v10 offset:8192
    ds_read_b128 v[100:103], v10 offset:17408
    s_waitcnt lgkmcnt(0)
    ds_read_b128 v[104:107], v13 offset:0
    ds_read_b128 v[108:111], v13 offset:9216
    ds_read_b128 v[112:115], v10 offset:0
    ds_read_b128 v[116:119], v10 offset:9216
    v_mfma_f32_16x16x32_bf16 v[80:83], v[88:91], v[176:179], v[80:83]
    v_mfma_f32_16x16x32_bf16 v[84:87], v[88:91], v[180:183], v[84:87]
    v_mfma_f32_16x16x32_bf16 v[80:83], v[92:95], v[184:187], v[80:83]
    v_mfma_f32_16x16x32_bf16 v[84:87], v[92:95], v[188:191], v[84:87]
    v_mfma_f32_16x16x32_bf16 v[80:83], v[96:99], v[192:195], v[80:83]
    v_mfma_f32_16x16x32_bf16 v[84:87], v[96:99], v[196:199], v[84:87]
    v_mfma_f32_16x16x32_bf16 v[80:83], v[100:103], v[200:203], v[80:83]
    v_mfma_f32_16x16x32_bf16 v[84:87], v[100:103], v[204:207], v[84:87]
    s_waitcnt lgkmcnt(0)
    ds_read_b128 v[88:91], v13 offset:1024
    ds_read_b128 v[92:95], v13 offset:10240
    ds_read_b128 v[96:99], v10 offset:1024
    ds_read_b128 v[100:103], v10 offset:10240
    v_mfma_f32_16x16x32_bf16 v[16:19], v[104:107], v[176:179], v[16:19]
    v_mfma_f32_16x16x32_bf16 v[20:23], v[104:107], v[180:183], v[20:23]
    v_lshlrev_b32 v4, 16, v172
    v_and_b32 v5, 0xffff0000, v172
    v_lshlrev_b32 v6, 16, v173
    v_mfma_f32_16x16x32_bf16 v[16:19], v[108:111], v[184:187], v[16:19]
    v_and_b32 v7, 0xffff0000, v173
    v_mul_f32 v4, v4, v80
    v_mul_f32 v5, v5, v81
    v_mfma_f32_16x16x32_bf16 v[20:23], v[108:111], v[188:191], v[20:23]
    v_mul_f32 v6, v6, v82
    v_mul_f32 v7, v7, v83
    v_cvt_pk_bf16_f32 v208, v4, v5
    v_mfma_f32_16x16x32_bf16 v[16:19], v[112:115], v[192:195], v[16:19]
    v_cvt_pk_bf16_f32 v209, v6, v7
    s_add_u32 s56, s62, 16384
    buffer_store_dwordx2 v[208:209], v1, s[40:43], s56 offen offset:0 sc1
    v_lshlrev_b32 v4, 16, v174
    v_mfma_f32_16x16x32_bf16 v[20:23], v[112:115], v[196:199], v[20:23]
    v_and_b32 v5, 0xffff0000, v174
    v_lshlrev_b32 v6, 16, v175
    v_and_b32 v7, 0xffff0000, v175
    v_mfma_f32_16x16x32_bf16 v[16:19], v[116:119], v[200:203], v[16:19]
    v_mul_f32 v4, v4, v84
    v_mul_f32 v5, v5, v85
    v_mul_f32 v6, v6, v86
    v_mfma_f32_16x16x32_bf16 v[20:23], v[116:119], v[204:207], v[20:23]
    v_mul_f32 v7, v7, v87
    v_cvt_pk_bf16_f32 v212, v4, v5
    v_cvt_pk_bf16_f32 v213, v6, v7
    s_add_u32 s56, s62, 17408
    buffer_store_dwordx2 v[212:213], v1, s[40:43], s56 offen offset:0 sc1
    s_waitcnt lgkmcnt(0)
    ds_read_b128 v[104:107], v13 offset:2048
    ds_read_b128 v[108:111], v13 offset:11264
    ds_read_b128 v[112:115], v10 offset:2048
    ds_read_b128 v[116:119], v10 offset:11264
    v_mfma_f32_16x16x32_bf16 v[24:27], v[88:91], v[176:179], v[24:27]
    v_mfma_f32_16x16x32_bf16 v[28:31], v[88:91], v[180:183], v[28:31]
    v_lshlrev_b32 v4, 16, v140
    v_and_b32 v5, 0xffff0000, v140
    v_lshlrev_b32 v6, 16, v141
    v_mfma_f32_16x16x32_bf16 v[24:27], v[92:95], v[184:187], v[24:27]
    v_and_b32 v7, 0xffff0000, v141
    v_mul_f32 v4, v4, v16
    v_mul_f32 v5, v5, v17
    v_mfma_f32_16x16x32_bf16 v[28:31], v[92:95], v[188:191], v[28:31]
    v_mul_f32 v6, v6, v18
    v_mul_f32 v7, v7, v19
    v_cvt_pk_bf16_f32 v208, v4, v5
    v_mfma_f32_16x16x32_bf16 v[24:27], v[96:99], v[192:195], v[24:27]
    v_cvt_pk_bf16_f32 v209, v6, v7
    v_lshlrev_b32 v4, 16, v142
    v_and_b32 v5, 0xffff0000, v142
    v_mfma_f32_16x16x32_bf16 v[28:31], v[96:99], v[196:199], v[28:31]
    v_lshlrev_b32 v6, 16, v143
    v_and_b32 v7, 0xffff0000, v143
    v_mul_f32 v4, v4, v20
    v_mfma_f32_16x16x32_bf16 v[24:27], v[100:103], v[200:203], v[24:27]
    v_mul_f32 v5, v5, v21
    v_mul_f32 v6, v6, v22
    v_mul_f32 v7, v7, v23
    v_mfma_f32_16x16x32_bf16 v[28:31], v[100:103], v[204:207], v[28:31]
    v_cvt_pk_bf16_f32 v212, v4, v5
    v_cvt_pk_bf16_f32 v213, v6, v7
    s_waitcnt lgkmcnt(0)
    ds_read_b128 v[88:91], v13 offset:3072
    ds_read_b128 v[92:95], v13 offset:12288
    ds_read_b128 v[96:99], v10 offset:3072
    ds_read_b128 v[100:103], v10 offset:12288
    v_mfma_f32_16x16x32_bf16 v[32:35], v[104:107], v[176:179], v[32:35]
    v_mfma_f32_16x16x32_bf16 v[36:39], v[104:107], v[180:183], v[36:39]
    v_lshlrev_b32 v4, 16, v144
    v_and_b32 v5, 0xffff0000, v144
    v_lshlrev_b32 v6, 16, v145
    v_mfma_f32_16x16x32_bf16 v[32:35], v[108:111], v[184:187], v[32:35]
    v_and_b32 v7, 0xffff0000, v145
    v_mul_f32 v4, v4, v24
    v_mul_f32 v5, v5, v25
    v_mfma_f32_16x16x32_bf16 v[36:39], v[108:111], v[188:191], v[36:39]
    v_mul_f32 v6, v6, v26
    v_mul_f32 v7, v7, v27
    v_cvt_pk_bf16_f32 v210, v4, v5
    v_mfma_f32_16x16x32_bf16 v[32:35], v[112:115], v[192:195], v[32:35]
    v_cvt_pk_bf16_f32 v211, v6, v7
    s_add_u32 s56, s62, 0
    buffer_store_dwordx4 v[208:211], v1, s[40:43], s56 offen sc1
    v_lshlrev_b32 v4, 16, v146
    v_mfma_f32_16x16x32_bf16 v[36:39], v[112:115], v[196:199], v[36:39]
    v_and_b32 v5, 0xffff0000, v146
    v_lshlrev_b32 v6, 16, v147
    v_and_b32 v7, 0xffff0000, v147
    v_mfma_f32_16x16x32_bf16 v[32:35], v[116:119], v[200:203], v[32:35]
    v_mul_f32 v4, v4, v28
    v_mul_f32 v5, v5, v29
    v_mul_f32 v6, v6, v30
    v_mfma_f32_16x16x32_bf16 v[36:39], v[116:119], v[204:207], v[36:39]
    v_mul_f32 v7, v7, v31
    v_cvt_pk_bf16_f32 v214, v4, v5
    v_cvt_pk_bf16_f32 v215, v6, v7
    s_add_u32 s56, s62, 1024
    buffer_store_dwordx4 v[212:215], v1, s[40:43], s56 offen sc1
    s_waitcnt lgkmcnt(0)
    ds_read_b128 v[104:107], v13 offset:4096
    ds_read_b128 v[108:111], v13 offset:13312
    ds_read_b128 v[112:115], v10 offset:4096
    ds_read_b128 v[116:119], v10 offset:13312
    v_mfma_f32_16x16x32_bf16 v[40:43], v[88:91], v[176:179], v[40:43]
    v_mfma_f32_16x16x32_bf16 v[44:47], v[88:91], v[180:183], v[44:47]
    v_lshlrev_b32 v4, 16, v148
    v_and_b32 v5, 0xffff0000, v148
    v_lshlrev_b32 v6, 16, v149
    v_mfma_f32_16x16x32_bf16 v[40:43], v[92:95], v[184:187], v[40:43]
    v_and_b32 v7, 0xffff0000, v149
    v_mul_f32 v4, v4, v32
    v_mul_f32 v5, v5, v33
    v_mfma_f32_16x16x32_bf16 v[44:47], v[92:95], v[188:191], v[44:47]
    v_mul_f32 v6, v6, v34
    v_mul_f32 v7, v7, v35
    v_cvt_pk_bf16_f32 v216, v4, v5
    v_mfma_f32_16x16x32_bf16 v[40:43], v[96:99], v[192:195], v[40:43]
    v_cvt_pk_bf16_f32 v217, v6, v7
    v_lshlrev_b32 v4, 16, v150
    v_and_b32 v5, 0xffff0000, v150
    v_mfma_f32_16x16x32_bf16 v[44:47], v[96:99], v[196:199], v[44:47]
    v_lshlrev_b32 v6, 16, v151
    v_and_b32 v7, 0xffff0000, v151
    v_mul_f32 v4, v4, v36
    v_mfma_f32_16x16x32_bf16 v[40:43], v[100:103], v[200:203], v[40:43]
    v_mul_f32 v5, v5, v37
    v_mul_f32 v6, v6, v38
    v_mul_f32 v7, v7, v39
    v_mfma_f32_16x16x32_bf16 v[44:47], v[100:103], v[204:207], v[44:47]
    v_cvt_pk_bf16_f32 v220, v4, v5
    v_cvt_pk_bf16_f32 v221, v6, v7
    s_waitcnt lgkmcnt(0)
    ds_read_b128 v[88:91], v13 offset:5120
    ds_read_b128 v[92:95], v13 offset:14336
    ds_read_b128 v[96:99], v10 offset:5120
    ds_read_b128 v[100:103], v10 offset:14336
    v_mfma_f32_16x16x32_bf16 v[48:51], v[104:107], v[176:179], v[48:51]
    v_mfma_f32_16x16x32_bf16 v[52:55], v[104:107], v[180:183], v[52:55]
    v_lshlrev_b32 v4, 16, v152
    v_and_b32 v5, 0xffff0000, v152
    v_lshlrev_b32 v6, 16, v153
    v_mfma_f32_16x16x32_bf16 v[48:51], v[108:111], v[184:187], v[48:51]
    v_and_b32 v7, 0xffff0000, v153
    v_mul_f32 v4, v4, v40
    v_mul_f32 v5, v5, v41
    v_mfma_f32_16x16x32_bf16 v[52:55], v[108:111], v[188:191], v[52:55]
    v_mul_f32 v6, v6, v42
    v_mul_f32 v7, v7, v43
    v_cvt_pk_bf16_f32 v218, v4, v5
    v_mfma_f32_16x16x32_bf16 v[48:51], v[112:115], v[192:195], v[48:51]
    v_cvt_pk_bf16_f32 v219, v6, v7
    s_add_u32 s56, s62, 4096
    buffer_store_dwordx4 v[216:219], v1, s[40:43], s56 offen sc1
    v_lshlrev_b32 v4, 16, v154
    v_mfma_f32_16x16x32_bf16 v[52:55], v[112:115], v[196:199], v[52:55]
    v_and_b32 v5, 0xffff0000, v154
    v_lshlrev_b32 v6, 16, v155
    v_and_b32 v7, 0xffff0000, v155
    v_mfma_f32_16x16x32_bf16 v[48:51], v[116:119], v[200:203], v[48:51]
    v_mul_f32 v4, v4, v44
    v_mul_f32 v5, v5, v45
    v_mul_f32 v6, v6, v46
    v_mfma_f32_16x16x32_bf16 v[52:55], v[116:119], v[204:207], v[52:55]
    v_mul_f32 v7, v7, v47
    v_cvt_pk_bf16_f32 v222, v4, v5
    v_cvt_pk_bf16_f32 v223, v6, v7
    s_add_u32 s56, s62, 5120
    buffer_store_dwordx4 v[220:223], v1, s[40:43], s56 offen sc1
    s_waitcnt lgkmcnt(0)
    ds_read_b128 v[104:107], v13 offset:6144
    ds_read_b128 v[108:111], v13 offset:15360
    ds_read_b128 v[112:115], v10 offset:6144
    ds_read_b128 v[116:119], v10 offset:15360
    v_mfma_f32_16x16x32_bf16 v[56:59], v[88:91], v[176:179], v[56:59]
    v_mfma_f32_16x16x32_bf16 v[60:63], v[88:91], v[180:183], v[60:63]
    v_lshlrev_b32 v4, 16, v156
    v_and_b32 v5, 0xffff0000, v156
    v_lshlrev_b32 v6, 16, v157
    v_mfma_f32_16x16x32_bf16 v[56:59], v[92:95], v[184:187], v[56:59]
    v_and_b32 v7, 0xffff0000, v157
    v_mul_f32 v4, v4, v48
    v_mul_f32 v5, v5, v49
    v_mfma_f32_16x16x32_bf16 v[60:63], v[92:95], v[188:191], v[60:63]
    v_mul_f32 v6, v6, v50
    v_mul_f32 v7, v7, v51
    v_cvt_pk_bf16_f32 v124, v4, v5
    v_mfma_f32_16x16x32_bf16 v[56:59], v[96:99], v[192:195], v[56:59]
    v_cvt_pk_bf16_f32 v125, v6, v7
    v_lshlrev_b32 v4, 16, v158
    v_and_b32 v5, 0xffff0000, v158
    v_mfma_f32_16x16x32_bf16 v[60:63], v[96:99], v[196:199], v[60:63]
    v_lshlrev_b32 v6, 16, v159
    v_and_b32 v7, 0xffff0000, v159
    v_mul_f32 v4, v4, v52
    v_mfma_f32_16x16x32_bf16 v[56:59], v[100:103], v[200:203], v[56:59]
    v_mul_f32 v5, v5, v53
    v_mul_f32 v6, v6, v54
    v_mul_f32 v7, v7, v55
    v_mfma_f32_16x16x32_bf16 v[60:63], v[100:103], v[204:207], v[60:63]
    v_cvt_pk_bf16_f32 v128, v4, v5
    v_cvt_pk_bf16_f32 v129, v6, v7
    s_waitcnt lgkmcnt(0)
    ds_read_b128 v[88:91], v13 offset:7168
    ds_read_b128 v[92:95], v13 offset:16384
    ds_read_b128 v[96:99], v10 offset:7168
    ds_read_b128 v[100:103], v10 offset:16384
    v_mfma_f32_16x16x32_bf16 v[64:67], v[104:107], v[176:179], v[64:67]
    v_mfma_f32_16x16x32_bf16 v[68:71], v[104:107], v[180:183], v[68:71]
    v_lshlrev_b32 v4, 16, v160
    v_and_b32 v5, 0xffff0000, v160
    v_lshlrev_b32 v6, 16, v161
    v_mfma_f32_16x16x32_bf16 v[64:67], v[108:111], v[184:187], v[64:67]
    v_and_b32 v7, 0xffff0000, v161
    v_mul_f32 v4, v4, v56
    v_mul_f32 v5, v5, v57
    v_mfma_f32_16x16x32_bf16 v[68:71], v[108:111], v[188:191], v[68:71]
    v_mul_f32 v6, v6, v58
    v_mul_f32 v7, v7, v59
    v_cvt_pk_bf16_f32 v126, v4, v5
    v_mfma_f32_16x16x32_bf16 v[64:67], v[112:115], v[192:195], v[64:67]
    v_cvt_pk_bf16_f32 v127, v6, v7
    s_add_u32 s56, s62, 8192
    buffer_store_dwordx4 v[124:127], v1, s[40:43], s56 offen sc1
    v_lshlrev_b32 v4, 16, v162
    v_mfma_f32_16x16x32_bf16 v[68:71], v[112:115], v[196:199], v[68:71]
    v_and_b32 v5, 0xffff0000, v162
    v_lshlrev_b32 v6, 16, v163
    v_and_b32 v7, 0xffff0000, v163
    v_mfma_f32_16x16x32_bf16 v[64:67], v[116:119], v[200:203], v[64:67]
    v_mul_f32 v4, v4, v60
    v_mul_f32 v5, v5, v61
    v_mul_f32 v6, v6, v62
    v_mfma_f32_16x16x32_bf16 v[68:71], v[116:119], v[204:207], v[68:71]
    v_mul_f32 v7, v7, v63
    v_cvt_pk_bf16_f32 v130, v4, v5
    v_cvt_pk_bf16_f32 v131, v6, v7
    s_add_u32 s56, s62, 9216
    buffer_store_dwordx4 v[128:131], v1, s[40:43], s56 offen sc1
    s_waitcnt lgkmcnt(0)
    v_mfma_f32_16x16x32_bf16 v[72:75], v[88:91], v[176:179], v[72:75]
    v_mfma_f32_16x16x32_bf16 v[76:79], v[88:91], v[180:183], v[76:79]
    v_lshlrev_b32 v4, 16, v164
    v_and_b32 v5, 0xffff0000, v164
    v_lshlrev_b32 v6, 16, v165
    v_mfma_f32_16x16x32_bf16 v[72:75], v[92:95], v[184:187], v[72:75]
    v_and_b32 v7, 0xffff0000, v165
    v_mul_f32 v4, v4, v64
    v_mul_f32 v5, v5, v65
    v_mfma_f32_16x16x32_bf16 v[76:79], v[92:95], v[188:191], v[76:79]
    v_mul_f32 v6, v6, v66
    v_mul_f32 v7, v7, v67
    v_cvt_pk_bf16_f32 v132, v4, v5
    v_mfma_f32_16x16x32_bf16 v[72:75], v[96:99], v[192:195], v[72:75]
    v_cvt_pk_bf16_f32 v133, v6, v7
    v_lshlrev_b32 v4, 16, v166
    v_and_b32 v5, 0xffff0000, v166
    v_mfma_f32_16x16x32_bf16 v[76:79], v[96:99], v[196:199], v[76:79]
    v_lshlrev_b32 v6, 16, v167
    v_and_b32 v7, 0xffff0000, v167
    v_mul_f32 v4, v4, v68
    v_mfma_f32_16x16x32_bf16 v[72:75], v[100:103], v[200:203], v[72:75]
    v_mul_f32 v5, v5, v69
    v_mul_f32 v6, v6, v70
    v_mul_f32 v7, v7, v71
    v_mfma_f32_16x16x32_bf16 v[76:79], v[100:103], v[204:207], v[76:79]
    v_cvt_pk_bf16_f32 v136, v4, v5
    v_cvt_pk_bf16_f32 v137, v6, v7
    s_barrier
    s_nop 4
    v_lshlrev_b32 v4, 16, v168
    v_and_b32 v5, 0xffff0000, v168
    v_lshlrev_b32 v6, 16, v169
    v_and_b32 v7, 0xffff0000, v169
    v_mul_f32 v4, v4, v72
    v_mul_f32 v5, v5, v73
    v_mul_f32 v6, v6, v74
    v_mul_f32 v7, v7, v75
    v_cvt_pk_bf16_f32 v134, v4, v5
    v_cvt_pk_bf16_f32 v135, v6, v7
    s_add_u32 s56, s62, 12288
    buffer_store_dwordx4 v[132:135], v1, s[40:43], s56 offen sc1
    v_lshlrev_b32 v4, 16, v170
    v_and_b32 v5, 0xffff0000, v170
    v_lshlrev_b32 v6, 16, v171
    v_and_b32 v7, 0xffff0000, v171
    v_mul_f32 v4, v4, v76
    v_mul_f32 v5, v5, v77
    v_mul_f32 v6, v6, v78
    v_mul_f32 v7, v7, v79
    v_cvt_pk_bf16_f32 v138, v4, v5
    v_cvt_pk_bf16_f32 v139, v6, v7
    s_add_u32 s56, s62, 13312
    buffer_store_dwordx4 v[136:139], v1, s[40:43], s56 offen sc1
    s_branch L_c_epi_done
L_c_odd:
    ds_read_b128 v[88:91], v13 offset:0
    ds_read_b128 v[92:95], v13 offset:9216
    ds_read_b128 v[96:99], v10 offset:0
    ds_read_b128 v[100:103], v10 offset:9216
    s_waitcnt lgkmcnt(0)
    ds_read_b128 v[104:107], v13 offset:1024
    ds_read_b128 v[108:111], v13 offset:10240
    ds_read_b128 v[112:115], v10 offset:1024
    ds_read_b128 v[116:119], v10 offset:10240
    v_mfma_f32_16x16x32_bf16 v[16:19], v[88:91], v[176:179], v[16:19]
    v_mfma_f32_16x16x32_bf16 v[20:23], v[88:91], v[180:183], v[20:23]
    v_mfma_f32_16x16x32_bf16 v[16:19], v[92:95], v[184:187], v[16:19]
    v_mfma_f32_16x16x32_bf16 v[20:23], v[92:95], v[188:191], v[20:23]
    v_mfma_f32_16x16x32_bf16 v[16:19], v[96:99], v[192:195], v[16:19]
    v_mfma_f32_16x16x32_bf16 v[20:23], v[96:99], v[196:199], v[20:23]
    v_mfma_f32_16x16x32_bf16 v[16:19], v[100:103], v[200:203], v[16:19]
    v_mfma_f32_16x16x32_bf16 v[20:23], v[100:103], v[204:207], v[20:23]
    s_waitcnt lgkmcnt(0)
    ds_read_b128 v[88:91], v13 offset:2048
    ds_read_b128 v[92:95], v13 offset:11264
    ds_read_b128 v[96:99], v10 offset:2048
    ds_read_b128 v[100:103], v10 offset:11264
    v_mfma_f32_16x16x32_bf16 v[24:27], v[104:107], v[176:179], v[24:27]
    v_mfma_f32_16x16x32_bf16 v[28:31], v[104:107], v[180:183], v[28:31]
    v_lshlrev_b32 v4, 16, v140
    v_and_b32 v5, 0xffff0000, v140
    v_lshlrev_b32 v6, 16, v141
    v_mfma_f32_16x16x32_bf16 v[24:27], v[108:111], v[184:187], v[24:27]
    v_and_b32 v7, 0xffff0000, v141
    v_mul_f32 v4, v4, v16
    v_mul_f32 v5, v5, v17
    v_mfma_f32_16x16x32_bf16 v[28:31], v[108:111], v[188:191], v[28:31]
    v_mul_f32 v6, v6, v18
    v_mul_f32 v7, v7, v19
    v_cvt_pk_bf16_f32 v210, v4, v5
    v_mfma_f32_16x16x32_bf16 v[24:27], v[112:115], v[192:195], v[24:27]
    v_cvt_pk_bf16_f32 v211, v6, v7
    s_add_u32 s56, s62, 0
    buffer_store_dwordx2 v[210:211], v1, s[40:43], s56 offen offset:8 sc1
    v_lshlrev_b32 v4, 16, v142
    v_mfma_f32_16x16x32_bf16 v[28:31], v[112:115], v[196:199], v[28:31]
    v_and_b32 v5, 0xffff0000, v142
    v_lshlrev_b32 v6, 16, v143
    v_and_b32 v7, 0xffff0000, v143
    v_mfma_f32_16x16x32_bf16 v[24:27], v[116:119], v[200:203], v[24:27]
    v_mul_f32 v4, v4, v20
    v_mul_f32 v5, v5, v21
    v_mul_f32 v6, v6, v22
    v_mfma_f32_16x16x32_bf16 v[28:31], v[116:119], v[204:207], v[28:31]
    v_mul_f32 v7, v7, v23
    v_cvt_pk_bf16_f32 v214, v4, v5
    v_cvt_pk_bf16_f32 v215, v6, v7
    s_add_u32 s56, s62, 1024
    buffer_store_dwordx2 v[214:215], v1, s[40:43], s56 offen offset:8 sc1
    s_waitcnt lgkmcnt(0)
    ds_read_b128 v[104:107], v13 offset:3072
    ds_read_b128 v[108:111], v13 offset:12288
    ds_read_b128 v[112:115], v10 offset:3072
    ds_read_b128 v[116:119], v10 offset:12288
    v_mfma_f32_16x16x32_bf16 v[32:35], v[88:91], v[176:179], v[32:35]
    v_mfma_f32_16x16x32_bf16 v[36:39], v[88:91], v[180:183], v[36:39]
    v_lshlrev_b32 v4, 16, v144
    v_and_b32 v5, 0xffff0000, v144
    v_lshlrev_b32 v6, 16, v145
    v_mfma_f32_16x16x32_bf16 v[32:35], v[92:95], v[184:187], v[32:35]
    v_and_b32 v7, 0xffff0000, v145
    v_mul_f32 v4, v4, v24
    v_mul_f32 v5, v5, v25
    v_mfma_f32_16x16x32_bf16 v[36:39], v[92:95], v[188:191], v[36:39]
    v_mul_f32 v6, v6, v26
    v_mul_f32 v7, v7, v27
    v_cvt_pk_bf16_f32 v216, v4, v5
    v_mfma_f32_16x16x32_bf16 v[32:35], v[96:99], v[192:195], v[32:35]
    v_cvt_pk_bf16_f32 v217, v6, v7
    v_lshlrev_b32 v4, 16, v146
    v_and_b32 v5, 0xffff0000, v146
    v_mfma_f32_16x16x32_bf16 v[36:39], v[96:99], v[196:199], v[36:39]
    v_lshlrev_b32 v6, 16, v147
    v_and_b32 v7, 0xffff0000, v147
    v_mul_f32 v4, v4, v28
    v_mfma_f32_16x16x32_bf16 v[32:35], v[100:103], v[200:203], v[32:35]
    v_mul_f32 v5, v5, v29
    v_mul_f32 v6, v6, v30
    v_mul_f32 v7, v7, v31
    v_mfma_f32_16x16x32_bf16 v[36:39], v[100:103], v[204:207], v[36:39]
    v_cvt_pk_bf16_f32 v220, v4, v5
    v_cvt_pk_bf16_f32 v221, v6, v7
    s_waitcnt lgkmcnt(0)
    ds_read_b128 v[88:91], v13 offset:4096
    ds_read_b128 v[92:95], v13 offset:13312
    ds_read_b128 v[96:99], v10 offset:4096
    ds_read_b128 v[100:103], v10 offset:13312
    v_mfma_f32_16x16x32_bf16 v[40:43], v[104:107], v[176:179], v[40:43]
    v_mfma_f32_16x16x32_bf16 v[44:47], v[104:107], v[180:183], v[44:47]
    v_lshlrev_b32 v4, 16, v148
    v_and_b32 v5, 0xffff0000, v148
    v_lshlrev_b32 v6, 16, v149
    v_mfma_f32_16x16x32_bf16 v[40:43], v[108:111], v[184:187], v[40:43]
    v_and_b32 v7, 0xffff0000, v149
    v_mul_f32 v4, v4, v32
    v_mul_f32 v5, v5, v33
    v_mfma_f32_16x16x32_bf16 v[44:47], v[108:111], v[188:191], v[44:47]
    v_mul_f32 v6, v6, v34
    v_mul_f32 v7, v7, v35
    v_cvt_pk_bf16_f32 v218, v4, v5
    v_mfma_f32_16x16x32_bf16 v[40:43], v[112:115], v[192:195], v[40:43]
    v_cvt_pk_bf16_f32 v219, v6, v7
    s_add_u32 s56, s62, 4096
    buffer_store_dwordx4 v[216:219], v1, s[40:43], s56 offen sc1
    v_lshlrev_b32 v4, 16, v150
    v_mfma_f32_16x16x32_bf16 v[44:47], v[112:115], v[196:199], v[44:47]
    v_and_b32 v5, 0xffff0000, v150
    v_lshlrev_b32 v6, 16, v151
    v_and_b32 v7, 0xffff0000, v151
    v_mfma_f32_16x16x32_bf16 v[40:43], v[116:119], v[200:203], v[40:43]
    v_mul_f32 v4, v4, v36
    v_mul_f32 v5, v5, v37
    v_mul_f32 v6, v6, v38
    v_mfma_f32_16x16x32_bf16 v[44:47], v[116:119], v[204:207], v[44:47]
    v_mul_f32 v7, v7, v39
    v_cvt_pk_bf16_f32 v222, v4, v5
    v_cvt_pk_bf16_f32 v223, v6, v7
    s_add_u32 s56, s62, 5120
    buffer_store_dwordx4 v[220:223], v1, s[40:43], s56 offen sc1
    s_waitcnt lgkmcnt(0)
    ds_read_b128 v[104:107], v13 offset:5120
    ds_read_b128 v[108:111], v13 offset:14336
    ds_read_b128 v[112:115], v10 offset:5120
    ds_read_b128 v[116:119], v10 offset:14336
    v_mfma_f32_16x16x32_bf16 v[48:51], v[88:91], v[176:179], v[48:51]
    v_mfma_f32_16x16x32_bf16 v[52:55], v[88:91], v[180:183], v[52:55]
    v_lshlrev_b32 v4, 16, v152
    v_and_b32 v5, 0xffff0000, v152
    v_lshlrev_b32 v6, 16, v153
    v_mfma_f32_16x16x32_bf16 v[48:51], v[92:95], v[184:187], v[48:51]
    v_and_b32 v7, 0xffff0000, v153
    v_mul_f32 v4, v4, v40
    v_mul_f32 v5, v5, v41
    v_mfma_f32_16x16x32_bf16 v[52:55], v[92:95], v[188:191], v[52:55]
    v_mul_f32 v6, v6, v42
    v_mul_f32 v7, v7, v43
    v_cvt_pk_bf16_f32 v124, v4, v5
    v_mfma_f32_16x16x32_bf16 v[48:51], v[96:99], v[192:195], v[48:51]
    v_cvt_pk_bf16_f32 v125, v6, v7
    v_lshlrev_b32 v4, 16, v154
    v_and_b32 v5, 0xffff0000, v154
    v_mfma_f32_16x16x32_bf16 v[52:55], v[96:99], v[196:199], v[52:55]
    v_lshlrev_b32 v6, 16, v155
    v_and_b32 v7, 0xffff0000, v155
    v_mul_f32 v4, v4, v44
    v_mfma_f32_16x16x32_bf16 v[48:51], v[100:103], v[200:203], v[48:51]
    v_mul_f32 v5, v5, v45
    v_mul_f32 v6, v6, v46
    v_mul_f32 v7, v7, v47
    v_mfma_f32_16x16x32_bf16 v[52:55], v[100:103], v[204:207], v[52:55]
    v_cvt_pk_bf16_f32 v128, v4, v5
    v_cvt_pk_bf16_f32 v129, v6, v7
    s_waitcnt lgkmcnt(0)
    ds_read_b128 v[88:91], v13 offset:6144
    ds_read_b128 v[92:95], v13 offset:15360
    ds_read_b128 v[96:99], v10 offset:6144
    ds_read_b128 v[100:103], v10 offset:15360
    v_mfma_f32_16x16x32_bf16 v[56:59], v[104:107], v[176:179], v[56:59]
    v_mfma_f32_16x16x32_bf16 v[60:63], v[104:107], v[180:183], v[60:63]
    v_lshlrev_b32 v4, 16, v156
    v_and_b32 v5, 0xffff0000, v156
    v_lshlrev_b32 v6, 16, v157
    v_mfma_f32_16x16x32_bf16 v[56:59], v[108:111], v[184:187], v[56:59]
    v_and_b32 v7, 0xffff0000, v157
    v_mul_f32 v4, v4, v48
    v_mul_f32 v5, v5, v49
    v_mfma_f32_16x16x32_bf16 v[60:63], v[108:111], v[188:191], v[60:63]
    v_mul_f32 v6, v6, v50
    v_mul_f32 v7, v7, v51
    v_cvt_pk_bf16_f32 v126, v4, v5
    v_mfma_f32_16x16x32_bf16 v[56:59], v[112:115], v[192:195], v[56:59]
    v_cvt_pk_bf16_f32 v127, v6, v7
    s_add_u32 s56, s62, 8192
    buffer_store_dwordx4 v[124:127], v1, s[40:43], s56 offen sc1
    v_lshlrev_b32 v4, 16, v158
    v_mfma_f32_16x16x32_bf16 v[60:63], v[112:115], v[196:199], v[60:63]
    v_and_b32 v5, 0xffff0000, v158
    v_lshlrev_b32 v6, 16, v159
    v_and_b32 v7, 0xffff0000, v159
    v_mfma_f32_16x16x32_bf16 v[56:59], v[116:119], v[200:203], v[56:59]
    v_mul_f32 v4, v4, v52
    v_mul_f32 v5, v5, v53
    v_mul_f32 v6, v6, v54
    v_mfma_f32_16x16x32_bf16 v[60:63], v[116:119], v[204:207], v[60:63]
    v_mul_f32 v7, v7, v55
    v_cvt_pk_bf16_f32 v130, v4, v5
    v_cvt_pk_bf16_f32 v131, v6, v7
    s_add_u32 s56, s62, 9216
    buffer_store_dwordx4 v[128:131], v1, s[40:43], s56 offen sc1
    s_waitcnt lgkmcnt(0)
    ds_read_b128 v[104:107], v13 offset:7168
    ds_read_b128 v[108:111], v13 offset:16384
    ds_read_b128 v[112:115], v10 offset:7168
    ds_read_b128 v[116:119], v10 offset:16384
    v_mfma_f32_16x16x32_bf16 v[64:67], v[88:91], v[176:179], v[64:67]
    v_mfma_f32_16x16x32_bf16 v[68:71], v[88:91], v[180:183], v[68:71]
    v_lshlrev_b32 v4, 16, v160
    v_and_b32 v5, 0xffff0000, v160
    v_lshlrev_b32 v6, 16, v161
    v_mfma_f32_16x16x32_bf16 v[64:67], v[92:95], v[184:187], v[64:67]
    v_and_b32 v7, 0xffff0000, v161
    v_mul_f32 v4, v4, v56
    v_mul_f32 v5, v5, v57
    v_mfma_f32_16x16x32_bf16 v[68:71], v[92:95], v[188:191], v[68:71]
    v_mul_f32 v6, v6, v58
    v_mul_f32 v7, v7, v59
    v_cvt_pk_bf16_f32 v132, v4, v5
    v_mfma_f32_16x16x32_bf16 v[64:67], v[96:99], v[192:195], v[64:67]
    v_cvt_pk_bf16_f32 v133, v6, v7
    v_lshlrev_b32 v4, 16, v162
    v_and_b32 v5, 0xffff0000, v162
    v_mfma_f32_16x16x32_bf16 v[68:71], v[96:99], v[196:199], v[68:71]
    v_lshlrev_b32 v6, 16, v163
    v_and_b32 v7, 0xffff0000, v163
    v_mul_f32 v4, v4, v60
    v_mfma_f32_16x16x32_bf16 v[64:67], v[100:103], v[200:203], v[64:67]
    v_mul_f32 v5, v5, v61
    v_mul_f32 v6, v6, v62
    v_mul_f32 v7, v7, v63
    v_mfma_f32_16x16x32_bf16 v[68:71], v[100:103], v[204:207], v[68:71]
    v_cvt_pk_bf16_f32 v136, v4, v5
    v_cvt_pk_bf16_f32 v137, v6, v7
    s_waitcnt lgkmcnt(0)
    ds_read_b128 v[88:91], v13 offset:8192
    ds_read_b128 v[92:95], v13 offset:17408
    ds_read_b128 v[96:99], v10 offset:8192
    ds_read_b128 v[100:103], v10 offset:17408
    v_mfma_f32_16x16x32_bf16 v[72:75], v[104:107], v[176:179], v[72:75]
    v_mfma_f32_16x16x32_bf16 v[76:79], v[104:107], v[180:183], v[76:79]
    v_lshlrev_b32 v4, 16, v164
    v_and_b32 v5, 0xffff0000, v164
    v_lshlrev_b32 v6, 16, v165
    v_mfma_f32_16x16x32_bf16 v[72:75], v[108:111], v[184:187], v[72:75]
    v_and_b32 v7, 0xffff0000, v165
    v_mul_f32 v4, v4, v64
    v_mul_f32 v5, v5, v65
    v_mfma_f32_16x16x32_bf16 v[76:79], v[108:111], v[188:191], v[76:79]
    v_mul_f32 v6, v6, v66
    v_mul_f32 v7, v7, v67
    v_cvt_pk_bf16_f32 v134, v4, v5
    v_mfma_f32_16x16x32_bf16 v[72:75], v[112:115], v[192:195], v[72:75]
    v_cvt_pk_bf16_f32 v135, v6, v7
    s_add_u32 s56, s62, 12288
    buffer_store_dwordx4 v[132:135], v1, s[40:43], s56 offen sc1
    v_lshlrev_b32 v4, 16, v166
    v_mfma_f32_16x16x32_bf16 v[76:79], v[112:115], v[196:199], v[76:79]
    v_and_b32 v5, 0xffff0000, v166
    v_lshlrev_b32 v6, 16, v167
    v_and_b32 v7, 0xffff0000, v167
    v_mfma_f32_16x16x32_bf16 v[72:75], v[116:119], v[200:203], v[72:75]
    v_mul_f32 v4, v4, v68
    v_mul_f32 v5, v5, v69
    v_mul_f32 v6, v6, v70
    v_mfma_f32_16x16x32_bf16 v[76:79], v[116:119], v[204:207], v[76:79]
    v_mul_f32 v7, v7, v71
    v_cvt_pk_bf16_f32 v138, v4, v5
    v_cvt_pk_bf16_f32 v139, v6, v7
    s_add_u32 s56, s62, 13312
    buffer_store_dwordx4 v[136:139], v1, s[40:43], s56 offen sc1
    s_waitcnt lgkmcnt(0)
    v_mfma_f32_16x16x32_bf16 v[80:83], v[88:91], v[176:179], v[80:83]
    v_mfma_f32_16x16x32_bf16 v[84:87], v[88:91], v[180:183], v[84:87]
    v_lshlrev_b32 v4, 16, v168
    v_and_b32 v5, 0xffff0000, v168
    v_lshlrev_b32 v6, 16, v169
    v_mfma_f32_16x16x32_bf16 v[80:83], v[92:95], v[184:187], v[80:83]
    v_and_b32 v7, 0xffff0000, v169
    v_mul_f32 v4, v4, v72
    v_mul_f32 v5, v5, v73
    v_mfma_f32_16x16x32_bf16 v[84:87], v[92:95], v[188:191], v[84:87]
    v_mul_f32 v6, v6, v74
    v_mul_f32 v7, v7, v75
    v_cvt_pk_bf16_f32 v208, v4, v5
    v_mfma_f32_16x16x32_bf16 v[80:83], v[96:99], v[192:195], v[80:83]
    v_cvt_pk_bf16_f32 v209, v6, v7
    v_lshlrev_b32 v4, 16, v170
    v_and_b32 v5, 0xffff0000, v170
    v_mfma_f32_16x16x32_bf16 v[84:87], v[96:99], v[196:199], v[84:87]
    v_lshlrev_b32 v6, 16, v171
    v_and_b32 v7, 0xffff0000, v171
    v_mul_f32 v4, v4, v76
    v_mfma_f32_16x16x32_bf16 v[80:83], v[100:103], v[200:203], v[80:83]
    v_mul_f32 v5, v5, v77
    v_mul_f32 v6, v6, v78
    v_mul_f32 v7, v7, v79
    v_mfma_f32_16x16x32_bf16 v[84:87], v[100:103], v[204:207], v[84:87]
    v_cvt_pk_bf16_f32 v212, v4, v5
    v_cvt_pk_bf16_f32 v213, v6, v7
    s_barrier
    s_nop 4
    v_lshlrev_b32 v4, 16, v172
    v_and_b32 v5, 0xffff0000, v172
    v_lshlrev_b32 v6, 16, v173
    v_and_b32 v7, 0xffff0000, v173
    v_mul_f32 v4, v4, v80
    v_mul_f32 v5, v5, v81
    v_mul_f32 v6, v6, v82
    v_mul_f32 v7, v7, v83
    v_cvt_pk_bf16_f32 v210, v4, v5
    v_cvt_pk_bf16_f32 v211, v6, v7
    s_add_u32 s56, s62, 16384
    buffer_store_dwordx4 v[208:211], v1, s[40:43], s56 offen sc1
    v_lshlrev_b32 v4, 16, v174
    v_and_b32 v5, 0xffff0000, v174
    v_lshlrev_b32 v6, 16, v175
    v_and_b32 v7, 0xffff0000, v175
    v_mul_f32 v4, v4, v84
    v_mul_f32 v5, v5, v85
    v_mul_f32 v6, v6, v86
    v_mul_f32 v7, v7, v87
    v_cvt_pk_bf16_f32 v214, v4, v5
    v_cvt_pk_bf16_f32 v215, v6, v7
    s_add_u32 s56, s62, 17408
    buffer_store_dwordx4 v[212:215], v1, s[40:43], s56 offen sc1
L_c_epi_done:
    s_mov_b32 s61, s58
    s_mov_b32 s65, 1
    s_lshr_b32 s55, s21, 1
    s_mul_i32 s22, s55, 36864
    s_mul_i32 s63, s55, 5120
    s_add_u32 s63, s63, 147456
    s_lshl_b32 s62, s2, 1
    s_add_u32 s62, s62, s55
    s_barrier
    s_call_b64 s[68:69], L_conv2
L_c_g3:
    s_and_b32 s18, s2, 7
    s_lshr_b32 s19, s2, 3
    s_lshl_b32 s18, s18, 2
    s_and_b32 s55, s19, 3
    s_add_u32 s18, s18, s55
    s_lshr_b32 s19, s19, 2
    s_mul_i32 s15, s19, 9
    s_add_u32 s15, s15, 1
    s_lshr_b32 s15, s15, 1
    s_load_dwordx2 s[24:25], s[0:1], 104
    s_lshl_b32 s55, s21, 12
    s_add_u32 s55, s55, 20480
    v_add_u32 v8, s55, v1
    v_mov_b32 v16, 0
    v_mov_b32 v17, 0
    v_mov_b32 v18, 0
    v_mov_b32 v19, 0
    v_mov_b32 v20, 0
    v_mov_b32 v21, 0
    v_mov_b32 v22, 0
    v_mov_b32 v23, 0
    v_mov_b32 v24, 0
    v_mov_b32 v25, 0
    v_mov_b32 v26, 0
    v_mov_b32 v27, 0
    v_mov_b32 v28, 0
    v_mov_b32 v29, 0
    v_mov_b32 v30, 0
    v_mov_b32 v31, 0
    v_mov_b32 v32, 0
    v_mov_b32 v33, 0
    v_mov_b32 v34, 0
    v_mov_b32 v35, 0
    s_waitcnt lgkmcnt(0)
    s_mov_b32 s44, s24
    s_mov_b32 s45, s25
    s_mov_b32 s46, 0x240000
    s_mov_b32 s47, 0x00020000
    v_add_u32 v10, s53, v1
    v_add_u32 v11, s53, v8
    s_barrier
    ds_read_b128 v[112:115], v11 offset:0
    ds_read_b128 v[128:131], v10 offset:0
    ds_read_b128 v[132:135], v10 offset:1024
    ds_read_b128 v[136:139], v10 offset:2048
    ds_read_b128 v[140:143], v10 offset:3072
    ds_read_b128 v[144:147], v10 offset:4096
    ds_read_b128 v[116:119], v11 offset:1024
    ds_read_b128 v[148:151], v10 offset:5120
    ds_read_b128 v[152:155], v10 offset:6144
    ds_read_b128 v[156:159], v10 offset:7168
    ds_read_b128 v[160:163], v10 offset:8192
    ds_read_b128 v[164:167], v10 offset:9216
    v_bfe_u32 v5, v3, 2, 2
    v_lshlrev_b32 v5, 3, v5
    v_and_b32 v4, 3, v3
    v_add_u32 v5, v5, v4
    s_lshl_b32 s60, s18, 6
    s_lshr_b32 s55, s21, 1
    s_lshl_b32 s55, s55, 5
    s_add_u32 s60, s60, s55
    s_and_b32 s55, s21, 1
    s_lshl_b32 s55, s55, 2
    s_add_u32 s60, s60, s55
    v_lshlrev_b32 v6, 2, v5
    s_lshl_b32 s55, s60, 2
    s_add_u32 s55, s55, 40239104
    buffer_load_dword v7, v6, s[40:43], s55 offen sc1
    ds_read_b128 v[120:123], v11 offset:2048
    s_waitcnt lgkmcnt(7)
    v_mfma_f32_16x16x32_bf16 v[16:19], v[128:131], v[112:115], v[16:19]
    ds_read_b128 v[128:131], v10 offset:10240
    v_mfma_f32_16x16x32_bf16 v[20:23], v[132:135], v[112:115], v[20:23]
    ds_read_b128 v[132:135], v10 offset:11264
    v_mfma_f32_16x16x32_bf16 v[24:27], v[136:139], v[112:115], v[24:27]
    ds_read_b128 v[136:139], v10 offset:12288
    v_mfma_f32_16x16x32_bf16 v[28:31], v[140:143], v[112:115], v[28:31]
    ds_read_b128 v[140:143], v10 offset:13312
    v_mfma_f32_16x16x32_bf16 v[32:35], v[144:147], v[112:115], v[32:35]
    ds_read_b128 v[144:147], v10 offset:14336
    ds_read_b128 v[124:127], v11 offset:3072
    s_waitcnt lgkmcnt(7)
    v_mfma_f32_16x16x32_bf16 v[16:19], v[148:151], v[116:119], v[16:19]
    ds_read_b128 v[148:151], v10 offset:15360
    v_mfma_f32_16x16x32_bf16 v[20:23], v[152:155], v[116:119], v[20:23]
    ds_read_b128 v[152:155], v10 offset:16384
    v_mfma_f32_16x16x32_bf16 v[24:27], v[156:159], v[116:119], v[24:27]
    ds_read_b128 v[156:159], v10 offset:17408
    v_mfma_f32_16x16x32_bf16 v[28:31], v[160:163], v[116:119], v[28:31]
    ds_read_b128 v[160:163], v10 offset:18432
    v_mfma_f32_16x16x32_bf16 v[32:35], v[164:167], v[116:119], v[32:35]
    ds_read_b128 v[164:167], v10 offset:19456
    s_mov_b32 s54, 1
L_c_g3l:
    s_add_u32 s53, s53, 36864
    s_cmp_ge_u32 s53, 147456
    s_cselect_b32 s53, 0, s53
    v_add_u32 v10, s53, v1
    v_add_u32 v11, s53, v8
    s_cmp_lg_u32 s54, 2
    s_cbranch_scc1 L_c_g3_nw
    s_waitcnt vmcnt(0)
L_c_g3_nw:
    s_barrier
    ds_read_b128 v[112:115], v11 offset:0
    s_waitcnt lgkmcnt(7)
    v_mfma_f32_16x16x32_bf16 v[16:19], v[128:131], v[120:123], v[16:19]
    ds_read_b128 v[128:131], v10 offset:0
    v_mfma_f32_16x16x32_bf16 v[20:23], v[132:135], v[120:123], v[20:23]
    ds_read_b128 v[132:135], v10 offset:1024
    v_mfma_f32_16x16x32_bf16 v[24:27], v[136:139], v[120:123], v[24:27]
    ds_read_b128 v[136:139], v10 offset:2048
    v_mfma_f32_16x16x32_bf16 v[28:31], v[140:143], v[120:123], v[28:31]
    ds_read_b128 v[140:143], v10 offset:3072
    v_mfma_f32_16x16x32_bf16 v[32:35], v[144:147], v[120:123], v[32:35]
    ds_read_b128 v[144:147], v10 offset:4096
    ds_read_b128 v[116:119], v11 offset:1024
    s_waitcnt lgkmcnt(7)
    v_mfma_f32_16x16x32_bf16 v[16:19], v[148:151], v[124:127], v[16:19]
    ds_read_b128 v[148:151], v10 offset:5120
    v_mfma_f32_16x16x32_bf16 v[20:23], v[152:155], v[124:127], v[20:23]
    ds_read_b128 v[152:155], v10 offset:6144
    v_mfma_f32_16x16x32_bf16 v[24:27], v[156:159], v[124:127], v[24:27]
    ds_read_b128 v[156:159], v10 offset:7168
    v_mfma_f32_16x16x32_bf16 v[28:31], v[160:163], v[124:127], v[28:31]
    ds_read_b128 v[160:163], v10 offset:8192
    v_mfma_f32_16x16x32_bf16 v[32:35], v[164:167], v[124:127], v[32:35]
    ds_read_b128 v[164:167], v10 offset:9216
    ds_read_b128 v[120:123], v11 offset:2048
    s_waitcnt lgkmcnt(7)
    v_mfma_f32_16x16x32_bf16 v[16:19], v[128:131], v[112:115], v[16:19]
    ds_read_b128 v[128:131], v10 offset:10240
    v_mfma_f32_16x16x32_bf16 v[20:23], v[132:135], v[112:115], v[20:23]
    ds_read_b128 v[132:135], v10 offset:11264
    v_mfma_f32_16x16x32_bf16 v[24:27], v[136:139], v[112:115], v[24:27]
    ds_read_b128 v[136:139], v10 offset:12288
    v_mfma_f32_16x16x32_bf16 v[28:31], v[140:143], v[112:115], v[28:31]
    ds_read_b128 v[140:143], v10 offset:13312
    v_mfma_f32_16x16x32_bf16 v[32:35], v[144:147], v[112:115], v[32:35]
    ds_read_b128 v[144:147], v10 offset:14336
    ds_read_b128 v[124:127], v11 offset:3072
    s_waitcnt lgkmcnt(7)
    v_mfma_f32_16x16x32_bf16 v[16:19], v[148:151], v[116:119], v[16:19]
    ds_read_b128 v[148:151], v10 offset:15360
    v_mfma_f32_16x16x32_bf16 v[20:23], v[152:155], v[116:119], v[20:23]
    ds_read_b128 v[152:155], v10 offset:16384
    v_mfma_f32_16x16x32_bf16 v[24:27], v[156:159], v[116:119], v[24:27]
    ds_read_b128 v[156:159], v10 offset:17408
    v_mfma_f32_16x16x32_bf16 v[28:31], v[160:163], v[116:119], v[28:31]
    ds_read_b128 v[160:163], v10 offset:18432
    v_mfma_f32_16x16x32_bf16 v[32:35], v[164:167], v[116:119], v[32:35]
    ds_read_b128 v[164:167], v10 offset:19456
    s_add_u32 s54, s54, 1
    s_cmp_lt_u32 s54, 18
    s_cbranch_scc1 L_c_g3l
    s_waitcnt lgkmcnt(6)
    v_mfma_f32_16x16x32_bf16 v[16:19], v[128:131], v[120:123], v[16:19]
    v_mfma_f32_16x16x32_bf16 v[20:23], v[132:135], v[120:123], v[20:23]
    v_mfma_f32_16x16x32_bf16 v[24:27], v[136:139], v[120:123], v[24:27]
    v_mfma_f32_16x16x32_bf16 v[28:31], v[140:143], v[120:123], v[28:31]
    v_mfma_f32_16x16x32_bf16 v[32:35], v[144:147], v[120:123], v[32:35]
    s_waitcnt lgkmcnt(0)
    v_mfma_f32_16x16x32_bf16 v[16:19], v[148:151], v[124:127], v[16:19]
    v_mfma_f32_16x16x32_bf16 v[20:23], v[152:155], v[124:127], v[20:23]
    v_mfma_f32_16x16x32_bf16 v[24:27], v[156:159], v[124:127], v[24:27]
    v_mfma_f32_16x16x32_bf16 v[28:31], v[160:163], v[124:127], v[28:31]
    v_mfma_f32_16x16x32_bf16 v[32:35], v[164:167], v[124:127], v[32:35]
    v_lshrrev_b32 v8, 4, v3
    v_lshlrev_b32 v8, 2, v8
    v_bfe_u32 v9, v3, 2, 2
    v_add_u32 v8, v8, v9
    v_lshlrev_b32 v8, 7, v8
    v_and_b32 v9, 3, v3
    v_lshl_add_u32 v8, v9, 4, v8
    s_and_b32 s55, s60, 63
    s_lshl_b32 s55, s55, 1
    s_add_u32 s55, s55, 147456
    v_add_u32 v8, s55, v8
    v_mul_u32_u24 v9, 1152, v5
    v_lshrrev_b32 v10, 4, v3
    v_lshl_add_u32 v9, v10, 3, v9
    s_mul_i32 s55, s60, 1152
    s_lshl_b32 s56, s15, 5
    s_add_u32 s55, s55, s56
    v_sub_f32 v10, 1.0, v7
    v_cvt_pk_bf16_f32 v10, v10, v10
    v_and_b32 v10, 0xffff0000, v10
    s_barrier
    ds_read_b64_tr_b16 v[56:57], v8 offset:0
    ds_read_b64_tr_b16 v[58:59], v8 offset:2048
    ds_read_b64_tr_b16 v[60:61], v8 offset:4096
    ds_read_b64_tr_b16 v[62:63], v8 offset:6144
    ds_read_b64_tr_b16 v[64:65], v8 offset:8192
    s_waitcnt lgkmcnt(0)
    v_lshlrev_b32 v72, 16, v56
    v_and_b32 v73, 0xffff0000, v56
    v_lshlrev_b32 v74, 16, v57
    v_and_b32 v75, 0xffff0000, v57
    v_mul_f32 v72, v72, v7
    v_mul_f32 v73, v73, v7
    v_mul_f32 v74, v74, v7
    v_mul_f32 v75, v75, v7
    v_fma_f32 v72, v16, v10, v72
    v_fma_f32 v73, v17, v10, v73
    v_fma_f32 v74, v18, v10, v74
    v_fma_f32 v75, v19, v10, v75
    v_cvt_pk_bf16_f32 v76, v72, v73
    v_cvt_pk_bf16_f32 v77, v74, v75
    buffer_store_dwordx2 v[76:77], v9, s[44:47], s55 offen offset:0
    v_lshlrev_b32 v80, 16, v58
    v_and_b32 v81, 0xffff0000, v58
    v_lshlrev_b32 v82, 16, v59
    v_and_b32 v83, 0xffff0000, v59
    v_mul_f32 v80, v80, v7
    v_mul_f32 v81, v81, v7
    v_mul_f32 v82, v82, v7
    v_mul_f32 v83, v83, v7
    v_fma_f32 v80, v20, v10, v80
    v_fma_f32 v81, v21, v10, v81
    v_fma_f32 v82, v22, v10, v82
    v_fma_f32 v83, v23, v10, v83
    v_cvt_pk_bf16_f32 v84, v80, v81
    v_cvt_pk_bf16_f32 v85, v82, v83
    buffer_store_dwordx2 v[84:85], v9, s[44:47], s55 offen offset:32
    v_lshlrev_b32 v88, 16, v60
    v_and_b32 v89, 0xffff0000, v60
    v_lshlrev_b32 v90, 16, v61
    v_and_b32 v91, 0xffff0000, v61
    v_mul_f32 v88, v88, v7
    v_mul_f32 v89, v89, v7
    v_mul_f32 v90, v90, v7
    v_mul_f32 v91, v91, v7
    v_fma_f32 v88, v24, v10, v88
    v_fma_f32 v89, v25, v10, v89
    v_fma_f32 v90, v26, v10, v90
    v_fma_f32 v91, v27, v10, v91
    v_cvt_pk_bf16_f32 v92, v88, v89
    v_cvt_pk_bf16_f32 v93, v90, v91
    buffer_store_dwordx2 v[92:93], v9, s[44:47], s55 offen offset:64
    v_lshlrev_b32 v96, 16, v62
    v_and_b32 v97, 0xffff0000, v62
    v_lshlrev_b32 v98, 16, v63
    v_and_b32 v99, 0xffff0000, v63
    v_mul_f32 v96, v96, v7
    v_mul_f32 v97, v97, v7
    v_mul_f32 v98, v98, v7
    v_mul_f32 v99, v99, v7
    v_fma_f32 v96, v28, v10, v96
    v_fma_f32 v97, v29, v10, v97
    v_fma_f32 v98, v30, v10, v98
    v_fma_f32 v99, v31, v10, v99
    v_cvt_pk_bf16_f32 v100, v96, v97
    v_cvt_pk_bf16_f32 v101, v98, v99
    buffer_store_dwordx2 v[100:101], v9, s[44:47], s55 offen offset:96
    s_bitcmp1_b32 s19, 0
    s_cbranch_scc1 L_c_fin
    v_lshlrev_b32 v104, 16, v64
    v_and_b32 v105, 0xffff0000, v64
    v_lshlrev_b32 v106, 16, v65
    v_and_b32 v107, 0xffff0000, v65
    v_mul_f32 v104, v104, v7
    v_mul_f32 v105, v105, v7
    v_mul_f32 v106, v106, v7
    v_mul_f32 v107, v107, v7
    v_fma_f32 v104, v32, v10, v104
    v_fma_f32 v105, v33, v10, v105
    v_fma_f32 v106, v34, v10, v106
    v_fma_f32 v107, v35, v10, v107
    v_cvt_pk_bf16_f32 v108, v104, v105
    v_cvt_pk_bf16_f32 v109, v106, v107
    buffer_store_dwordx2 v[108:109], v9, s[44:47], s55 offen offset:128
L_c_fin:
    s_endpgm
L_L:
    s_setprio 2
    s_add_u32 s55, s23, s27
    s_add_u32 m0, s55, 0
    s_nop 0
    buffer_load_dwordx4 v221, s[32:35], s29 offen lds
    s_add_u32 m0, s55, 1024
    s_nop 0
    buffer_load_dwordx4 v222, s[32:35], s29 offen lds
    s_add_u32 m0, s55, 2048
    s_nop 0
    buffer_load_dwordx4 v223, s[32:35], s29 offen lds
    s_add_u32 m0, s55, 3072
    s_nop 0
    buffer_load_dwordx4 v224, s[32:35], s29 offen lds
    s_add_u32 s29, s29, 128
    s_mov_b32 s56, 238609295
    s_movk_i32 s57, 9216
    v_mov_b32 v11, 0x40000000
    v_add_u32 v14, 0, v2
    v_mul_hi_u32 v15, v14, s56
    v_mul_u32_u24 v13, 18, v15
    v_sub_u32 v13, v14, v13
    v_and_b32 v12, 0x23, v15
    v_bfe_u32 v14, v15, 2, 2
    v_lshl_add_u32 v12, v14, 3, v12
    v_bfe_u32 v14, v15, 4, 1
    v_lshl_add_u32 v12, v14, 2, v12
    v_cmp_gt_u32 vcc, 64, v15
    v_mul_u32_u24 v12, s57, v12
    v_lshl_add_u32 v216, v13, 4, v12
    v_add_u32 v14, 256, v2
    v_mul_hi_u32 v15, v14, s56
    v_mul_u32_u24 v13, 18, v15
    v_sub_u32 v13, v14, v13
    v_and_b32 v12, 0x23, v15
    v_bfe_u32 v14, v15, 2, 2
    v_lshl_add_u32 v12, v14, 3, v12
    v_bfe_u32 v14, v15, 4, 1
    v_lshl_add_u32 v12, v14, 2, v12
    v_cmp_gt_u32 vcc, 64, v15
    v_mul_u32_u24 v12, s57, v12
    v_lshl_add_u32 v217, v13, 4, v12
    v_add_u32 v14, 512, v2
    v_mul_hi_u32 v15, v14, s56
    v_mul_u32_u24 v13, 18, v15
    v_sub_u32 v13, v14, v13
    v_and_b32 v12, 0x23, v15
    v_bfe_u32 v14, v15, 2, 2
    v_lshl_add_u32 v12, v14, 3, v12
    v_bfe_u32 v14, v15, 4, 1
    v_lshl_add_u32 v12, v14, 2, v12
    v_cmp_gt_u32 vcc, 64, v15
    v_mul_u32_u24 v12, s57, v12
    v_lshl_add_u32 v218, v13, 4, v12
    v_add_u32 v14, 768, v2
    v_mul_hi_u32 v15, v14, s56
    v_mul_u32_u24 v13, 18, v15
    v_sub_u32 v13, v14, v13
    v_and_b32 v12, 0x23, v15
    v_bfe_u32 v14, v15, 2, 2
    v_lshl_add_u32 v12, v14, 3, v12
    v_bfe_u32 v14, v15, 4, 1
    v_lshl_add_u32 v12, v14, 2, v12
    v_cmp_gt_u32 vcc, 64, v15
    v_mul_u32_u24 v12, s57, v12
    v_lshl_add_u32 v219, v13, 4, v12
    v_add_u32 v14, 1024, v2
    v_mul_hi_u32 v15, v14, s56
    v_mul_u32_u24 v13, 18, v15
    v_sub_u32 v13, v14, v13
    v_and_b32 v12, 0x23, v15
    v_bfe_u32 v14, v15, 2, 2
    v_lshl_add_u32 v12, v14, 3, v12
    v_bfe_u32 v14, v15, 4, 1
    v_lshl_add_u32 v12, v14, 2, v12
    v_cmp_gt_u32 vcc, 64, v15
    v_mul_u32_u24 v12, s57, v12
    v_lshl_add_u32 v220, v13, 4, v12
    v_cndmask_b32 v220, v11, v220, vcc
    s_add_u32 s55, s23, s26
    s_add_u32 m0, s55, 0
    s_nop 0
    buffer_load_dwordx4 v216, s[36:39], s28 offen lds
    s_add_u32 m0, s55, 4096
    s_nop 0
    buffer_load_dwordx4 v217, s[36:39], s28 offen lds
    s_add_u32 m0, s55, 8192
    s_nop 0
    buffer_load_dwordx4 v218, s[36:39], s28 offen lds
    s_add_u32 m0, s55, 12288
    s_nop 0
    buffer_load_dwordx4 v219, s[36:39], s28 offen lds
    s_add_u32 m0, s23, s24
    s_nop 0
    buffer_load_dwordx4 v220, s[36:39], s28 offen lds
    s_add_u32 s28, s28, 589824
    s_add_u32 s23, s23, 36864
    s_cmp_ge_u32 s23, 147456
    s_cselect_b32 s23, 0, s23
    s_call_b64 s[68:69], L_zbatch
    s_load_dwordx4 s[4:7], s[0:1], 8
    s_load_dwordx4 s[8:11], s[0:1], 24
    s_load_dwordx4 s[12:15], s[0:1], 40
    s_and_b32 s3, s2, 31
    s_lshr_b32 s55, s2, 6
    s_lshl_b32 s55, s55, 5
    s_add_u32 s3, s3, s55
    s_add_u32 s3, s3, 512
    s_bitcmp1_b32 s2, 5
    s_cselect_b32 s3, s3, 0xffff
    s_lshl_b32 s64, s2, 1
    s_add_u32 s64, s64, s21
    s_cmp_eq_u32 s21, 2
    s_cselect_b32 s64, s3, s64
    s_cmp_eq_u32 s21, 3
    s_cselect_b32 s64, 0xffff, s64
    s_mov_b32 s65, 0x40000000
    s_mov_b32 s54, 0
    s_waitcnt lgkmcnt(0)
    buffer_load_dword v229, v230, s[48:51], 0 offen sc1
    s_cmp_ge_u32 s64, 576
    s_cbranch_scc1 L_l_jl
    s_lshl_b32 s55, s64, 8
    s_lshl_b32 s56, s64, 1
    v_lshlrev_b32 v14, 1, v3
    s_mov_b32 s44, s4
    s_mov_b32 s45, s5
    s_mov_b32 s46, 0x24000
    s_mov_b32 s47, 0x00020000
    buffer_load_ushort v200, v14, s[44:47], s55 offen nt
    buffer_load_ushort v204, v14, s[44:47], s55 offen offset:128 nt
    s_mov_b32 s44, s6
    s_mov_b32 s45, s7
    s_mov_b32 s46, 0x24000
    s_mov_b32 s47, 0x00020000
    buffer_load_ushort v201, v14, s[44:47], s55 offen nt
    buffer_load_ushort v205, v14, s[44:47], s55 offen offset:128 nt
    s_mov_b32 s44, s8
    s_mov_b32 s45, s9
    s_mov_b32 s46, 0x24000
    s_mov_b32 s47, 0x00020000
    buffer_load_ushort v202, v14, s[44:47], s55 offen nt
    buffer_load_ushort v206, v14, s[44:47], s55 offen offset:128 nt
    s_mov_b32 s44, s10
    s_mov_b32 s45, s11
    s_mov_b32 s46, 0x24000
    s_mov_b32 s47, 0x00020000
    buffer_load_ushort v203, v14, s[44:47], s55 offen nt
    buffer_load_ushort v207, v14, s[44:47], s55 offen offset:128 nt
    s_mov_b32 s44, s12
    s_mov_b32 s45, s13
    s_mov_b32 s46, 0x480
    s_mov_b32 s47, 0x00020000
    buffer_load_ushort v208, v230, s[44:47], s56 offen
    s_mov_b32 s44, s14
    s_mov_b32 s45, s15
    s_mov_b32 s46, 0x480
    s_mov_b32 s47, 0x00020000
    buffer_load_ushort v209, v230, s[44:47], s56 offen
    s_branch L_l_z2b
L_l_jl:
    s_load_dwordx2 s[4:5], s[0:1], 88
    s_load_dwordx2 s[6:7], s[0:1], 96
    s_add_u32 s61, s2, 0x10000
    s_mov_b32 s62, 0x30000
    s_mov_b32 s63, 0x30000
    s_cmp_lt_u32 s3, 576
    s_cselect_b32 s62, s2, s62
    s_and_b32 s55, s2, 31
    s_add_u32 s55, s55, 256
    s_lshr_b32 s56, s2, 5
    s_cmp_eq_u32 s56, 5
    s_cselect_b32 s62, s55, s62
    s_add_u32 s55, s55, 0x10000
    s_cmp_eq_u32 s56, 7
    s_cselect_b32 s62, s55, s62
    s_add_u32 s55, s2, 0x20020
    s_and_b32 s57, s56, 5
    s_cmp_eq_u32 s57, 0
    s_cselect_b32 s62, s55, s62
    s_add_u32 s55, s2, 0x20000
    s_cmp_eq_u32 s21, 2
    s_cselect_b32 s61, s2, s61
    s_cselect_b32 s62, s55, s62
    s_waitcnt lgkmcnt(0)
    s_lshr_b32 s66, s61, 16
    s_and_b32 s67, s61, 0xffff
    s_call_b64 s[68:69], L_job_load
L_l_z2b:
    s_waitcnt vmcnt(18)
    s_barrier
    s_call_b64 s[68:69], L_zbatch
    s_waitcnt vmcnt(18)
    s_barrier
    s_call_b64 s[68:69], L_zbatch
    s_mov_b32 s54, 2
L_l_z2:
    s_waitcnt vmcnt(9)
    s_barrier
    s_cmp_eq_u32 s54, 7
    s_cselect_b32 s28, s30, s28
    s_cselect_b32 s29, s31, s29
    s_call_b64 s[68:69], L_zbatch
    s_add_u32 s54, s54, 1
    s_cmp_lt_u32 s54, 9
    s_cbranch_scc1 L_l_z2
    s_setprio 0
    s_cmp_ge_u32 s64, 576
    s_cbranch_scc1 L_l_misc
    s_mul_i32 s22, s21, 1792
    s_add_u32 s22, s22, 147456
    s_mov_b32 s62, s60
    v_and_b32 v12, 15, v3
    v_lshrrev_b32 v13, 4, v3
    v_subrev_u32 v14, 8, v12
    v_med3_i32 v14, v14, 1, 4
    v_lshlrev_b32 v14, 9, v14
    v_cmp_eq_u32 vcc, 9, v12
    v_add_u32 v30, 4, v14
    s_nop 0
    v_cndmask_b32 v14, v14, v30, vcc
    v_cmp_gt_u32 vcc, 8, v12
    s_nop 1
    v_cndmask_b32 v30, v14, v12, vcc
    v_cvt_f32_u32 v30, v30
    v_cvt_f32_u32 v31, v12
    v_mul_f32 v31, 0x41000000, v31
    v_lshl_add_u32 v32, v3, 2, s22
    s_mov_b32 s56, 0x3e22f983
    s_mov_b32 s57, 0x31dc9c88
    v_mov_b32 v52, 0
    v_mov_b32 v53, 0
    v_mov_b32 v54, 0
    v_mov_b32 v55, 0
    v_mov_b32 v56, 0
    v_mov_b32 v57, 0
    v_mov_b32 v58, 0
    v_mov_b32 v59, 0
    v_mov_b32 v60, 0
    v_mov_b32 v61, 0
    v_mov_b32 v62, 0
    v_mov_b32 v63, 0
    v_mov_b32 v64, 0
    v_mov_b32 v65, 0
    v_mov_b32 v66, 0
    v_mov_b32 v67, 0
    v_lshlrev_b32 v40, 16, v200
    v_lshlrev_b32 v41, 16, v201
    v_lshlrev_b32 v42, 16, v202
    v_lshlrev_b32 v43, 16, v203
    v_lshlrev_b32 v44, 16, v204
    v_lshlrev_b32 v45, 16, v205
    v_lshlrev_b32 v46, 16, v206
    v_lshlrev_b32 v47, 16, v207
    v_lshlrev_b32 v48, 16, v208
    v_lshlrev_b32 v49, 16, v209
    v_max3_f32 v34, |v42|, |v43|, |v46|
    v_max_f32 v34, v34, |v47|
    v_mul_f32 v48, 0x3fb8aa3b, v48
    v_exp_f32 v48, v48
    v_max_f32_dpp v34, v34, v34 quad_perm:[1,0,3,2] row_mask:0xf bank_mask:0xf
    s_nop 1
    v_max_f32_dpp v34, v34, v34 quad_perm:[2,3,0,1] row_mask:0xf bank_mask:0xf
    s_nop 1
    v_max_f32_dpp v34, v34, v34 row_half_mirror row_mask:0xf bank_mask:0xf
    s_nop 1
    v_max_f32_dpp v34, v34, v34 row_mirror row_mask:0xf bank_mask:0xf
    s_nop 1
    v_mov_b32 v14, v34
    s_nop 1
    v_permlane32_swap_b32 v34, v14
    s_nop 1
    v_max_f32 v34, v34, v14
    v_mov_b32 v14, v34
    s_nop 1
    v_permlane16_swap_b32 v34, v14
    s_nop 1
    v_max_f32 v34, v34, v14
    v_cvt_pk_bf16_f32 v48, v48, v48
    v_and_b32 v48, 0xffff0000, v48
    v_lshrrev_b32 v34, 23, v34
    v_max_u32 v34, 2, v34
    v_min_u32 v34, 252, v34
    v_sub_u32 v35, 254, v34
    v_lshlrev_b32 v35, 23, v35
    v_lshlrev_b32 v34, 23, v34
    v_mul_f32 v34, v34, v48
    v_add_f32 v34, v34, v34
    v_cmp_eq_u32 vcc, 0, v3
    s_nop 1
    v_cndmask_b32 v49, 0, v49, vcc
    s_mov_b32 s60, 0
L_kg_b:
    v_mul_f32 v40, 0x3fb8aa3b, v40
    v_exp_f32 v40, v40
    v_mul_f32 v41, v41, v48
    v_cvt_pk_bf16_f32 v40, v40, v40
    v_and_b32 v40, 0xffff0000, v40
    v_mul_f32 v40, v40, v48
    v_mul_f32 v40, 0xbfb8aa3b, v40
    v_mul_f32 v116, s56, v41
    v_and_b32 v116, 0xffffff00, v116
    v_fma_f32 v117, v41, s56, -v116
    v_fma_f32 v117, v41, s57, v117
    v_mul_f32 v118, 0x43000000, v116
    v_mul_f32 v120, 0x43000000, v40
    v_fract_f32 v118, v118
    v_exp_f32 v120, v120
    v_fmac_f32 v118, 0x43000000, v117
    v_fract_f32 v118, v118
    v_sin_f32 v119, v118
    v_cos_f32 v118, v118
    v_mul_f32 v42, v42, v35
    v_mul_f32 v43, v43, v35
    v_mul_f32 v119, v119, v120
    v_mul_f32 v118, v118, v120
    ds_write_b32 v32, v116 offset:0
    ds_write_b32 v32, v117 offset:256
    ds_write_b32 v32, v40 offset:512
    ds_write_b32 v32, v42 offset:768
    ds_write_b32 v32, v43 offset:1024
    ds_write_b32 v32, v118 offset:1280
    ds_write_b32 v32, v119 offset:1536
    v_lshl_add_u32 v33, v13, 4, s22
    s_mov_b32 s61, 0
    s_waitcnt lgkmcnt(0)
L_kg_k:
    ds_read_b128 v[68:71], v33 offset:0
    ds_read_b128 v[72:75], v33 offset:64
    ds_read_b128 v[76:79], v33 offset:256
    ds_read_b128 v[80:83], v33 offset:320
    ds_read_b128 v[84:87], v33 offset:512
    ds_read_b128 v[88:91], v33 offset:576
    ds_read_b128 v[92:95], v33 offset:768
    ds_read_b128 v[96:99], v33 offset:832
    ds_read_b128 v[100:103], v33 offset:1024
    ds_read_b128 v[104:107], v33 offset:1088
    ds_read_b128 v[108:111], v33 offset:1280
    ds_read_b128 v[112:115], v33 offset:1344
    ds_read_b128 v[116:119], v33 offset:1536
    ds_read_b128 v[120:123], v33 offset:1600
    v_add_u32 v33, 128, v33
    s_waitcnt lgkmcnt(8)
    v_pk_mul_f32 v[132:133], v[84:85], v[30:31] op_sel_hi:[1,0]
    v_pk_mul_f32 v[134:135], v[86:87], v[30:31] op_sel_hi:[1,0]
    v_pk_mul_f32 v[136:137], v[88:89], v[30:31] op_sel_hi:[1,0]
    v_pk_mul_f32 v[138:139], v[90:91], v[30:31] op_sel_hi:[1,0]
    v_pk_mul_f32 v[124:125], v[68:69], v[30:31] op_sel_hi:[1,0]
    v_pk_mul_f32 v[126:127], v[70:71], v[30:31] op_sel_hi:[1,0]
    v_pk_mul_f32 v[128:129], v[72:73], v[30:31] op_sel_hi:[1,0]
    v_pk_mul_f32 v[130:131], v[74:75], v[30:31] op_sel_hi:[1,0]
    v_exp_f32 v132, v132
    v_fract_f32 v124, v124
    v_exp_f32 v133, v133
    v_fract_f32 v125, v125
    v_exp_f32 v134, v134
    v_fract_f32 v126, v126
    v_exp_f32 v135, v135
    v_fract_f32 v127, v127
    v_exp_f32 v136, v136
    v_fract_f32 v128, v128
    v_exp_f32 v137, v137
    v_fract_f32 v129, v129
    v_exp_f32 v138, v138
    v_fract_f32 v130, v130
    v_exp_f32 v139, v139
    v_fract_f32 v131, v131
    v_pk_fma_f32 v[124:125], v[76:77], v[30:31], v[124:125] op_sel_hi:[1,0,1]
    v_pk_fma_f32 v[126:127], v[78:79], v[30:31], v[126:127] op_sel_hi:[1,0,1]
    v_pk_fma_f32 v[128:129], v[80:81], v[30:31], v[128:129] op_sel_hi:[1,0,1]
    v_pk_fma_f32 v[130:131], v[82:83], v[30:31], v[130:131] op_sel_hi:[1,0,1]
    v_fract_f32 v124, v124
    v_fract_f32 v125, v125
    v_fract_f32 v126, v126
    v_fract_f32 v127, v127
    v_fract_f32 v128, v128
    v_fract_f32 v129, v129
    v_fract_f32 v130, v130
    v_fract_f32 v131, v131
    v_cos_f32 v140, v124
    v_cos_f32 v141, v125
    v_cos_f32 v142, v126
    v_cos_f32 v143, v127
    v_cos_f32 v144, v128
    v_cos_f32 v145, v129
    v_cos_f32 v146, v130
    v_cos_f32 v147, v131
    v_sin_f32 v124, v124
    v_sin_f32 v125, v125
    v_pk_mul_f32 v[140:141], v[140:141], v[132:133]
    v_sin_f32 v126, v126
    v_sin_f32 v127, v127
    v_pk_mul_f32 v[142:143], v[142:143], v[134:135]
    v_sin_f32 v128, v128
    v_sin_f32 v129, v129
    v_pk_mul_f32 v[144:145], v[144:145], v[136:137]
    v_sin_f32 v130, v130
    v_sin_f32 v131, v131
    v_pk_mul_f32 v[146:147], v[146:147], v[138:139]
    v_pk_mul_f32 v[124:125], v[124:125], v[132:133]
    v_pk_mul_f32 v[126:127], v[126:127], v[134:135]
    v_pk_mul_f32 v[128:129], v[128:129], v[136:137]
    v_pk_mul_f32 v[130:131], v[130:131], v[138:139]
    v_cvt_pk_f16_f32 v20, v140, v124
    v_cvt_pk_f16_f32 v21, v141, v125
    v_cvt_pk_f16_f32 v22, v142, v126
    v_cvt_pk_f16_f32 v23, v143, v127
    v_cvt_pk_f16_f32 v24, v144, v128
    v_cvt_pk_f16_f32 v25, v145, v129
    v_cvt_pk_f16_f32 v26, v146, v130
    v_cvt_pk_f16_f32 v27, v147, v131
    s_waitcnt lgkmcnt(0)
    v_pk_mul_f32 v[132:133], v[84:85], v[30:31] op_sel:[0,1] op_sel_hi:[1,1]
    v_pk_mul_f32 v[134:135], v[86:87], v[30:31] op_sel:[0,1] op_sel_hi:[1,1]
    v_pk_mul_f32 v[136:137], v[88:89], v[30:31] op_sel:[0,1] op_sel_hi:[1,1]
    v_pk_mul_f32 v[138:139], v[90:91], v[30:31] op_sel:[0,1] op_sel_hi:[1,1]
    v_pk_mul_f32 v[124:125], v[68:69], v[30:31] op_sel:[0,1] op_sel_hi:[1,1]
    v_pk_mul_f32 v[126:127], v[70:71], v[30:31] op_sel:[0,1] op_sel_hi:[1,1]
    v_pk_mul_f32 v[128:129], v[72:73], v[30:31] op_sel:[0,1] op_sel_hi:[1,1]
    v_pk_mul_f32 v[130:131], v[74:75], v[30:31] op_sel:[0,1] op_sel_hi:[1,1]
    v_exp_f32 v132, v132
    v_fract_f32 v124, v124
    v_exp_f32 v133, v133
    v_fract_f32 v125, v125
    v_exp_f32 v134, v134
    v_fract_f32 v126, v126
    v_exp_f32 v135, v135
    v_fract_f32 v127, v127
    v_exp_f32 v136, v136
    v_fract_f32 v128, v128
    v_exp_f32 v137, v137
    v_fract_f32 v129, v129
    v_exp_f32 v138, v138
    v_fract_f32 v130, v130
    v_exp_f32 v139, v139
    v_fract_f32 v131, v131
    v_pk_fma_f32 v[124:125], v[76:77], v[30:31], v[124:125] op_sel:[0,1,0] op_sel_hi:[1,1,1]
    v_pk_fma_f32 v[126:127], v[78:79], v[30:31], v[126:127] op_sel:[0,1,0] op_sel_hi:[1,1,1]
    v_pk_fma_f32 v[128:129], v[80:81], v[30:31], v[128:129] op_sel:[0,1,0] op_sel_hi:[1,1,1]
    v_pk_fma_f32 v[130:131], v[82:83], v[30:31], v[130:131] op_sel:[0,1,0] op_sel_hi:[1,1,1]
    v_fract_f32 v124, v124
    v_fract_f32 v125, v125
    v_fract_f32 v126, v126
    v_fract_f32 v127, v127
    v_fract_f32 v128, v128
    v_fract_f32 v129, v129
    v_fract_f32 v130, v130
    v_fract_f32 v131, v131
    v_cos_f32 v140, v124
    v_cos_f32 v141, v125
    v_cos_f32 v142, v126
    v_cos_f32 v143, v127
    v_cos_f32 v144, v128
    v_cos_f32 v145, v129
    v_cos_f32 v146, v130
    v_cos_f32 v147, v131
    v_sin_f32 v124, v124
    v_sin_f32 v125, v125
    v_pk_mul_f32 v[140:141], v[140:141], v[132:133]
    v_sin_f32 v126, v126
    v_sin_f32 v127, v127
    v_pk_mul_f32 v[142:143], v[142:143], v[134:135]
    v_sin_f32 v128, v128
    v_sin_f32 v129, v129
    v_pk_mul_f32 v[144:145], v[144:145], v[136:137]
    v_sin_f32 v130, v130
    v_sin_f32 v131, v131
    v_pk_mul_f32 v[146:147], v[146:147], v[138:139]
    v_pk_mul_f32 v[124:125], v[124:125], v[132:133]
    v_pk_mul_f32 v[126:127], v[126:127], v[134:135]
    v_pk_mul_f32 v[128:129], v[128:129], v[136:137]
    v_pk_mul_f32 v[130:131], v[130:131], v[138:139]
    v_pk_mul_f32 v[132:133], v[92:93], v[140:141]
    v_pk_mul_f32 v[134:135], v[94:95], v[142:143]
    v_pk_mul_f32 v[136:137], v[96:97], v[144:145]
    v_pk_mul_f32 v[138:139], v[98:99], v[146:147]
    v_pk_mul_f32 v[148:149], v[92:93], v[124:125]
    v_pk_mul_f32 v[150:151], v[94:95], v[126:127]
    v_pk_mul_f32 v[152:153], v[96:97], v[128:129]
    v_pk_mul_f32 v[154:155], v[98:99], v[130:131]
    v_pk_fma_f32 v[132:133], v[100:101], v[124:125], v[132:133] neg_lo:[1,0,0] neg_hi:[1,0,0]
    v_pk_fma_f32 v[134:135], v[102:103], v[126:127], v[134:135] neg_lo:[1,0,0] neg_hi:[1,0,0]
    v_pk_fma_f32 v[136:137], v[104:105], v[128:129], v[136:137] neg_lo:[1,0,0] neg_hi:[1,0,0]
    v_pk_fma_f32 v[138:139], v[106:107], v[130:131], v[138:139] neg_lo:[1,0,0] neg_hi:[1,0,0]
    v_pk_fma_f32 v[148:149], v[100:101], v[140:141], v[148:149]
    v_pk_fma_f32 v[150:151], v[102:103], v[142:143], v[150:151]
    v_pk_fma_f32 v[152:153], v[104:105], v[144:145], v[152:153]
    v_pk_fma_f32 v[154:155], v[106:107], v[146:147], v[154:155]
    v_cvt_pk_f16_f32 v156, v132, -v148
    v_cvt_pk_f16_f32 v157, v133, -v149
    v_cvt_pk_f16_f32 v158, v134, -v150
    v_cvt_pk_f16_f32 v159, v135, -v151
    v_cvt_pk_f16_f32 v160, v136, -v152
    v_cvt_pk_f16_f32 v161, v137, -v153
    v_cvt_pk_f16_f32 v162, v138, -v154
    v_cvt_pk_f16_f32 v163, v139, -v155
    v_pk_mul_f32 v[140:141], v[108:109], v[132:133]
    v_pk_mul_f32 v[142:143], v[110:111], v[134:135]
    v_pk_mul_f32 v[144:145], v[112:113], v[136:137]
    v_pk_mul_f32 v[146:147], v[114:115], v[138:139]
    v_pk_mul_f32 v[124:125], v[108:109], v[148:149]
    v_pk_mul_f32 v[126:127], v[110:111], v[150:151]
    v_pk_mul_f32 v[128:129], v[112:113], v[152:153]
    v_pk_mul_f32 v[130:131], v[114:115], v[154:155]
    v_mfma_f32_16x16x32_f16 v[52:55], v[20:23], v[156:159], v[52:55]
    v_mfma_f32_16x16x32_f16 v[52:55], v[24:27], v[160:163], v[52:55]
    v_pk_fma_f32 v[140:141], v[116:117], v[148:149], v[140:141] neg_lo:[1,0,0] neg_hi:[1,0,0]
    v_pk_fma_f32 v[142:143], v[118:119], v[150:151], v[142:143] neg_lo:[1,0,0] neg_hi:[1,0,0]
    v_pk_fma_f32 v[144:145], v[120:121], v[152:153], v[144:145] neg_lo:[1,0,0] neg_hi:[1,0,0]
    v_pk_fma_f32 v[146:147], v[122:123], v[154:155], v[146:147] neg_lo:[1,0,0] neg_hi:[1,0,0]
    v_pk_fma_f32 v[124:125], v[116:117], v[132:133], v[124:125]
    v_pk_fma_f32 v[126:127], v[118:119], v[134:135], v[126:127]
    v_pk_fma_f32 v[128:129], v[120:121], v[136:137], v[128:129]
    v_pk_fma_f32 v[130:131], v[122:123], v[138:139], v[130:131]
    v_cvt_pk_f16_f32 v164, v140, -v124
    v_cvt_pk_f16_f32 v165, v141, -v125
    v_cvt_pk_f16_f32 v166, v142, -v126
    v_cvt_pk_f16_f32 v167, v143, -v127
    v_cvt_pk_f16_f32 v168, v144, -v128
    v_cvt_pk_f16_f32 v169, v145, -v129
    v_cvt_pk_f16_f32 v170, v146, -v130
    v_cvt_pk_f16_f32 v171, v147, -v131
    v_pk_mul_f32 v[132:133], v[108:109], v[140:141]
    v_pk_mul_f32 v[134:135], v[110:111], v[142:143]
    v_pk_mul_f32 v[136:137], v[112:113], v[144:145]
    v_pk_mul_f32 v[138:139], v[114:115], v[146:147]
    v_pk_mul_f32 v[148:149], v[108:109], v[124:125]
    v_pk_mul_f32 v[150:151], v[110:111], v[126:127]
    v_pk_mul_f32 v[152:153], v[112:113], v[128:129]
    v_pk_mul_f32 v[154:155], v[114:115], v[130:131]
    v_mfma_f32_16x16x32_f16 v[56:59], v[20:23], v[164:167], v[56:59]
    v_mfma_f32_16x16x32_f16 v[56:59], v[24:27], v[168:171], v[56:59]
    v_pk_fma_f32 v[132:133], v[116:117], v[124:125], v[132:133] neg_lo:[1,0,0] neg_hi:[1,0,0]
    v_pk_fma_f32 v[134:135], v[118:119], v[126:127], v[134:135] neg_lo:[1,0,0] neg_hi:[1,0,0]
    v_pk_fma_f32 v[136:137], v[120:121], v[128:129], v[136:137] neg_lo:[1,0,0] neg_hi:[1,0,0]
    v_pk_fma_f32 v[138:139], v[122:123], v[130:131], v[138:139] neg_lo:[1,0,0] neg_hi:[1,0,0]
    v_pk_fma_f32 v[148:149], v[116:117], v[140:141], v[148:149]
    v_pk_fma_f32 v[150:151], v[118:119], v[142:143], v[150:151]
    v_pk_fma_f32 v[152:153], v[120:121], v[144:145], v[152:153]
    v_pk_fma_f32 v[154:155], v[122:123], v[146:147], v[154:155]
    v_cvt_pk_f16_f32 v156, v132, -v148
    v_cvt_pk_f16_f32 v157, v133, -v149
    v_cvt_pk_f16_f32 v158, v134, -v150
    v_cvt_pk_f16_f32 v159, v135, -v151
    v_cvt_pk_f16_f32 v160, v136, -v152
    v_cvt_pk_f16_f32 v161, v137, -v153
    v_cvt_pk_f16_f32 v162, v138, -v154
    v_cvt_pk_f16_f32 v163, v139, -v155
    v_pk_mul_f32 v[140:141], v[108:109], v[132:133]
    v_pk_mul_f32 v[142:143], v[110:111], v[134:135]
    v_pk_mul_f32 v[144:145], v[112:113], v[136:137]
    v_pk_mul_f32 v[146:147], v[114:115], v[138:139]
    v_pk_mul_f32 v[124:125], v[108:109], v[148:149]
    v_pk_mul_f32 v[126:127], v[110:111], v[150:151]
    v_pk_mul_f32 v[128:129], v[112:113], v[152:153]
    v_pk_mul_f32 v[130:131], v[114:115], v[154:155]
    v_mfma_f32_16x16x32_f16 v[60:63], v[20:23], v[156:159], v[60:63]
    v_mfma_f32_16x16x32_f16 v[60:63], v[24:27], v[160:163], v[60:63]
    v_pk_fma_f32 v[140:141], v[116:117], v[148:149], v[140:141] neg_lo:[1,0,0] neg_hi:[1,0,0]
    v_pk_fma_f32 v[142:143], v[118:119], v[150:151], v[142:143] neg_lo:[1,0,0] neg_hi:[1,0,0]
    v_pk_fma_f32 v[144:145], v[120:121], v[152:153], v[144:145] neg_lo:[1,0,0] neg_hi:[1,0,0]
    v_pk_fma_f32 v[146:147], v[122:123], v[154:155], v[146:147] neg_lo:[1,0,0] neg_hi:[1,0,0]
    v_pk_fma_f32 v[124:125], v[116:117], v[132:133], v[124:125]
    v_pk_fma_f32 v[126:127], v[118:119], v[134:135], v[126:127]
    v_pk_fma_f32 v[128:129], v[120:121], v[136:137], v[128:129]
    v_pk_fma_f32 v[130:131], v[122:123], v[138:139], v[130:131]
    v_cvt_pk_f16_f32 v164, v140, -v124
    v_cvt_pk_f16_f32 v165, v141, -v125
    v_cvt_pk_f16_f32 v166, v142, -v126
    v_cvt_pk_f16_f32 v167, v143, -v127
    v_cvt_pk_f16_f32 v168, v144, -v128
    v_cvt_pk_f16_f32 v169, v145, -v129
    v_cvt_pk_f16_f32 v170, v146, -v130
    v_cvt_pk_f16_f32 v171, v147, -v131
    s_add_u32 s61, s61, 1
    s_cmp_lt_u32 s61, 2
    v_mfma_f32_16x16x32_f16 v[64:67], v[20:23], v[164:167], v[64:67]
    v_mfma_f32_16x16x32_f16 v[64:67], v[24:27], v[168:171], v[64:67]
    s_lshl_b32 s55, s60, 1
    s_add_u32 s55, s55, s61
    s_cmp_lg_u32 s55, 1
    s_cbranch_scc1 L_kg_ne
    s_waitcnt vmcnt(0)
    s_barrier
    s_call_b64 s[68:69], L_zbatch
    s_call_b64 s[68:69], L_zbatch
L_kg_ne:
    s_cmp_lt_u32 s61, 2
    s_cbranch_scc1 L_kg_k
    v_mov_b32 v40, v44
    v_mov_b32 v41, v45
    v_mov_b32 v42, v46
    v_mov_b32 v43, v47
    s_add_u32 s60, s60, 1
    s_cmp_lt_u32 s60, 2
    s_cbranch_scc1 L_kg_b
    s_nop 7
    v_fma_f32 v52, v52, v34, v49
    v_mul_f32 v53, v53, v34
    v_mul_f32 v54, v54, v34
    v_mul_f32 v55, v55, v34
    v_mul_f32 v56, v56, v34
    v_mul_f32 v57, v57, v34
    v_mul_f32 v58, v58, v34
    v_mul_f32 v59, v59, v34
    v_mul_f32 v60, v60, v34
    v_mul_f32 v61, v61, v34
    v_mul_f32 v62, v62, v34
    v_mul_f32 v63, v63, v34
    v_mul_f32 v64, v64, v34
    v_mul_f32 v65, v65, v34
    v_mul_f32 v66, v66, v34
    v_mul_f32 v67, v67, v34
    v_cvt_pk_bf16_f32 v192, v52, v53
    v_cvt_pk_bf16_f32 v193, v54, v55
    v_cvt_pk_bf16_f32 v194, v56, v57
    v_cvt_pk_bf16_f32 v195, v58, v59
    v_cvt_pk_bf16_f32 v196, v60, v61
    v_cvt_pk_bf16_f32 v197, v62, v63
    v_cvt_pk_bf16_f32 v198, v64, v65
    v_cvt_pk_bf16_f32 v199, v66, v67
    s_mov_b32 s60, s62
    s_mov_b32 s59, 0
    v_mov_b32 v230, 0
L_nn_lk:
    s_waitcnt vmcnt(0)
    v_readfirstlane_b32 s52, v229
    s_add_u32 s59, s59, 1
    s_nop 2
    s_cmp_lg_u32 s52, 0
    s_cbranch_scc1 L_nnd_lk
    s_sleep 2
    buffer_load_dword v229, v230, s[48:51], 0 offen sc1
    s_cmp_lt_u32 s59, 0x20000
    s_cbranch_scc1 L_nn_lk
L_nnd_lk:
    s_branch L_l_z1
L_l_misc:
    s_call_b64 s[68:69], L_job_proc
    s_lshr_b32 s66, s62, 16
    s_and_b32 s67, s62, 0xffff
    s_waitcnt vmcnt(0)
    s_barrier
    s_call_b64 s[68:69], L_job_load
    s_call_b64 s[68:69], L_zbatch
    s_call_b64 s[68:69], L_zbatch
    s_waitcnt vmcnt(18)
    s_call_b64 s[68:69], L_job_proc
    s_mov_b32 s59, 0
    v_mov_b32 v230, 0
L_nn_lm:
    s_waitcnt vmcnt(0)
    v_readfirstlane_b32 s52, v229
    s_add_u32 s59, s59, 1
    s_nop 2
    s_cmp_lg_u32 s52, 0
    s_cbranch_scc1 L_nnd_lm
    s_sleep 2
    buffer_load_dword v229, v230, s[48:51], 0 offen sc1
    s_cmp_lt_u32 s59, 0x20000
    s_cbranch_scc1 L_nn_lm
L_nnd_lm:
L_l_z1:
    s_setprio 2
    s_mov_b32 s54, 11
    s_load_dwordx2 s[8:9], s[0:1], 72
L_l_z1l:
    s_waitcnt vmcnt(9)
    s_barrier
    s_call_b64 s[68:69], L_zbatch
    s_add_u32 s54, s54, 1
    s_cmp_lt_u32 s54, 16
    s_cbranch_scc1 L_l_z1l
    v_lshrrev_b32 v14, 3, v3
    v_add_u32 v14, 0, v14
    v_bfe_u32 v15, v14, 1, 3
    v_and_b32 v13, 7, v3
    v_xor_b32 v15, v15, v13
    v_and_b32 v13, 3, v14
    v_bfe_u32 v12, v14, 2, 2
    v_lshl_add_u32 v13, v12, 3, v13
    v_lshrrev_b32 v12, 4, v14
    v_lshl_add_u32 v14, v12, 2, v13
    v_mul_u32_u24 v14, 4096, v14
    v_lshl_add_u32 v221, v15, 4, v14
    v_lshrrev_b32 v14, 3, v3
    v_add_u32 v14, 8, v14
    v_bfe_u32 v15, v14, 1, 3
    v_and_b32 v13, 7, v3
    v_xor_b32 v15, v15, v13
    v_and_b32 v13, 3, v14
    v_bfe_u32 v12, v14, 2, 2
    v_lshl_add_u32 v13, v12, 3, v13
    v_lshrrev_b32 v12, 4, v14
    v_lshl_add_u32 v14, v12, 2, v13
    v_mul_u32_u24 v14, 4096, v14
    v_lshl_add_u32 v222, v15, 4, v14
    v_lshrrev_b32 v14, 3, v3
    v_add_u32 v14, 16, v14
    v_bfe_u32 v15, v14, 1, 3
    v_and_b32 v13, 7, v3
    v_xor_b32 v15, v15, v13
    v_and_b32 v13, 3, v14
    v_bfe_u32 v12, v14, 2, 2
    v_lshl_add_u32 v13, v12, 3, v13
    v_lshrrev_b32 v12, 4, v14
    v_lshl_add_u32 v14, v12, 2, v13
    v_mul_u32_u24 v14, 4096, v14
    v_lshl_add_u32 v223, v15, 4, v14
    v_lshrrev_b32 v14, 3, v3
    v_add_u32 v14, 24, v14
    v_bfe_u32 v15, v14, 1, 3
    v_and_b32 v13, 7, v3
    v_xor_b32 v15, v15, v13
    v_and_b32 v13, 3, v14
    v_bfe_u32 v12, v14, 2, 2
    v_lshl_add_u32 v13, v12, 3, v13
    v_lshrrev_b32 v12, 4, v14
    v_lshl_add_u32 v14, v12, 2, v13
    v_mul_u32_u24 v14, 4096, v14
    v_lshl_add_u32 v224, v15, 4, v14
    s_waitcnt lgkmcnt(0)
    s_mov_b32 s36, s8
    s_mov_b32 s37, s9
    s_mov_b32 s38, 0x800000
    s_mov_b32 s39, 0x00020000
    s_lshl_b32 s29, s60, 17
    s_mul_i32 s28, s16, 589824
    s_add_u32 s28, s28, s26
    s_add_u32 s28, s28, 0
    s_cmp_lt_u32 s21, 2
    s_mov_b32 s25, 0x40000000
    s_cselect_b32 s25, 16384, s25
    s_mov_b32 s30, 73728
    s_mov_b32 s31, 110592
    s_waitcnt vmcnt(9)
    s_barrier
    s_add_u32 s55, s30, s27
    s_add_u32 m0, s55, 0
    s_nop 0
    buffer_load_dwordx4 v221, s[36:39], s29 offen lds
    s_add_u32 m0, s55, 1024
    s_nop 0
    buffer_load_dwordx4 v222, s[36:39], s29 offen lds
    s_add_u32 m0, s55, 2048
    s_nop 0
    buffer_load_dwordx4 v223, s[36:39], s29 offen lds
    s_add_u32 m0, s55, 3072
    s_nop 0
    buffer_load_dwordx4 v224, s[36:39], s29 offen lds
    s_add_u32 s29, s29, 128
    s_waitcnt vmcnt(4)
    s_barrier
    s_add_u32 s55, s31, s27
    s_add_u32 m0, s55, 0
    s_nop 0
    buffer_load_dwordx4 v221, s[36:39], s29 offen lds
    s_add_u32 m0, s55, 1024
    s_nop 0
    buffer_load_dwordx4 v222, s[36:39], s29 offen lds
    s_add_u32 m0, s55, 2048
    s_nop 0
    buffer_load_dwordx4 v223, s[36:39], s29 offen lds
    s_add_u32 m0, s55, 3072
    s_nop 0
    buffer_load_dwordx4 v224, s[36:39], s29 offen lds
    s_add_u32 s29, s29, 128
    s_mul_i32 s58, s16, 256
    s_add_u32 s58, s58, 40386816
    v_and_b32 v8, 63, v3
    v_lshlrev_b32 v8, 2, v8
    s_mov_b32 s59, 0
L_poll_f1:
    buffer_load_dword v4, v8, s[40:43], s58 offen sc1
    s_waitcnt vmcnt(0)
    v_cmp_ne_u32 vcc, s52, v4
    s_add_u32 s59, s59, 1
    s_nop 1
    s_cbranch_vccz L_polled_f1
    s_sleep 1
    s_cmp_lt_u32 s59, 0x20000
    s_cbranch_scc1 L_poll_f1
L_polled_f1:
    s_add_u32 s55, s30, s26
    s_add_u32 m0, s55, 0
    s_add_u32 s56, s28, 0
    buffer_load_dwordx4 v1, s[40:43], s56 offen sc1 lds
    s_add_u32 m0, s55, 4096
    s_add_u32 s56, s28, 4096
    buffer_load_dwordx4 v1, s[40:43], s56 offen sc1 lds
    s_add_u32 m0, s55, 8192
    s_add_u32 s56, s28, 8192
    buffer_load_dwordx4 v1, s[40:43], s56 offen sc1 lds
    s_add_u32 m0, s55, 12288
    s_add_u32 s56, s28, 12288
    buffer_load_dwordx4 v1, s[40:43], s56 offen sc1 lds
    s_add_u32 m0, s30, s24
    s_add_u32 s56, s28, s25
    buffer_load_dwordx4 v1, s[40:43], s56 offen sc1 lds
    s_add_u32 s28, s28, 18432
    s_add_u32 s55, s31, s26
    s_add_u32 m0, s55, 0
    s_add_u32 s56, s28, 0
    buffer_load_dwordx4 v1, s[40:43], s56 offen sc1 lds
    s_add_u32 m0, s55, 4096
    s_add_u32 s56, s28, 4096
    buffer_load_dwordx4 v1, s[40:43], s56 offen sc1 lds
    s_add_u32 m0, s55, 8192
    s_add_u32 s56, s28, 8192
    buffer_load_dwordx4 v1, s[40:43], s56 offen sc1 lds
    s_add_u32 m0, s55, 12288
    s_add_u32 s56, s28, 12288
    buffer_load_dwordx4 v1, s[40:43], s56 offen sc1 lds
    s_add_u32 m0, s31, s24
    s_add_u32 s56, s28, s25
    buffer_load_dwordx4 v1, s[40:43], s56 offen sc1 lds
    s_add_u32 s28, s28, 18432
    s_mov_b32 s53, 0
    s_mov_b32 s54, 0
    s_waitcnt vmcnt(5)
L_l_g2:
    s_waitcnt vmcnt(9)
    s_barrier
    s_add_u32 s55, s53, s27
    s_add_u32 m0, s55, 0
    s_nop 0
    buffer_load_dwordx4 v221, s[36:39], s29 offen lds
    s_add_u32 m0, s55, 1024
    s_nop 0
    buffer_load_dwordx4 v222, s[36:39], s29 offen lds
    s_add_u32 m0, s55, 2048
    s_nop 0
    buffer_load_dwordx4 v223, s[36:39], s29 offen lds
    s_add_u32 m0, s55, 3072
    s_nop 0
    buffer_load_dwordx4 v224, s[36:39], s29 offen lds
    s_add_u32 s29, s29, 128
    s_add_u32 s55, s53, s26
    s_add_u32 m0, s55, 0
    s_add_u32 s56, s28, 0
    buffer_load_dwordx4 v1, s[40:43], s56 offen sc1 lds
    s_add_u32 m0, s55, 4096
    s_add_u32 s56, s28, 4096
    buffer_load_dwordx4 v1, s[40:43], s56 offen sc1 lds
    s_add_u32 m0, s55, 8192
    s_add_u32 s56, s28, 8192
    buffer_load_dwordx4 v1, s[40:43], s56 offen sc1 lds
    s_add_u32 m0, s55, 12288
    s_add_u32 s56, s28, 12288
    buffer_load_dwordx4 v1, s[40:43], s56 offen sc1 lds
    s_add_u32 m0, s53, s24
    s_add_u32 s56, s28, s25
    buffer_load_dwordx4 v1, s[40:43], s56 offen sc1 lds
    s_add_u32 s28, s28, 18432
    s_add_u32 s53, s53, 36864
    s_cmp_ge_u32 s53, 147456
    s_cselect_b32 s53, 0, s53
    s_cmp_lg_u32 s54, 2
    s_cbranch_scc1 L_l_g2nf
    s_cmp_lg_u32 s21, 0
    s_cbranch_scc1 L_l_g2nf
    s_lshl_b32 s58, s2, 2
    s_add_u32 s58, s58, 40318976
    v_mov_b32 v230, 0
    v_mov_b32 v231, s52
    s_mov_b64 exec, 1
    buffer_store_dword v231, v230, s[40:43], s58 offen sc1
    s_mov_b64 exec, -1
L_l_g2nf:
    s_add_u32 s54, s54, 1
    s_cmp_lt_u32 s54, 30
    s_cbranch_scc1 L_l_g2
    s_and_b32 s18, s2, 7
    s_lshr_b32 s19, s2, 3
    s_lshl_b32 s18, s18, 2
    s_and_b32 s55, s19, 3
    s_add_u32 s18, s18, s55
    s_lshr_b32 s19, s19, 2
    s_mul_i32 s15, s19, 9
    s_add_u32 s15, s15, 1
    s_lshr_b32 s15, s15, 1
    s_mul_i32 s28, s21, 36864
    s_lshl_b32 s55, s15, 10
    s_add_u32 s28, s28, s55
    s_add_u32 s28, s28, 36700160
    s_bitcmp1_b32 s19, 0
    s_mov_b32 s25, 4096
    s_cselect_b32 s25, 0x40000000, s25
    s_mul_i32 s24, s21, 5120
    s_add_u32 s27, s27, 2048
    s_mul_i32 s29, s18, 294912
    s_add_u32 s29, s29, s26
    s_add_u32 s29, s29, 27262976
    s_waitcnt vmcnt(9)
    s_barrier
    s_mov_b32 s58, 40318976
    s_mov_b32 s59, 0
L_poll_fm:
    buffer_load_dwordx4 v[4:7], v1, s[40:43], s58 offen sc1
    s_waitcnt vmcnt(0)
    v_xor_b32 v4, s52, v4
    v_xor_b32 v5, s52, v5
    v_xor_b32 v6, s52, v6
    v_xor_b32 v7, s52, v7
    v_or3_b32 v4, v4, v5, v6
    v_or_b32 v4, v4, v7
    v_cmp_ne_u32 vcc, 0, v4
    s_add_u32 s59, s59, 1
    s_nop 1
    s_cbranch_vccz L_polled_fm
    s_sleep 1
    s_cmp_lt_u32 s59, 0x20000
    s_cbranch_scc1 L_poll_fm
L_polled_fm:
    s_lshl_b32 s57, s21, 4
    v_lshl_add_u32 v226, v3, 6, s57
    s_lshl_b32 s55, s2, 13
    s_add_u32 s55, s55, 42991616
    s_mul_i32 s56, s21, 1280
    s_add_u32 m0, s56, 147712
    s_add_u32 s57, s55, 0
    buffer_load_dwordx4 v226, s[40:43], s57 offen sc1 lds
    s_add_u32 m0, s56, 152832
    s_add_u32 s57, s55, 4096
    buffer_load_dwordx4 v226, s[40:43], s57 offen sc1 lds
    s_lshl_b32 s55, s3, 12
    s_add_u32 s55, s55, 42991616
    s_add_u32 m0, s56, 157952
    s_cmp_lt_u32 s3, 576
    s_cselect_b32 s55, s55, 0x40000000
    buffer_load_dwordx4 v226, s[40:43], s55 offen sc1 lds
    s_add_u32 s55, s30, s24
    s_add_u32 m0, s55, 0
    s_add_u32 s56, s28, 0
    buffer_load_dwordx4 v1, s[40:43], s56 offen sc1 lds
    s_add_u32 m0, s55, 1024
    s_add_u32 s56, s28, 1024
    buffer_load_dwordx4 v1, s[40:43], s56 offen sc1 lds
    s_add_u32 m0, s55, 2048
    s_add_u32 s56, s28, 2048
    buffer_load_dwordx4 v1, s[40:43], s56 offen sc1 lds
    s_add_u32 m0, s55, 3072
    s_add_u32 s56, s28, 3072
    buffer_load_dwordx4 v1, s[40:43], s56 offen sc1 lds
    s_add_u32 m0, s55, 4096
    s_add_u32 s56, s28, 4096
    s_bitcmp1_b32 s19, 0
    s_cbranch_scc1 L_sk_1
    buffer_load_dwordx4 v1, s[40:43], s56 offen sc1 lds
L_sk_1:
    s_add_u32 s28, s28, 147456
    v_mov_b32 v8, 0
    v_mov_b32 v9, 0
    v_mov_b32 v10, 0
    v_mov_b32 v11, 0
    v_lshrrev_b32 v13, 4, v3
    v_mul_u32_u24 v4, 1280, v13
    v_and_b32 v12, 15, v3
    v_lshl_add_u32 v4, v12, 4, v4
    v_add_u32 v4, 147456, v4
    ds_write_b128 v4, v[8:11] offset:0
    ds_write_b128 v4, v[8:11] offset:5120
    ds_write_b128 v4, v[8:11] offset:10240
    s_barrier
    s_cmp_ge_u32 s64, 576
    s_cbranch_scc1 L_l_nk3
    s_mul_i32 s22, s21, 5120
    s_add_u32 s22, s22, 110592
    v_and_b32 v12, 15, v3
    v_lshrrev_b32 v13, 4, v3
    v_lshlrev_b32 v14, 2, v13
    v_lshl_add_u32 v15, v12, 4, s22
    v_add_u32 v16, 0, v14
    v_subrev_u32 v17, 8, v16
    v_med3_i32 v17, v17, 1, 4
    v_lshlrev_b32 v17, 9, v17
    v_cmp_eq_u32 vcc, 9, v16
    v_add_u32 v36, 4, v17
    s_nop 0
    v_cndmask_b32 v17, v17, v36, vcc
    v_cmp_gt_u32 vcc, 8, v16
    s_nop 1
    v_cndmask_b32 v36, v17, v16, vcc
    v_lshl_add_u32 v36, v36, 1, v15
    v_add_u32 v16, 1, v14
    v_subrev_u32 v17, 8, v16
    v_med3_i32 v17, v17, 1, 4
    v_lshlrev_b32 v17, 9, v17
    v_cmp_eq_u32 vcc, 9, v16
    v_add_u32 v37, 4, v17
    s_nop 0
    v_cndmask_b32 v17, v17, v37, vcc
    v_cmp_gt_u32 vcc, 8, v16
    s_nop 1
    v_cndmask_b32 v37, v17, v16, vcc
    v_lshl_add_u32 v37, v37, 1, v15
    v_add_u32 v16, 2, v14
    v_subrev_u32 v17, 8, v16
    v_med3_i32 v17, v17, 1, 4
    v_lshlrev_b32 v17, 9, v17
    v_cmp_eq_u32 vcc, 9, v16
    v_add_u32 v38, 4, v17
    s_nop 0
    v_cndmask_b32 v17, v17, v38, vcc
    v_cmp_gt_u32 vcc, 8, v16
    s_nop 1
    v_cndmask_b32 v38, v17, v16, vcc
    v_lshl_add_u32 v38, v38, 1, v15
    v_add_u32 v16, 3, v14
    v_subrev_u32 v17, 8, v16
    v_med3_i32 v17, v17, 1, 4
    v_lshlrev_b32 v17, 9, v17
    v_cmp_eq_u32 vcc, 9, v16
    v_add_u32 v39, 4, v17
    s_nop 0
    v_cndmask_b32 v17, v17, v39, vcc
    v_cmp_gt_u32 vcc, 8, v16
    s_nop 1
    v_cndmask_b32 v39, v17, v16, vcc
    v_lshl_add_u32 v39, v39, 1, v15
    ds_write_b16 v36, v192 offset:0
    ds_write_b16_d16_hi v37, v192 offset:0
    ds_write_b16 v38, v193 offset:0
    ds_write_b16_d16_hi v39, v193 offset:0
    ds_write_b16 v36, v194 offset:256
    ds_write_b16_d16_hi v37, v194 offset:256
    ds_write_b16 v38, v195 offset:256
    ds_write_b16_d16_hi v39, v195 offset:256
    ds_write_b16 v36, v196 offset:512
    ds_write_b16_d16_hi v37, v196 offset:512
    ds_write_b16 v38, v197 offset:512
    ds_write_b16_d16_hi v39, v197 offset:512
    ds_write_b16 v36, v198 offset:768
    ds_write_b16_d16_hi v37, v198 offset:768
    ds_write_b16 v38, v199 offset:768
    ds_write_b16_d16_hi v39, v199 offset:768
    v_mov_b32 v19, 0x4b000000
    v_lshlrev_b32 v14, 3, v3
    v_cvt_f32_u32 v14, v14
    v_add_f32 v16, 0x00000000, v14
    v_lshrrev_b32 v17, 23, v16
    v_sub_u32 v17, 261, v17
    v_min_u32 v17, 127, v17
    v_sub_u32 v18, 128, v17
    v_lshlrev_b32 v17, 23, v17
    v_lshlrev_b32 v18, v18, 1
    v_add_f32 v68, 0x00000000, v16
    v_add_f32 v69, 0x3f800000, v16
    v_add_f32 v70, 0x40000000, v16
    v_add_f32 v71, 0x40400000, v16
    v_add_f32 v72, 0x40800000, v16
    v_add_f32 v73, 0x40a00000, v16
    v_add_f32 v74, 0x40c00000, v16
    v_add_f32 v75, 0x40e00000, v16
    v_fma_f32 v68, v68, v17, v19
    v_fma_f32 v69, v69, v17, v19
    v_fma_f32 v70, v70, v17, v19
    v_fma_f32 v71, v71, v17, v19
    v_fma_f32 v72, v72, v17, v19
    v_fma_f32 v73, v73, v17, v19
    v_fma_f32 v74, v74, v17, v19
    v_fma_f32 v75, v75, v17, v19
    v_mad_u32_u24 v68, v68, v18, s22
    v_mad_u32_u24 v69, v69, v18, s22
    v_mad_u32_u24 v70, v70, v18, s22
    v_mad_u32_u24 v71, v71, v18, s22
    v_mad_u32_u24 v72, v72, v18, s22
    v_mad_u32_u24 v73, v73, v18, s22
    v_mad_u32_u24 v74, v74, v18, s22
    v_mad_u32_u24 v75, v75, v18, s22
    ds_read_u16 v76, v68
    ds_read_u16 v77, v69
    ds_read_u16 v78, v70
    ds_read_u16 v79, v71
    ds_read_u16 v80, v72
    ds_read_u16 v81, v73
    ds_read_u16 v82, v74
    ds_read_u16 v83, v75
    v_add_f32 v16, 0x44000000, v14
    v_lshrrev_b32 v17, 23, v16
    v_sub_u32 v17, 261, v17
    v_min_u32 v17, 127, v17
    v_sub_u32 v18, 128, v17
    v_lshlrev_b32 v17, 23, v17
    v_lshlrev_b32 v18, v18, 1
    v_add_f32 v68, 0x00000000, v16
    v_add_f32 v69, 0x3f800000, v16
    v_add_f32 v70, 0x40000000, v16
    v_add_f32 v71, 0x40400000, v16
    v_add_f32 v72, 0x40800000, v16
    v_add_f32 v73, 0x40a00000, v16
    v_add_f32 v74, 0x40c00000, v16
    v_add_f32 v75, 0x40e00000, v16
    v_fma_f32 v68, v68, v17, v19
    v_fma_f32 v69, v69, v17, v19
    v_fma_f32 v70, v70, v17, v19
    v_fma_f32 v71, v71, v17, v19
    v_fma_f32 v72, v72, v17, v19
    v_fma_f32 v73, v73, v17, v19
    v_fma_f32 v74, v74, v17, v19
    v_fma_f32 v75, v75, v17, v19
    v_mad_u32_u24 v68, v68, v18, s22
    v_mad_u32_u24 v69, v69, v18, s22
    v_mad_u32_u24 v70, v70, v18, s22
    v_mad_u32_u24 v71, v71, v18, s22
    v_mad_u32_u24 v72, v72, v18, s22
    v_mad_u32_u24 v73, v73, v18, s22
    v_mad_u32_u24 v74, v74, v18, s22
    v_mad_u32_u24 v75, v75, v18, s22
    ds_read_u16 v84, v68
    ds_read_u16 v85, v69
    ds_read_u16 v86, v70
    ds_read_u16 v87, v71
    ds_read_u16 v88, v72
    ds_read_u16 v89, v73
    ds_read_u16 v90, v74
    ds_read_u16 v91, v75
    v_add_f32 v16, 0x44800000, v14
    v_lshrrev_b32 v17, 23, v16
    v_sub_u32 v17, 261, v17
    v_min_u32 v17, 127, v17
    v_sub_u32 v18, 128, v17
    v_lshlrev_b32 v17, 23, v17
    v_lshlrev_b32 v18, v18, 1
    v_add_f32 v68, 0x00000000, v16
    v_add_f32 v69, 0x3f800000, v16
    v_add_f32 v70, 0x40000000, v16
    v_add_f32 v71, 0x40400000, v16
    v_add_f32 v72, 0x40800000, v16
    v_add_f32 v73, 0x40a00000, v16
    v_add_f32 v74, 0x40c00000, v16
    v_add_f32 v75, 0x40e00000, v16
    v_fma_f32 v68, v68, v17, v19
    v_fma_f32 v69, v69, v17, v19
    v_fma_f32 v70, v70, v17, v19
    v_fma_f32 v71, v71, v17, v19
    v_fma_f32 v72, v72, v17, v19
    v_fma_f32 v73, v73, v17, v19
    v_fma_f32 v74, v74, v17, v19
    v_fma_f32 v75, v75, v17, v19
    v_mad_u32_u24 v68, v68, v18, s22
    v_mad_u32_u24 v69, v69, v18, s22
    v_mad_u32_u24 v70, v70, v18, s22
    v_mad_u32_u24 v71, v71, v18, s22
    v_mad_u32_u24 v72, v72, v18, s22
    v_mad_u32_u24 v73, v73, v18, s22
    v_mad_u32_u24 v74, v74, v18, s22
    v_mad_u32_u24 v75, v75, v18, s22
    ds_read_u16 v92, v68
    ds_read_u16 v93, v69
    ds_read_u16 v94, v70
    ds_read_u16 v95, v71
    ds_read_u16 v96, v72
    ds_read_u16 v97, v73
    ds_read_u16 v98, v74
    ds_read_u16 v99, v75
    v_add_f32 v16, 0x44c00000, v14
    v_lshrrev_b32 v17, 23, v16
    v_sub_u32 v17, 261, v17
    v_min_u32 v17, 127, v17
    v_sub_u32 v18, 128, v17
    v_lshlrev_b32 v17, 23, v17
    v_lshlrev_b32 v18, v18, 1
    v_add_f32 v68, 0x00000000, v16
    v_add_f32 v69, 0x3f800000, v16
    v_add_f32 v70, 0x40000000, v16
    v_add_f32 v71, 0x40400000, v16
    v_add_f32 v72, 0x40800000, v16
    v_add_f32 v73, 0x40a00000, v16
    v_add_f32 v74, 0x40c00000, v16
    v_add_f32 v75, 0x40e00000, v16
    v_fma_f32 v68, v68, v17, v19
    v_fma_f32 v69, v69, v17, v19
    v_fma_f32 v70, v70, v17, v19
    v_fma_f32 v71, v71, v17, v19
    v_fma_f32 v72, v72, v17, v19
    v_fma_f32 v73, v73, v17, v19
    v_fma_f32 v74, v74, v17, v19
    v_fma_f32 v75, v75, v17, v19
    v_mad_u32_u24 v68, v68, v18, s22
    v_mad_u32_u24 v69, v69, v18, s22
    v_mad_u32_u24 v70, v70, v18, s22
    v_mad_u32_u24 v71, v71, v18, s22
    v_mad_u32_u24 v72, v72, v18, s22
    v_mad_u32_u24 v73, v73, v18, s22
    v_mad_u32_u24 v74, v74, v18, s22
    v_mad_u32_u24 v75, v75, v18, s22
    ds_read_u16 v100, v68
    ds_read_u16 v101, v69
    ds_read_u16 v102, v70
    ds_read_u16 v103, v71
    ds_read_u16 v104, v72
    ds_read_u16 v105, v73
    ds_read_u16 v106, v74
    ds_read_u16 v107, v75
    s_waitcnt lgkmcnt(0)
    v_lshl_or_b32 v176, v77, 16, v76
    v_lshl_or_b32 v177, v79, 16, v78
    v_lshl_or_b32 v178, v81, 16, v80
    v_lshl_or_b32 v179, v83, 16, v82
    v_lshl_or_b32 v180, v85, 16, v84
    v_lshl_or_b32 v181, v87, 16, v86
    v_lshl_or_b32 v182, v89, 16, v88
    v_lshl_or_b32 v183, v91, 16, v90
    v_lshl_or_b32 v184, v93, 16, v92
    v_lshl_or_b32 v185, v95, 16, v94
    v_lshl_or_b32 v186, v97, 16, v96
    v_lshl_or_b32 v187, v99, 16, v98
    v_lshl_or_b32 v188, v101, 16, v100
    v_lshl_or_b32 v189, v103, 16, v102
    v_lshl_or_b32 v190, v105, 16, v104
    v_lshl_or_b32 v191, v107, 16, v106
L_l_nk3:
    s_barrier
    s_cmp_ge_u32 s64, 576
    s_cbranch_scc1 L_l_nc0
    s_mul_i32 s22, s21, 36864
    s_cmp_eq_u32 s21, 2
    s_cselect_b32 s22, 110592, s22
    v_mov_b32 v8, 0
    v_mov_b32 v9, 0
    v_mov_b32 v10, 0
    v_mov_b32 v11, 0
    v_add_u32 v7, s22, v1
    v_lshrrev_b32 v4, 2, v3
    v_and_b32 v4, 7, v4
    v_mul_u32_u24 v4, 4160, v4
    v_and_b32 v5, 3, v3
    v_min_u32 v5, 2, v5
    v_lshl_add_u32 v4, v5, 4, v4
    v_add_u32 v4, s22, v4
    ds_write_b128 v4, v[8:11]
    ds_write_b128 v7, v[176:179] offset:48
    ds_write_b128 v7, v[180:183] offset:1072
    ds_write_b128 v7, v[184:187] offset:2096
    ds_write_b128 v7, v[188:191] offset:3120
L_l_nc0:
    s_waitcnt vmcnt(4) lgkmcnt(0)
    s_barrier
    s_mul_i32 s58, s18, 256
    s_add_u32 s58, s58, 40391168
    s_cmp_ge_u32 s3, 576
    s_cbranch_scc1 L_l_nox
    s_cmp_ge_u32 s21, 2
    s_cbranch_scc1 L_l_xw
    s_mov_b32 s22, 110592
    s_mov_b32 s63, 157696
    s_mov_b32 s62, s3
    s_mov_b32 s65, 0
    s_call_b64 s[68:69], L_conv2
    s_branch L_l_xd
L_l_xw:
    s_barrier
    s_barrier
    s_barrier
L_l_xd:
    v_and_b32 v8, 31, v3
    v_lshlrev_b32 v8, 2, v8
    s_mov_b32 s59, 0
L_poll_f2x:
    buffer_load_dword v4, v8, s[40:43], s58 offen sc1
    s_waitcnt vmcnt(0)
    v_cmp_ne_u32 vcc, s52, v4
    s_add_u32 s59, s59, 1
    s_nop 1
    s_cbranch_vccz L_polled_f2x
    s_sleep 1
    s_cmp_lt_u32 s59, 0x20000
    s_cbranch_scc1 L_poll_f2x
L_polled_f2x:
    s_add_u32 s55, s30, s27
    s_add_u32 m0, s55, 0
    s_add_u32 s56, s29, 0
    buffer_load_dwordx4 v1, s[40:43], s56 offen sc1 lds
    s_add_u32 m0, s55, 1024
    s_add_u32 s56, s29, 4096
    buffer_load_dwordx4 v1, s[40:43], s56 offen sc1 lds
    s_add_u32 m0, s55, 2048
    s_add_u32 s56, s29, 8192
    buffer_load_dwordx4 v1, s[40:43], s56 offen sc1 lds
    s_add_u32 m0, s55, 3072
    s_add_u32 s56, s29, 12288
    buffer_load_dwordx4 v1, s[40:43], s56 offen sc1 lds
    s_add_u32 s29, s29, 16384
    s_waitcnt vmcnt(0)
    s_barrier
    s_add_u32 s55, s31, s27
    s_add_u32 m0, s55, 0
    s_add_u32 s56, s29, 0
    buffer_load_dwordx4 v1, s[40:43], s56 offen sc1 lds
    s_add_u32 m0, s55, 1024
    s_add_u32 s56, s29, 4096
    buffer_load_dwordx4 v1, s[40:43], s56 offen sc1 lds
    s_add_u32 m0, s55, 2048
    s_add_u32 s56, s29, 8192
    buffer_load_dwordx4 v1, s[40:43], s56 offen sc1 lds
    s_add_u32 m0, s55, 3072
    s_add_u32 s56, s29, 12288
    buffer_load_dwordx4 v1, s[40:43], s56 offen sc1 lds
    s_add_u32 s29, s29, 16384
    s_add_u32 s55, s31, s24
    s_add_u32 m0, s55, 0
    s_add_u32 s56, s28, 0
    buffer_load_dwordx4 v1, s[40:43], s56 offen sc1 lds
    s_add_u32 m0, s55, 1024
    s_add_u32 s56, s28, 1024
    buffer_load_dwordx4 v1, s[40:43], s56 offen sc1 lds
    s_add_u32 m0, s55, 2048
    s_add_u32 s56, s28, 2048
    buffer_load_dwordx4 v1, s[40:43], s56 offen sc1 lds
    s_add_u32 m0, s55, 3072
    s_add_u32 s56, s28, 3072
    buffer_load_dwordx4 v1, s[40:43], s56 offen sc1 lds
    s_add_u32 m0, s55, 4096
    s_add_u32 s56, s28, 4096
    s_bitcmp1_b32 s19, 0
    s_cbranch_scc1 L_sk_2
    buffer_load_dwordx4 v1, s[40:43], s56 offen sc1 lds
L_sk_2:
    s_add_u32 s28, s28, 147456
    s_branch L_l_g3go
L_l_nox:
    s_add_u32 s55, s31, s24
    s_add_u32 m0, s55, 0
    s_add_u32 s56, s28, 0
    buffer_load_dwordx4 v1, s[40:43], s56 offen sc1 lds
    s_add_u32 m0, s55, 1024
    s_add_u32 s56, s28, 1024
    buffer_load_dwordx4 v1, s[40:43], s56 offen sc1 lds
    s_add_u32 m0, s55, 2048
    s_add_u32 s56, s28, 2048
    buffer_load_dwordx4 v1, s[40:43], s56 offen sc1 lds
    s_add_u32 m0, s55, 3072
    s_add_u32 s56, s28, 3072
    buffer_load_dwordx4 v1, s[40:43], s56 offen sc1 lds
    s_add_u32 m0, s55, 4096
    s_add_u32 s56, s28, 4096
    s_bitcmp1_b32 s19, 0
    s_cbranch_scc1 L_sk_3
    buffer_load_dwordx4 v1, s[40:43], s56 offen sc1 lds
L_sk_3:
    s_add_u32 s28, s28, 147456
    s_barrier
    v_and_b32 v8, 31, v3
    v_lshlrev_b32 v8, 2, v8
    s_mov_b32 s59, 0
L_poll_f2:
    buffer_load_dword v4, v8, s[40:43], s58 offen sc1
    s_waitcnt vmcnt(0)
    v_cmp_ne_u32 vcc, s52, v4
    s_add_u32 s59, s59, 1
    s_nop 1
    s_cbranch_vccz L_polled_f2
    s_sleep 1
    s_cmp_lt_u32 s59, 0x20000
    s_cbranch_scc1 L_poll_f2
L_polled_f2:
    s_add_u32 s55, s30, s27
    s_add_u32 m0, s55, 0
    s_add_u32 s56, s29, 0
    buffer_load_dwordx4 v1, s[40:43], s56 offen sc1 lds
    s_add_u32 m0, s55, 1024
    s_add_u32 s56, s29, 4096
    buffer_load_dwordx4 v1, s[40:43], s56 offen sc1 lds
    s_add_u32 m0, s55, 2048
    s_add_u32 s56, s29, 8192
    buffer_load_dwordx4 v1, s[40:43], s56 offen sc1 lds
    s_add_u32 m0, s55, 3072
    s_add_u32 s56, s29, 12288
    buffer_load_dwordx4 v1, s[40:43], s56 offen sc1 lds
    s_add_u32 s29, s29, 16384
    s_add_u32 s55, s31, s27
    s_add_u32 m0, s55, 0
    s_add_u32 s56, s29, 0
    buffer_load_dwordx4 v1, s[40:43], s56 offen sc1 lds
    s_add_u32 m0, s55, 1024
    s_add_u32 s56, s29, 4096
    buffer_load_dwordx4 v1, s[40:43], s56 offen sc1 lds
    s_add_u32 m0, s55, 2048
    s_add_u32 s56, s29, 8192
    buffer_load_dwordx4 v1, s[40:43], s56 offen sc1 lds
    s_add_u32 m0, s55, 3072
    s_add_u32 s56, s29, 12288
    buffer_load_dwordx4 v1, s[40:43], s56 offen sc1 lds
    s_add_u32 s29, s29, 16384
    s_barrier
    s_barrier
    s_waitcnt vmcnt(4)
    s_barrier
L_l_g3go:
    s_mov_b32 s53, 0
    s_add_u32 s55, s53, s27
    s_add_u32 m0, s55, 0
    s_add_u32 s56, s29, 0
    buffer_load_dwordx4 v1, s[40:43], s56 offen sc1 lds
    s_add_u32 m0, s55, 1024
    s_add_u32 s56, s29, 4096
    buffer_load_dwordx4 v1, s[40:43], s56 offen sc1 lds
    s_add_u32 m0, s55, 2048
    s_add_u32 s56, s29, 8192
    buffer_load_dwordx4 v1, s[40:43], s56 offen sc1 lds
    s_add_u32 m0, s55, 3072
    s_add_u32 s56, s29, 12288
    buffer_load_dwordx4 v1, s[40:43], s56 offen sc1 lds
    s_add_u32 s29, s29, 16384
    s_add_u32 s55, s53, s24
    s_add_u32 m0, s55, 0
    s_add_u32 s56, s28, 0
    buffer_load_dwordx4 v1, s[40:43], s56 offen sc1 lds
    s_add_u32 m0, s55, 1024
    s_add_u32 s56, s28, 1024
    buffer_load_dwordx4 v1, s[40:43], s56 offen sc1 lds
    s_add_u32 m0, s55, 2048
    s_add_u32 s56, s28, 2048
    buffer_load_dwordx4 v1, s[40:43], s56 offen sc1 lds
    s_add_u32 m0, s55, 3072
    s_add_u32 s56, s28, 3072
    buffer_load_dwordx4 v1, s[40:43], s56 offen sc1 lds
    s_add_u32 m0, s55, 4096
    s_add_u32 s56, s28, 4096
    s_bitcmp1_b32 s19, 0
    s_cbranch_scc1 L_sk_4
    buffer_load_dwordx4 v1, s[40:43], s56 offen sc1 lds
L_sk_4:
    s_add_u32 s28, s28, 147456
    s_add_u32 s53, s53, 36864
    s_cmp_ge_u32 s53, 147456
    s_cselect_b32 s53, 0, s53
    s_mov_b32 s54, 1
L_l_g3:
    s_waitcnt vmcnt(8)
    s_barrier
    s_add_u32 s55, s53, s27
    s_add_u32 m0, s55, 0
    s_add_u32 s56, s29, 0
    buffer_load_dwordx4 v1, s[40:43], s56 offen sc1 lds
    s_add_u32 m0, s55, 1024
    s_add_u32 s56, s29, 4096
    buffer_load_dwordx4 v1, s[40:43], s56 offen sc1 lds
    s_add_u32 m0, s55, 2048
    s_add_u32 s56, s29, 8192
    buffer_load_dwordx4 v1, s[40:43], s56 offen sc1 lds
    s_add_u32 m0, s55, 3072
    s_add_u32 s56, s29, 12288
    buffer_load_dwordx4 v1, s[40:43], s56 offen sc1 lds
    s_add_u32 s29, s29, 16384
    s_add_u32 s55, s53, s24
    s_add_u32 m0, s55, 0
    s_add_u32 s56, s28, 0
    buffer_load_dwordx4 v1, s[40:43], s56 offen sc1 lds
    s_add_u32 m0, s55, 1024
    s_add_u32 s56, s28, 1024
    buffer_load_dwordx4 v1, s[40:43], s56 offen sc1 lds
    s_add_u32 m0, s55, 2048
    s_add_u32 s56, s28, 2048
    buffer_load_dwordx4 v1, s[40:43], s56 offen sc1 lds
    s_add_u32 m0, s55, 3072
    s_add_u32 s56, s28, 3072
    buffer_load_dwordx4 v1, s[40:43], s56 offen sc1 lds
    s_add_u32 m0, s55, 4096
    s_add_u32 s56, s28, 4096
    s_bitcmp1_b32 s19, 0
    s_cbranch_scc1 L_sk_5
    buffer_load_dwordx4 v1, s[40:43], s56 offen sc1 lds
L_sk_5:
    s_add_u32 s28, s28, 147456
    s_add_u32 s53, s53, 36864
    s_cmp_ge_u32 s53, 147456
    s_cselect_b32 s53, 0, s53
    s_cmp_lg_u32 s54, 2
    s_cbranch_scc1 L_l_g3nf
    s_cmp_lg_u32 s21, 0
    s_cbranch_scc1 L_l_g3nf
    s_lshl_b32 s58, s2, 2
    s_add_u32 s58, s58, 40321024
    v_mov_b32 v230, 0
    v_mov_b32 v231, s52
    s_mov_b64 exec, 1
    buffer_store_dword v231, v230, s[40:43], s58 offen sc1
    s_mov_b64 exec, -1
L_l_g3nf:
    s_add_u32 s54, s54, 1
    s_cmp_lt_u32 s54, 16
    s_cbranch_scc1 L_l_g3
    s_waitcnt vmcnt(8)
    s_barrier
    s_mov_b32 s58, 40321024
    s_mov_b32 s59, 0
L_poll_fx:
    buffer_load_dwordx4 v[4:7], v1, s[40:43], s58 offen sc1
    s_waitcnt vmcnt(0)
    v_xor_b32 v4, s52, v4
    v_xor_b32 v5, s52, v5
    v_xor_b32 v6, s52, v6
    v_xor_b32 v7, s52, v7
    v_or3_b32 v4, v4, v5, v6
    v_or_b32 v4, v4, v7
    v_cmp_ne_u32 vcc, 0, v4
    s_add_u32 s59, s59, 1
    s_nop 1
    s_cbranch_vccz L_polled_fx
    s_sleep 1
    s_cmp_lt_u32 s59, 0x20000
    s_cbranch_scc1 L_poll_fx
L_polled_fx:
    v_lshrrev_b32 v5, 3, v3
    v_lshlrev_b32 v5, 12, v5
    v_and_b32 v6, 7, v3
    v_lshl_add_u32 v5, v6, 4, v5
    s_lshl_b32 s55, s15, 16
    s_lshl_b32 s56, s18, 7
    s_add_u32 s55, s55, s56
    s_lshl_b32 s56, s21, 15
    s_add_u32 s55, s55, s56
    s_add_u32 s55, s55, 45613056
    s_add_u32 m0, s26, 147456
    s_add_u32 s56, s55, 0
    buffer_load_dwordx4 v5, s[40:43], s56 offen sc1 lds
    s_add_u32 m0, s26, 151552
    s_add_u32 s56, s55, 131072
    buffer_load_dwordx4 v5, s[40:43], s56 offen sc1 lds
    s_add_u32 m0, s26, 155648
    s_add_u32 s56, s55, 262144
    buffer_load_dwordx4 v5, s[40:43], s56 offen sc1 lds
    s_barrier
    s_waitcnt vmcnt(0)
    s_barrier
    s_endpgm
L_conv2:
    s_and_b32 s57, s21, 1
    v_lshrrev_b32 v13, 4, v3
    v_and_b32 v12, 15, v3
    s_lshl_b32 s55, s57, 11
    s_add_u32 s55, s55, s22
    v_add_u32 v7, s55, v1
    ds_read_b128 v[16:19], v7 offset:32
    ds_read_b128 v[20:23], v7 offset:48
    ds_read_b128 v[48:51], v7 offset:1056
    ds_read_b128 v[52:55], v7 offset:1072
    v_and_b32 v5, 7, v3
    v_sub_u32 v5, 7, v5
    v_mul_u32_u24 v5, 4160, v5
    v_bfe_u32 v6, v3, 3, 1
    v_sub_u32 v6, v6, v13
    v_add_u32 v6, 3, v6
    v_lshl_add_u32 v5, v6, 4, v5
    s_lshl_b32 s55, s57, 6
    s_add_u32 s55, s55, s22
    v_add_u32 v5, s55, v5
    v_mul_u32_u24 v6, 1280, v13
    v_lshl_add_u32 v6, v12, 4, v6
    s_lshl_b32 s55, s57, 4
    s_sub_u32 s55, s63, s55
    s_sub_u32 s55, s55, 736
    v_add_u32 v6, s55, v6
    s_waitcnt lgkmcnt(2)
    ds_write_b128 v7, v[18:21] offset:16688
    v_mov_b32 v24, v17
    v_mov_b32 v25, v18
    v_mov_b32 v26, v19
    v_mov_b32 v27, v20
    v_mov_b32 v28, v21
    v_mov_b32 v29, v22
    ds_write_b128 v7, v[26:29] offset:8368
    ds_write_b128 v7, v[24:27] offset:25008
    v_alignbit_b32 v30, v17, v16, 16
    v_alignbit_b32 v31, v18, v17, 16
    v_alignbit_b32 v32, v19, v18, 16
    v_alignbit_b32 v33, v20, v19, 16
    v_alignbit_b32 v34, v21, v20, 16
    v_alignbit_b32 v35, v22, v21, 16
    ds_write_b128 v7, v[32:35] offset:12528
    ds_write_b128 v7, v[30:33] offset:29168
    v_alignbit_b32 v36, v18, v17, 16
    v_alignbit_b32 v37, v19, v18, 16
    v_alignbit_b32 v38, v20, v19, 16
    v_alignbit_b32 v39, v21, v20, 16
    v_alignbit_b32 v40, v22, v21, 16
    v_alignbit_b32 v41, v23, v22, 16
    ds_write_b128 v7, v[38:41] offset:4208
    ds_write_b128 v7, v[36:39] offset:20848
    s_waitcnt lgkmcnt(7)
    ds_write_b128 v7, v[50:53] offset:17712
    v_mov_b32 v56, v49
    v_mov_b32 v57, v50
    v_mov_b32 v58, v51
    v_mov_b32 v59, v52
    v_mov_b32 v60, v53
    v_mov_b32 v61, v54
    ds_write_b128 v7, v[58:61] offset:9392
    ds_write_b128 v7, v[56:59] offset:26032
    v_alignbit_b32 v62, v49, v48, 16
    v_alignbit_b32 v63, v50, v49, 16
    v_alignbit_b32 v64, v51, v50, 16
    v_alignbit_b32 v65, v52, v51, 16
    v_alignbit_b32 v66, v53, v52, 16
    v_alignbit_b32 v67, v54, v53, 16
    ds_write_b128 v7, v[64:67] offset:13552
    ds_write_b128 v7, v[62:65] offset:30192
    v_alignbit_b32 v68, v50, v49, 16
    v_alignbit_b32 v69, v51, v50, 16
    v_alignbit_b32 v70, v52, v51, 16
    v_alignbit_b32 v71, v53, v52, 16
    v_alignbit_b32 v72, v54, v53, 16
    v_alignbit_b32 v73, v55, v54, 16
    ds_write_b128 v7, v[70:73] offset:5232
    ds_write_b128 v7, v[68:71] offset:21872
    v_mov_b32 v96, 0
    v_mov_b32 v97, 0
    v_mov_b32 v98, 0
    v_mov_b32 v99, 0
    v_mov_b32 v100, 0
    v_mov_b32 v101, 0
    v_mov_b32 v102, 0
    v_mov_b32 v103, 0
    v_mov_b32 v104, 0
    v_mov_b32 v105, 0
    v_mov_b32 v106, 0
    v_mov_b32 v107, 0
    v_mov_b32 v108, 0
    v_mov_b32 v109, 0
    v_mov_b32 v110, 0
    v_mov_b32 v111, 0
    v_mov_b32 v112, 0
    v_mov_b32 v113, 0
    v_mov_b32 v114, 0
    v_mov_b32 v115, 0
    v_mov_b32 v116, 0
    v_mov_b32 v117, 0
    v_mov_b32 v118, 0
    v_mov_b32 v119, 0
    v_mov_b32 v120, 0
    v_mov_b32 v121, 0
    v_mov_b32 v122, 0
    v_mov_b32 v123, 0
    v_mov_b32 v124, 0
    v_mov_b32 v125, 0
    v_mov_b32 v126, 0
    v_mov_b32 v127, 0
    s_waitcnt lgkmcnt(0)
    s_barrier
    ds_read_b128 v[16:19], v5 offset:0
    ds_read_b128 v[20:23], v5 offset:32
    ds_read_b128 v[24:27], v6 offset:992
    ds_read_b128 v[28:31], v6 offset:1248
    ds_read_b128 v[32:35], v6 offset:1504
    ds_read_b128 v[36:39], v6 offset:1760
    ds_read_b128 v[40:43], v5 offset:128
    ds_read_b128 v[44:47], v5 offset:160
    ds_read_b128 v[48:51], v6 offset:960
    ds_read_b128 v[52:55], v6 offset:1216
    ds_read_b128 v[56:59], v6 offset:1472
    ds_read_b128 v[60:63], v6 offset:1728
    s_waitcnt lgkmcnt(6)
    v_mfma_f32_16x16x32_bf16 v[96:99], v[16:19], v[24:27], v[96:99]
    ds_read_b128 v[64:67], v5 offset:256
    v_mfma_f32_16x16x32_bf16 v[100:103], v[20:23], v[24:27], v[100:103]
    ds_read_b128 v[68:71], v5 offset:288
    v_mfma_f32_16x16x32_bf16 v[104:107], v[16:19], v[28:31], v[104:107]
    ds_read_b128 v[72:75], v6 offset:928
    v_mfma_f32_16x16x32_bf16 v[108:111], v[20:23], v[28:31], v[108:111]
    ds_read_b128 v[76:79], v6 offset:1184
    v_mfma_f32_16x16x32_bf16 v[112:115], v[16:19], v[32:35], v[112:115]
    ds_read_b128 v[80:83], v6 offset:1440
    v_mfma_f32_16x16x32_bf16 v[116:119], v[20:23], v[32:35], v[116:119]
    ds_read_b128 v[84:87], v6 offset:1696
    v_mfma_f32_16x16x32_bf16 v[120:123], v[16:19], v[36:39], v[120:123]
    v_mfma_f32_16x16x32_bf16 v[124:127], v[20:23], v[36:39], v[124:127]
    s_waitcnt lgkmcnt(6)
    v_mfma_f32_16x16x32_bf16 v[96:99], v[40:43], v[48:51], v[96:99]
    ds_read_b128 v[16:19], v5 offset:384
    v_mfma_f32_16x16x32_bf16 v[100:103], v[44:47], v[48:51], v[100:103]
    ds_read_b128 v[20:23], v5 offset:416
    v_mfma_f32_16x16x32_bf16 v[104:107], v[40:43], v[52:55], v[104:107]
    ds_read_b128 v[24:27], v6 offset:896
    v_mfma_f32_16x16x32_bf16 v[108:111], v[44:47], v[52:55], v[108:111]
    ds_read_b128 v[28:31], v6 offset:1152
    v_mfma_f32_16x16x32_bf16 v[112:115], v[40:43], v[56:59], v[112:115]
    ds_read_b128 v[32:35], v6 offset:1408
    v_mfma_f32_16x16x32_bf16 v[116:119], v[44:47], v[56:59], v[116:119]
    ds_read_b128 v[36:39], v6 offset:1664
    v_mfma_f32_16x16x32_bf16 v[120:123], v[40:43], v[60:63], v[120:123]
    v_mfma_f32_16x16x32_bf16 v[124:127], v[44:47], v[60:63], v[124:127]
    s_cmp_lg_u32 s65, 1
    s_cbranch_scc1 L_c2_nf
    s_waitcnt vmcnt(0)
    s_mov_b32 s58, s61
    v_mov_b32 v230, 0
    v_mov_b32 v231, s52
    s_mov_b64 exec, 1
    buffer_store_dword v231, v230, s[40:43], s58 offen sc1
    s_mov_b64 exec, -1
L_c2_nf:
    s_waitcnt lgkmcnt(6)
    v_mfma_f32_16x16x32_bf16 v[96:99], v[64:67], v[72:75], v[96:99]
    ds_read_b128 v[40:43], v5 offset:512
    v_mfma_f32_16x16x32_bf16 v[100:103], v[68:71], v[72:75], v[100:103]
    ds_read_b128 v[44:47], v5 offset:544
    v_mfma_f32_16x16x32_bf16 v[104:107], v[64:67], v[76:79], v[104:107]
    ds_read_b128 v[48:51], v6 offset:864
    v_mfma_f32_16x16x32_bf16 v[108:111], v[68:71], v[76:79], v[108:111]
    ds_read_b128 v[52:55], v6 offset:1120
    v_mfma_f32_16x16x32_bf16 v[112:115], v[64:67], v[80:83], v[112:115]
    ds_read_b128 v[56:59], v6 offset:1376
    v_mfma_f32_16x16x32_bf16 v[116:119], v[68:71], v[80:83], v[116:119]
    ds_read_b128 v[60:63], v6 offset:1632
    v_mfma_f32_16x16x32_bf16 v[120:123], v[64:67], v[84:87], v[120:123]
    v_mfma_f32_16x16x32_bf16 v[124:127], v[68:71], v[84:87], v[124:127]
    s_waitcnt lgkmcnt(6)
    v_mfma_f32_16x16x32_bf16 v[96:99], v[16:19], v[24:27], v[96:99]
    ds_read_b128 v[64:67], v5 offset:640
    v_mfma_f32_16x16x32_bf16 v[100:103], v[20:23], v[24:27], v[100:103]
    ds_read_b128 v[68:71], v5 offset:672
    v_mfma_f32_16x16x32_bf16 v[104:107], v[16:19], v[28:31], v[104:107]
    ds_read_b128 v[72:75], v6 offset:832
    v_mfma_f32_16x16x32_bf16 v[108:111], v[20:23], v[28:31], v[108:111]
    ds_read_b128 v[76:79], v6 offset:1088
    v_mfma_f32_16x16x32_bf16 v[112:115], v[16:19], v[32:35], v[112:115]
    ds_read_b128 v[80:83], v6 offset:1344
    v_mfma_f32_16x16x32_bf16 v[116:119], v[20:23], v[32:35], v[116:119]
    ds_read_b128 v[84:87], v6 offset:1600
    v_mfma_f32_16x16x32_bf16 v[120:123], v[16:19], v[36:39], v[120:123]
    v_mfma_f32_16x16x32_bf16 v[124:127], v[20:23], v[36:39], v[124:127]
    s_waitcnt lgkmcnt(6)
    v_mfma_f32_16x16x32_bf16 v[96:99], v[40:43], v[48:51], v[96:99]
    ds_read_b128 v[16:19], v5 offset:768
    v_mfma_f32_16x16x32_bf16 v[100:103], v[44:47], v[48:51], v[100:103]
    ds_read_b128 v[20:23], v5 offset:800
    v_mfma_f32_16x16x32_bf16 v[104:107], v[40:43], v[52:55], v[104:107]
    ds_read_b128 v[24:27], v6 offset:800
    v_mfma_f32_16x16x32_bf16 v[108:111], v[44:47], v[52:55], v[108:111]
    ds_read_b128 v[28:31], v6 offset:1056
    v_mfma_f32_16x16x32_bf16 v[112:115], v[40:43], v[56:59], v[112:115]
    ds_read_b128 v[32:35], v6 offset:1312
    v_mfma_f32_16x16x32_bf16 v[116:119], v[44:47], v[56:59], v[116:119]
    ds_read_b128 v[36:39], v6 offset:1568
    v_mfma_f32_16x16x32_bf16 v[120:123], v[40:43], v[60:63], v[120:123]
    v_mfma_f32_16x16x32_bf16 v[124:127], v[44:47], v[60:63], v[124:127]
    s_waitcnt lgkmcnt(6)
    v_mfma_f32_16x16x32_bf16 v[96:99], v[64:67], v[72:75], v[96:99]
    ds_read_b128 v[40:43], v5 offset:896
    v_mfma_f32_16x16x32_bf16 v[100:103], v[68:71], v[72:75], v[100:103]
    ds_read_b128 v[44:47], v5 offset:928
    v_mfma_f32_16x16x32_bf16 v[104:107], v[64:67], v[76:79], v[104:107]
    ds_read_b128 v[48:51], v6 offset:768
    v_mfma_f32_16x16x32_bf16 v[108:111], v[68:71], v[76:79], v[108:111]
    ds_read_b128 v[52:55], v6 offset:1024
    v_mfma_f32_16x16x32_bf16 v[112:115], v[64:67], v[80:83], v[112:115]
    ds_read_b128 v[56:59], v6 offset:1280
    v_mfma_f32_16x16x32_bf16 v[116:119], v[68:71], v[80:83], v[116:119]
    ds_read_b128 v[60:63], v6 offset:1536
    v_mfma_f32_16x16x32_bf16 v[120:123], v[64:67], v[84:87], v[120:123]
    v_mfma_f32_16x16x32_bf16 v[124:127], v[68:71], v[84:87], v[124:127]
    s_waitcnt lgkmcnt(6)
    v_mfma_f32_16x16x32_bf16 v[96:99], v[16:19], v[24:27], v[96:99]
    ds_read_b128 v[64:67], v5 offset:1024
    v_mfma_f32_16x16x32_bf16 v[100:103], v[20:23], v[24:27], v[100:103]
    ds_read_b128 v[68:71], v5 offset:1056
    v_mfma_f32_16x16x32_bf16 v[104:107], v[16:19], v[28:31], v[104:107]
    ds_read_b128 v[76:79], v6 offset:992
    v_mfma_f32_16x16x32_bf16 v[108:111], v[20:23], v[28:31], v[108:111]
    ds_read_b128 v[80:83], v6 offset:1248
    v_mfma_f32_16x16x32_bf16 v[112:115], v[16:19], v[32:35], v[112:115]
    ds_read_b128 v[84:87], v6 offset:1504
    v_mfma_f32_16x16x32_bf16 v[116:119], v[20:23], v[32:35], v[116:119]
    v_mfma_f32_16x16x32_bf16 v[120:123], v[16:19], v[36:39], v[120:123]
    v_mfma_f32_16x16x32_bf16 v[124:127], v[20:23], v[36:39], v[124:127]
    s_waitcnt lgkmcnt(5)
    v_mfma_f32_16x16x32_bf16 v[96:99], v[40:43], v[48:51], v[96:99]
    ds_read_b128 v[16:19], v5 offset:1152
    v_mfma_f32_16x16x32_bf16 v[100:103], v[44:47], v[48:51], v[100:103]
    ds_read_b128 v[20:23], v5 offset:1184
    v_mfma_f32_16x16x32_bf16 v[104:107], v[40:43], v[52:55], v[104:107]
    ds_read_b128 v[28:31], v6 offset:960
    v_mfma_f32_16x16x32_bf16 v[108:111], v[44:47], v[52:55], v[108:111]
    ds_read_b128 v[32:35], v6 offset:1216
    v_mfma_f32_16x16x32_bf16 v[112:115], v[40:43], v[56:59], v[112:115]
    ds_read_b128 v[36:39], v6 offset:1472
    v_mfma_f32_16x16x32_bf16 v[116:119], v[44:47], v[56:59], v[116:119]
    v_mfma_f32_16x16x32_bf16 v[120:123], v[40:43], v[60:63], v[120:123]
    v_mfma_f32_16x16x32_bf16 v[124:127], v[44:47], v[60:63], v[124:127]
    s_waitcnt lgkmcnt(5)
    v_mfma_f32_16x16x32_bf16 v[104:107], v[64:67], v[76:79], v[104:107]
    ds_read_b128 v[40:43], v5 offset:1280
    v_mfma_f32_16x16x32_bf16 v[108:111], v[68:71], v[76:79], v[108:111]
    ds_read_b128 v[44:47], v5 offset:1312
    v_mfma_f32_16x16x32_bf16 v[112:115], v[64:67], v[80:83], v[112:115]
    ds_read_b128 v[52:55], v6 offset:928
    v_mfma_f32_16x16x32_bf16 v[116:119], v[68:71], v[80:83], v[116:119]
    ds_read_b128 v[56:59], v6 offset:1184
    v_mfma_f32_16x16x32_bf16 v[120:123], v[64:67], v[84:87], v[120:123]
    ds_read_b128 v[60:63], v6 offset:1440
    v_mfma_f32_16x16x32_bf16 v[124:127], v[68:71], v[84:87], v[124:127]
    s_waitcnt lgkmcnt(5)
    v_mfma_f32_16x16x32_bf16 v[104:107], v[16:19], v[28:31], v[104:107]
    ds_read_b128 v[64:67], v5 offset:1408
    v_mfma_f32_16x16x32_bf16 v[108:111], v[20:23], v[28:31], v[108:111]
    ds_read_b128 v[68:71], v5 offset:1440
    v_mfma_f32_16x16x32_bf16 v[112:115], v[16:19], v[32:35], v[112:115]
    ds_read_b128 v[76:79], v6 offset:896
    v_mfma_f32_16x16x32_bf16 v[116:119], v[20:23], v[32:35], v[116:119]
    ds_read_b128 v[80:83], v6 offset:1152
    v_mfma_f32_16x16x32_bf16 v[120:123], v[16:19], v[36:39], v[120:123]
    ds_read_b128 v[84:87], v6 offset:1408
    v_mfma_f32_16x16x32_bf16 v[124:127], v[20:23], v[36:39], v[124:127]
    s_waitcnt lgkmcnt(5)
    v_mfma_f32_16x16x32_bf16 v[104:107], v[40:43], v[52:55], v[104:107]
    ds_read_b128 v[16:19], v5 offset:1536
    v_mfma_f32_16x16x32_bf16 v[108:111], v[44:47], v[52:55], v[108:111]
    ds_read_b128 v[20:23], v5 offset:1568
    v_mfma_f32_16x16x32_bf16 v[112:115], v[40:43], v[56:59], v[112:115]
    ds_read_b128 v[28:31], v6 offset:864
    v_mfma_f32_16x16x32_bf16 v[116:119], v[44:47], v[56:59], v[116:119]
    ds_read_b128 v[32:35], v6 offset:1120
    v_mfma_f32_16x16x32_bf16 v[120:123], v[40:43], v[60:63], v[120:123]
    ds_read_b128 v[36:39], v6 offset:1376
    v_mfma_f32_16x16x32_bf16 v[124:127], v[44:47], v[60:63], v[124:127]
    s_waitcnt lgkmcnt(5)
    v_mfma_f32_16x16x32_bf16 v[104:107], v[64:67], v[76:79], v[104:107]
    ds_read_b128 v[40:43], v5 offset:1664
    v_mfma_f32_16x16x32_bf16 v[108:111], v[68:71], v[76:79], v[108:111]
    ds_read_b128 v[44:47], v5 offset:1696
    v_mfma_f32_16x16x32_bf16 v[112:115], v[64:67], v[80:83], v[112:115]
    ds_read_b128 v[52:55], v6 offset:832
    v_mfma_f32_16x16x32_bf16 v[116:119], v[68:71], v[80:83], v[116:119]
    ds_read_b128 v[56:59], v6 offset:1088
    v_mfma_f32_16x16x32_bf16 v[120:123], v[64:67], v[84:87], v[120:123]
    ds_read_b128 v[60:63], v6 offset:1344
    v_mfma_f32_16x16x32_bf16 v[124:127], v[68:71], v[84:87], v[124:127]
    s_waitcnt lgkmcnt(5)
    v_mfma_f32_16x16x32_bf16 v[104:107], v[16:19], v[28:31], v[104:107]
    ds_read_b128 v[64:67], v5 offset:1792
    v_mfma_f32_16x16x32_bf16 v[108:111], v[20:23], v[28:31], v[108:111]
    ds_read_b128 v[68:71], v5 offset:1824
    v_mfma_f32_16x16x32_bf16 v[112:115], v[16:19], v[32:35], v[112:115]
    ds_read_b128 v[76:79], v6 offset:800
    v_mfma_f32_16x16x32_bf16 v[116:119], v[20:23], v[32:35], v[116:119]
    ds_read_b128 v[80:83], v6 offset:1056
    v_mfma_f32_16x16x32_bf16 v[120:123], v[16:19], v[36:39], v[120:123]
    ds_read_b128 v[84:87], v6 offset:1312
    v_mfma_f32_16x16x32_bf16 v[124:127], v[20:23], v[36:39], v[124:127]
    s_waitcnt lgkmcnt(5)
    v_mfma_f32_16x16x32_bf16 v[104:107], v[40:43], v[52:55], v[104:107]
    ds_read_b128 v[16:19], v5 offset:1920
    v_mfma_f32_16x16x32_bf16 v[108:111], v[44:47], v[52:55], v[108:111]
    ds_read_b128 v[20:23], v5 offset:1952
    v_mfma_f32_16x16x32_bf16 v[112:115], v[40:43], v[56:59], v[112:115]
    ds_read_b128 v[28:31], v6 offset:768
    v_mfma_f32_16x16x32_bf16 v[116:119], v[44:47], v[56:59], v[116:119]
    ds_read_b128 v[32:35], v6 offset:1024
    v_mfma_f32_16x16x32_bf16 v[120:123], v[40:43], v[60:63], v[120:123]
    ds_read_b128 v[36:39], v6 offset:1280
    v_mfma_f32_16x16x32_bf16 v[124:127], v[44:47], v[60:63], v[124:127]
    s_waitcnt lgkmcnt(5)
    v_mfma_f32_16x16x32_bf16 v[104:107], v[64:67], v[76:79], v[104:107]
    ds_read_b128 v[40:43], v5 offset:2048
    v_mfma_f32_16x16x32_bf16 v[108:111], v[68:71], v[76:79], v[108:111]
    ds_read_b128 v[44:47], v5 offset:2080
    v_mfma_f32_16x16x32_bf16 v[112:115], v[64:67], v[80:83], v[112:115]
    ds_read_b128 v[56:59], v6 offset:992
    v_mfma_f32_16x16x32_bf16 v[116:119], v[68:71], v[80:83], v[116:119]
    ds_read_b128 v[60:63], v6 offset:1248
    v_mfma_f32_16x16x32_bf16 v[120:123], v[64:67], v[84:87], v[120:123]
    v_mfma_f32_16x16x32_bf16 v[124:127], v[68:71], v[84:87], v[124:127]
    s_waitcnt lgkmcnt(4)
    v_mfma_f32_16x16x32_bf16 v[104:107], v[16:19], v[28:31], v[104:107]
    ds_read_b128 v[64:67], v5 offset:2176
    v_mfma_f32_16x16x32_bf16 v[108:111], v[20:23], v[28:31], v[108:111]
    ds_read_b128 v[68:71], v5 offset:2208
    v_mfma_f32_16x16x32_bf16 v[112:115], v[16:19], v[32:35], v[112:115]
    ds_read_b128 v[80:83], v6 offset:960
    v_mfma_f32_16x16x32_bf16 v[116:119], v[20:23], v[32:35], v[116:119]
    ds_read_b128 v[84:87], v6 offset:1216
    v_mfma_f32_16x16x32_bf16 v[120:123], v[16:19], v[36:39], v[120:123]
    v_mfma_f32_16x16x32_bf16 v[124:127], v[20:23], v[36:39], v[124:127]
    s_waitcnt lgkmcnt(4)
    v_mfma_f32_16x16x32_bf16 v[112:115], v[40:43], v[56:59], v[112:115]
    ds_read_b128 v[16:19], v5 offset:2304
    v_mfma_f32_16x16x32_bf16 v[116:119], v[44:47], v[56:59], v[116:119]
    ds_read_b128 v[20:23], v5 offset:2336
    v_mfma_f32_16x16x32_bf16 v[120:123], v[40:43], v[60:63], v[120:123]
    ds_read_b128 v[32:35], v6 offset:928
    v_mfma_f32_16x16x32_bf16 v[124:127], v[44:47], v[60:63], v[124:127]
    ds_read_b128 v[36:39], v6 offset:1184
    s_waitcnt lgkmcnt(4)
    v_mfma_f32_16x16x32_bf16 v[112:115], v[64:67], v[80:83], v[112:115]
    ds_read_b128 v[40:43], v5 offset:2432
    v_mfma_f32_16x16x32_bf16 v[116:119], v[68:71], v[80:83], v[116:119]
    ds_read_b128 v[44:47], v5 offset:2464
    v_mfma_f32_16x16x32_bf16 v[120:123], v[64:67], v[84:87], v[120:123]
    ds_read_b128 v[56:59], v6 offset:896
    v_mfma_f32_16x16x32_bf16 v[124:127], v[68:71], v[84:87], v[124:127]
    ds_read_b128 v[60:63], v6 offset:1152
    s_waitcnt lgkmcnt(4)
    v_mfma_f32_16x16x32_bf16 v[112:115], v[16:19], v[32:35], v[112:115]
    ds_read_b128 v[64:67], v5 offset:2560
    v_mfma_f32_16x16x32_bf16 v[116:119], v[20:23], v[32:35], v[116:119]
    ds_read_b128 v[68:71], v5 offset:2592
    v_mfma_f32_16x16x32_bf16 v[120:123], v[16:19], v[36:39], v[120:123]
    ds_read_b128 v[80:83], v6 offset:864
    v_mfma_f32_16x16x32_bf16 v[124:127], v[20:23], v[36:39], v[124:127]
    ds_read_b128 v[84:87], v6 offset:1120
    s_waitcnt lgkmcnt(4)
    v_mfma_f32_16x16x32_bf16 v[112:115], v[40:43], v[56:59], v[112:115]
    ds_read_b128 v[16:19], v5 offset:2688
    v_mfma_f32_16x16x32_bf16 v[116:119], v[44:47], v[56:59], v[116:119]
    ds_read_b128 v[20:23], v5 offset:2720
    v_mfma_f32_16x16x32_bf16 v[120:123], v[40:43], v[60:63], v[120:123]
    ds_read_b128 v[32:35], v6 offset:832
    v_mfma_f32_16x16x32_bf16 v[124:127], v[44:47], v[60:63], v[124:127]
    ds_read_b128 v[36:39], v6 offset:1088
    s_waitcnt lgkmcnt(4)
    v_mfma_f32_16x16x32_bf16 v[112:115], v[64:67], v[80:83], v[112:115]
    ds_read_b128 v[40:43], v5 offset:2816
    v_mfma_f32_16x16x32_bf16 v[116:119], v[68:71], v[80:83], v[116:119]
    ds_read_b128 v[44:47], v5 offset:2848
    v_mfma_f32_16x16x32_bf16 v[120:123], v[64:67], v[84:87], v[120:123]
    ds_read_b128 v[56:59], v6 offset:800
    v_mfma_f32_16x16x32_bf16 v[124:127], v[68:71], v[84:87], v[124:127]
    ds_read_b128 v[60:63], v6 offset:1056
    s_waitcnt lgkmcnt(4)
    v_mfma_f32_16x16x32_bf16 v[112:115], v[16:19], v[32:35], v[112:115]
    ds_read_b128 v[64:67], v5 offset:2944
    v_mfma_f32_16x16x32_bf16 v[116:119], v[20:23], v[32:35], v[116:119]
    ds_read_b128 v[68:71], v5 offset:2976
    v_mfma_f32_16x16x32_bf16 v[120:123], v[16:19], v[36:39], v[120:123]
    ds_read_b128 v[80:83], v6 offset:768
    v_mfma_f32_16x16x32_bf16 v[124:127], v[20:23], v[36:39], v[124:127]
    ds_read_b128 v[84:87], v6 offset:1024
    s_waitcnt lgkmcnt(4)
    v_mfma_f32_16x16x32_bf16 v[112:115], v[40:43], v[56:59], v[112:115]
    ds_read_b128 v[16:19], v5 offset:3072
    v_mfma_f32_16x16x32_bf16 v[116:119], v[44:47], v[56:59], v[116:119]
    ds_read_b128 v[20:23], v5 offset:3104
    v_mfma_f32_16x16x32_bf16 v[120:123], v[40:43], v[60:63], v[120:123]
    ds_read_b128 v[36:39], v6 offset:992
    v_mfma_f32_16x16x32_bf16 v[124:127], v[44:47], v[60:63], v[124:127]
    s_waitcnt lgkmcnt(3)
    v_mfma_f32_16x16x32_bf16 v[112:115], v[64:67], v[80:83], v[112:115]
    ds_read_b128 v[40:43], v5 offset:3200
    v_mfma_f32_16x16x32_bf16 v[116:119], v[68:71], v[80:83], v[116:119]
    ds_read_b128 v[44:47], v5 offset:3232
    v_mfma_f32_16x16x32_bf16 v[120:123], v[64:67], v[84:87], v[120:123]
    ds_read_b128 v[60:63], v6 offset:960
    v_mfma_f32_16x16x32_bf16 v[124:127], v[68:71], v[84:87], v[124:127]
    s_waitcnt lgkmcnt(3)
    v_mfma_f32_16x16x32_bf16 v[120:123], v[16:19], v[36:39], v[120:123]
    ds_read_b128 v[64:67], v5 offset:3328
    v_mfma_f32_16x16x32_bf16 v[124:127], v[20:23], v[36:39], v[124:127]
    ds_read_b128 v[68:71], v5 offset:3360
    ds_read_b128 v[84:87], v6 offset:928
    s_waitcnt lgkmcnt(3)
    v_mfma_f32_16x16x32_bf16 v[120:123], v[40:43], v[60:63], v[120:123]
    ds_read_b128 v[16:19], v5 offset:3456
    v_mfma_f32_16x16x32_bf16 v[124:127], v[44:47], v[60:63], v[124:127]
    ds_read_b128 v[20:23], v5 offset:3488
    ds_read_b128 v[36:39], v6 offset:896
    s_waitcnt lgkmcnt(3)
    v_mfma_f32_16x16x32_bf16 v[120:123], v[64:67], v[84:87], v[120:123]
    ds_read_b128 v[40:43], v5 offset:3584
    v_mfma_f32_16x16x32_bf16 v[124:127], v[68:71], v[84:87], v[124:127]
    ds_read_b128 v[44:47], v5 offset:3616
    ds_read_b128 v[60:63], v6 offset:864
    s_waitcnt lgkmcnt(3)
    v_mfma_f32_16x16x32_bf16 v[120:123], v[16:19], v[36:39], v[120:123]
    ds_read_b128 v[64:67], v5 offset:3712
    v_mfma_f32_16x16x32_bf16 v[124:127], v[20:23], v[36:39], v[124:127]
    ds_read_b128 v[68:71], v5 offset:3744
    ds_read_b128 v[84:87], v6 offset:832
    s_waitcnt lgkmcnt(3)
    v_mfma_f32_16x16x32_bf16 v[120:123], v[40:43], v[60:63], v[120:123]
    ds_read_b128 v[16:19], v5 offset:3840
    v_mfma_f32_16x16x32_bf16 v[124:127], v[44:47], v[60:63], v[124:127]
    ds_read_b128 v[20:23], v5 offset:3872
    ds_read_b128 v[36:39], v6 offset:800
    s_waitcnt lgkmcnt(3)
    v_mfma_f32_16x16x32_bf16 v[120:123], v[64:67], v[84:87], v[120:123]
    ds_read_b128 v[40:43], v5 offset:3968
    v_mfma_f32_16x16x32_bf16 v[124:127], v[68:71], v[84:87], v[124:127]
    ds_read_b128 v[44:47], v5 offset:4000
    ds_read_b128 v[60:63], v6 offset:768
    s_waitcnt lgkmcnt(3)
    v_mfma_f32_16x16x32_bf16 v[120:123], v[16:19], v[36:39], v[120:123]
    v_mfma_f32_16x16x32_bf16 v[124:127], v[20:23], v[36:39], v[124:127]
    s_waitcnt lgkmcnt(0)
    v_mfma_f32_16x16x32_bf16 v[120:123], v[40:43], v[60:63], v[120:123]
    v_mfma_f32_16x16x32_bf16 v[124:127], v[44:47], v[60:63], v[124:127]
    s_lshl_b32 s55, s57, 13
    s_add_u32 s55, s55, s22
    v_add_u32 v9, s55, v1
    s_lshl_b32 s55, s57, 12
    s_add_u32 s55, s55, s22
    v_add_u32 v10, s55, v1
    s_nop 2
    s_barrier
    ds_write_b128 v9, v[96:99] offset:0
    ds_write_b128 v9, v[100:103] offset:1024
    ds_write_b128 v9, v[104:107] offset:2048
    ds_write_b128 v9, v[108:111] offset:3072
    ds_write_b128 v9, v[112:115] offset:4096
    ds_write_b128 v9, v[116:119] offset:5120
    ds_write_b128 v9, v[120:123] offset:6144
    ds_write_b128 v9, v[124:127] offset:7168
    v_lshlrev_b32 v5, 6, v12
    v_and_b32 v6, 1, v13
    v_lshl_add_u32 v5, v6, 5, v5
    v_lshrrev_b32 v6, 1, v13
    v_lshl_add_u32 v5, v6, 4, v5
    s_lshl_b32 s55, s62, 12
    s_lshl_b32 s56, s57, 11
    s_add_u32 s55, s55, s56
    s_add_u32 s55, s55, 45613056
    s_waitcnt lgkmcnt(0)
    s_barrier
    ds_read_b128 v[16:19], v10 offset:0
    ds_read_b128 v[20:23], v10 offset:1024
    ds_read_b128 v[24:27], v10 offset:2048
    ds_read_b128 v[28:31], v10 offset:3072
    ds_read_b128 v[32:35], v10 offset:8192
    ds_read_b128 v[36:39], v10 offset:9216
    ds_read_b128 v[40:43], v10 offset:10240
    ds_read_b128 v[44:47], v10 offset:11264
    s_waitcnt lgkmcnt(0)
    v_pk_add_f32 v[16:17], v[16:17], v[32:33]
    v_pk_add_f32 v[18:19], v[18:19], v[34:35]
    v_pk_add_f32 v[20:21], v[20:21], v[36:37]
    v_pk_add_f32 v[22:23], v[22:23], v[38:39]
    v_pk_add_f32 v[24:25], v[24:25], v[40:41]
    v_pk_add_f32 v[26:27], v[26:27], v[42:43]
    v_pk_add_f32 v[28:29], v[28:29], v[44:45]
    v_pk_add_f32 v[30:31], v[30:31], v[46:47]
    v_cvt_pk_bf16_f32 v48, v16, v17
    v_cvt_pk_bf16_f32 v49, v18, v19
    v_cvt_pk_bf16_f32 v50, v20, v21
    v_cvt_pk_bf16_f32 v51, v22, v23
    v_cvt_pk_bf16_f32 v52, v24, v25
    v_cvt_pk_bf16_f32 v53, v26, v27
    v_cvt_pk_bf16_f32 v54, v28, v29
    v_cvt_pk_bf16_f32 v55, v30, v31
    s_nop 1
    v_permlane16_swap_b32 v48, v50
    v_permlane16_swap_b32 v49, v51
    v_permlane16_swap_b32 v52, v54
    v_permlane16_swap_b32 v53, v55
    s_nop 1
    buffer_store_dwordx4 v[48:51], v5, s[40:43], s55 offen offset:0 sc1
    buffer_store_dwordx4 v[52:55], v5, s[40:43], s55 offen offset:1024 sc1
    s_setpc_b64 s[68:69]
L_job_load:
    s_cmp_eq_u32 s66, 0
    s_cbranch_scc1 L_jl_O
    s_cmp_eq_u32 s66, 1
    s_cbranch_scc1 L_jl_U
    s_cmp_eq_u32 s66, 2
    s_cbranch_scc0 L_jl_ret
    s_mov_b32 s44, s6
    s_mov_b32 s45, s7
    s_mov_b32 s46, 0x480
    s_mov_b32 s47, 0x00020000
    v_and_b32 v5, 7, v3
    v_lshlrev_b32 v5, 4, v5
    v_lshrrev_b32 v7, 3, v3
    v_mul_u32_u24 v8, 1152, v7
    v_add_u32 v8, v8, v5
    s_mul_i32 s55, s67, 9216
    buffer_load_dwordx4 v[16:19], v8, s[32:35], s55 offen offset:0
    buffer_load_dwordx4 v[52:55], v5, s[44:47], 0 offen offset:0
    buffer_load_dwordx4 v[20:23], v8, s[32:35], s55 offen offset:128
    buffer_load_dwordx4 v[56:59], v5, s[44:47], 0 offen offset:128
    buffer_load_dwordx4 v[24:27], v8, s[32:35], s55 offen offset:256
    buffer_load_dwordx4 v[60:63], v5, s[44:47], 0 offen offset:256
    buffer_load_dwordx4 v[28:31], v8, s[32:35], s55 offen offset:384
    buffer_load_dwordx4 v[64:67], v5, s[44:47], 0 offen offset:384
    buffer_load_dwordx4 v[32:35], v8, s[32:35], s55 offen offset:512
    buffer_load_dwordx4 v[68:71], v5, s[44:47], 0 offen offset:512
    buffer_load_dwordx4 v[36:39], v8, s[32:35], s55 offen offset:640
    buffer_load_dwordx4 v[72:75], v5, s[44:47], 0 offen offset:640
    buffer_load_dwordx4 v[40:43], v8, s[32:35], s55 offen offset:768
    buffer_load_dwordx4 v[76:79], v5, s[44:47], 0 offen offset:768
    buffer_load_dwordx4 v[44:47], v8, s[32:35], s55 offen offset:896
    buffer_load_dwordx4 v[80:83], v5, s[44:47], 0 offen offset:896
    buffer_load_dwordx4 v[48:51], v8, s[32:35], s55 offen offset:1024
    buffer_load_dwordx4 v[84:87], v5, s[44:47], 0 offen offset:1024
    s_setpc_b64 s[68:69]
L_jl_O:
    s_mov_b32 s44, s4
    s_mov_b32 s45, s5
    s_mov_b32 s46, 0x288000
    s_mov_b32 s47, 0x00020000
    s_lshr_b32 s55, s67, 2
    s_and_b32 s56, s67, 3
    s_mul_i32 s55, s55, 36864
    s_mul_i32 s56, s56, 288
    s_add_u32 s55, s55, s56
    s_mov_b32 s56, 238609295
    s_movk_i32 s57, 1152
    v_add_u32 v4, 0, v3
    v_mul_hi_u32 v5, v4, s56
    v_mul_u32_u24 v6, 18, v5
    v_sub_u32 v6, v4, v6
    v_mul_u32_u24 v5, s57, v5
    v_lshl_add_u32 v4, v6, 4, v5
    buffer_load_dwordx4 v[16:19], v4, s[44:47], s55 offen nt
    v_add_u32 v4, 64, v3
    v_mul_hi_u32 v5, v4, s56
    v_mul_u32_u24 v6, 18, v5
    v_sub_u32 v6, v4, v6
    v_mul_u32_u24 v5, s57, v5
    v_lshl_add_u32 v4, v6, 4, v5
    buffer_load_dwordx4 v[20:23], v4, s[44:47], s55 offen nt
    v_add_u32 v4, 128, v3
    v_mul_hi_u32 v5, v4, s56
    v_mul_u32_u24 v6, 18, v5
    v_sub_u32 v6, v4, v6
    v_mul_u32_u24 v5, s57, v5
    v_lshl_add_u32 v4, v6, 4, v5
    buffer_load_dwordx4 v[24:27], v4, s[44:47], s55 offen nt
    v_add_u32 v4, 192, v3
    v_mul_hi_u32 v5, v4, s56
    v_mul_u32_u24 v6, 18, v5
    v_sub_u32 v6, v4, v6
    v_mul_u32_u24 v5, s57, v5
    v_lshl_add_u32 v4, v6, 4, v5
    buffer_load_dwordx4 v[28:31], v4, s[44:47], s55 offen nt
    v_add_u32 v4, 256, v3
    v_mul_hi_u32 v5, v4, s56
    v_mul_u32_u24 v6, 18, v5
    v_sub_u32 v6, v4, v6
    v_mul_u32_u24 v5, s57, v5
    v_lshl_add_u32 v4, v6, 4, v5
    buffer_load_dwordx4 v[32:35], v4, s[44:47], s55 offen nt
    v_add_u32 v4, 320, v3
    v_mul_hi_u32 v5, v4, s56
    v_mul_u32_u24 v6, 18, v5
    v_sub_u32 v6, v4, v6
    v_mul_u32_u24 v5, s57, v5
    v_lshl_add_u32 v4, v6, 4, v5
    buffer_load_dwordx4 v[36:39], v4, s[44:47], s55 offen nt
    v_add_u32 v4, 384, v3
    v_mul_hi_u32 v5, v4, s56
    v_mul_u32_u24 v6, 18, v5
    v_sub_u32 v6, v4, v6
    v_mul_u32_u24 v5, s57, v5
    v_lshl_add_u32 v4, v6, 4, v5
    buffer_load_dwordx4 v[40:43], v4, s[44:47], s55 offen nt
    v_add_u32 v4, 448, v3
    v_mul_hi_u32 v5, v4, s56
    v_mul_u32_u24 v6, 18, v5
    v_sub_u32 v6, v4, v6
    v_mul_u32_u24 v5, s57, v5
    v_lshl_add_u32 v4, v6, 4, v5
    buffer_load_dwordx4 v[44:47], v4, s[44:47], s55 offen nt
    v_add_u32 v4, 512, v3
    v_mul_hi_u32 v5, v4, s56
    v_mul_u32_u24 v6, 18, v5
    v_sub_u32 v6, v4, v6
    v_mul_u32_u24 v5, s57, v5
    v_lshl_add_u32 v4, v6, 4, v5
    buffer_load_dwordx4 v[48:51], v4, s[44:47], s55 offen nt
    s_setpc_b64 s[68:69]
L_jl_U:
    s_mul_i32 s55, s67, 7282
    s_lshr_b32 s55, s55, 16
    s_mul_i32 s56, s55, 9
    s_sub_u32 s56, s67, s56
    s_mul_i32 s57, s55, 73728
    s_lshl_b32 s58, s56, 7
    s_add_u32 s57, s57, s58
    v_lshrrev_b32 v4, 3, v3
    v_mul_u32_u24 v4, 1152, v4
    v_and_b32 v5, 7, v3
    v_lshl_add_u32 v4, v5, 4, v4
    s_add_u32 s58, s57, 0
    buffer_load_dwordx4 v[16:19], v4, s[32:35], s58 offen
    s_add_u32 s58, s57, 9216
    buffer_load_dwordx4 v[20:23], v4, s[32:35], s58 offen
    s_add_u32 s58, s57, 18432
    buffer_load_dwordx4 v[24:27], v4, s[32:35], s58 offen
    s_add_u32 s58, s57, 27648
    buffer_load_dwordx4 v[28:31], v4, s[32:35], s58 offen
    s_add_u32 s58, s57, 36864
    buffer_load_dwordx4 v[32:35], v4, s[32:35], s58 offen
    s_add_u32 s58, s57, 46080
    buffer_load_dwordx4 v[36:39], v4, s[32:35], s58 offen
    s_add_u32 s58, s57, 55296
    buffer_load_dwordx4 v[40:43], v4, s[32:35], s58 offen
    s_add_u32 s58, s57, 64512
    buffer_load_dwordx4 v[44:47], v4, s[32:35], s58 offen
L_jl_ret:
    s_setpc_b64 s[68:69]
L_job_proc:
    s_and_b32 s22, s21, 1
    s_mul_i32 s22, s22, 42240
    s_add_u32 s22, s22, 110592
    v_add_u32 v13, s22, v1
    s_mov_b32 s65, 0x40000000
    s_cmp_eq_u32 s66, 0
    s_cbranch_scc1 L_jp_O
    s_cmp_eq_u32 s66, 1
    s_cbranch_scc1 L_jp_U
    s_cmp_eq_u32 s66, 2
    s_cbranch_scc0 L_jp_ret
    v_mov_b32 v9, 0
    v_mov_b32 v10, 0x3f803f80
    v_lshlrev_b32 v92, 16, v16
    v_and_b32 v93, 0xffff0000, v16
    v_lshlrev_b32 v100, 16, v52
    v_and_b32 v101, 0xffff0000, v52
    v_lshlrev_b32 v94, 16, v17
    v_and_b32 v95, 0xffff0000, v17
    v_lshlrev_b32 v102, 16, v53
    v_and_b32 v103, 0xffff0000, v53
    v_lshlrev_b32 v96, 16, v18
    v_and_b32 v97, 0xffff0000, v18
    v_lshlrev_b32 v104, 16, v54
    v_and_b32 v105, 0xffff0000, v54
    v_lshlrev_b32 v98, 16, v19
    v_and_b32 v99, 0xffff0000, v19
    v_lshlrev_b32 v106, 16, v55
    v_and_b32 v107, 0xffff0000, v55
    v_pk_mul_f32 v[92:93], v[92:93], v[100:101]
    v_pk_mul_f32 v[94:95], v[94:95], v[102:103]
    v_pk_mul_f32 v[96:97], v[96:97], v[104:105]
    v_pk_mul_f32 v[98:99], v[98:99], v[106:107]
    v_cvt_pk_bf16_f32 v88, v92, v93
    v_cvt_pk_bf16_f32 v89, v94, v95
    v_cvt_pk_bf16_f32 v90, v96, v97
    v_cvt_pk_bf16_f32 v91, v98, v99
    v_dot2_f32_bf16 v9, v88, v10, v9
    v_dot2_f32_bf16 v9, v89, v10, v9
    v_dot2_f32_bf16 v9, v90, v10, v9
    v_dot2_f32_bf16 v9, v91, v10, v9
    v_lshlrev_b32 v92, 16, v20
    v_and_b32 v93, 0xffff0000, v20
    v_lshlrev_b32 v100, 16, v56
    v_and_b32 v101, 0xffff0000, v56
    v_lshlrev_b32 v94, 16, v21
    v_and_b32 v95, 0xffff0000, v21
    v_lshlrev_b32 v102, 16, v57
    v_and_b32 v103, 0xffff0000, v57
    v_lshlrev_b32 v96, 16, v22
    v_and_b32 v97, 0xffff0000, v22
    v_lshlrev_b32 v104, 16, v58
    v_and_b32 v105, 0xffff0000, v58
    v_lshlrev_b32 v98, 16, v23
    v_and_b32 v99, 0xffff0000, v23
    v_lshlrev_b32 v106, 16, v59
    v_and_b32 v107, 0xffff0000, v59
    v_pk_mul_f32 v[92:93], v[92:93], v[100:101]
    v_pk_mul_f32 v[94:95], v[94:95], v[102:103]
    v_pk_mul_f32 v[96:97], v[96:97], v[104:105]
    v_pk_mul_f32 v[98:99], v[98:99], v[106:107]
    v_cvt_pk_bf16_f32 v88, v92, v93
    v_cvt_pk_bf16_f32 v89, v94, v95
    v_cvt_pk_bf16_f32 v90, v96, v97
    v_cvt_pk_bf16_f32 v91, v98, v99
    v_dot2_f32_bf16 v9, v88, v10, v9
    v_dot2_f32_bf16 v9, v89, v10, v9
    v_dot2_f32_bf16 v9, v90, v10, v9
    v_dot2_f32_bf16 v9, v91, v10, v9
    v_lshlrev_b32 v92, 16, v24
    v_and_b32 v93, 0xffff0000, v24
    v_lshlrev_b32 v100, 16, v60
    v_and_b32 v101, 0xffff0000, v60
    v_lshlrev_b32 v94, 16, v25
    v_and_b32 v95, 0xffff0000, v25
    v_lshlrev_b32 v102, 16, v61
    v_and_b32 v103, 0xffff0000, v61
    v_lshlrev_b32 v96, 16, v26
    v_and_b32 v97, 0xffff0000, v26
    v_lshlrev_b32 v104, 16, v62
    v_and_b32 v105, 0xffff0000, v62
    v_lshlrev_b32 v98, 16, v27
    v_and_b32 v99, 0xffff0000, v27
    v_lshlrev_b32 v106, 16, v63
    v_and_b32 v107, 0xffff0000, v63
    v_pk_mul_f32 v[92:93], v[92:93], v[100:101]
    v_pk_mul_f32 v[94:95], v[94:95], v[102:103]
    v_pk_mul_f32 v[96:97], v[96:97], v[104:105]
    v_pk_mul_f32 v[98:99], v[98:99], v[106:107]
    v_cvt_pk_bf16_f32 v88, v92, v93
    v_cvt_pk_bf16_f32 v89, v94, v95
    v_cvt_pk_bf16_f32 v90, v96, v97
    v_cvt_pk_bf16_f32 v91, v98, v99
    v_dot2_f32_bf16 v9, v88, v10, v9
    v_dot2_f32_bf16 v9, v89, v10, v9
    v_dot2_f32_bf16 v9, v90, v10, v9
    v_dot2_f32_bf16 v9, v91, v10, v9
    v_lshlrev_b32 v92, 16, v28
    v_and_b32 v93, 0xffff0000, v28
    v_lshlrev_b32 v100, 16, v64
    v_and_b32 v101, 0xffff0000, v64
    v_lshlrev_b32 v94, 16, v29
    v_and_b32 v95, 0xffff0000, v29
    v_lshlrev_b32 v102, 16, v65
    v_and_b32 v103, 0xffff0000, v65
    v_lshlrev_b32 v96, 16, v30
    v_and_b32 v97, 0xffff0000, v30
    v_lshlrev_b32 v104, 16, v66
    v_and_b32 v105, 0xffff0000, v66
    v_lshlrev_b32 v98, 16, v31
    v_and_b32 v99, 0xffff0000, v31
    v_lshlrev_b32 v106, 16, v67
    v_and_b32 v107, 0xffff0000, v67
    v_pk_mul_f32 v[92:93], v[92:93], v[100:101]
    v_pk_mul_f32 v[94:95], v[94:95], v[102:103]
    v_pk_mul_f32 v[96:97], v[96:97], v[104:105]
    v_pk_mul_f32 v[98:99], v[98:99], v[106:107]
    v_cvt_pk_bf16_f32 v88, v92, v93
    v_cvt_pk_bf16_f32 v89, v94, v95
    v_cvt_pk_bf16_f32 v90, v96, v97
    v_cvt_pk_bf16_f32 v91, v98, v99
    v_dot2_f32_bf16 v9, v88, v10, v9
    v_dot2_f32_bf16 v9, v89, v10, v9
    v_dot2_f32_bf16 v9, v90, v10, v9
    v_dot2_f32_bf16 v9, v91, v10, v9
    v_lshlrev_b32 v92, 16, v32
    v_and_b32 v93, 0xffff0000, v32
    v_lshlrev_b32 v100, 16, v68
    v_and_b32 v101, 0xffff0000, v68
    v_lshlrev_b32 v94, 16, v33
    v_and_b32 v95, 0xffff0000, v33
    v_lshlrev_b32 v102, 16, v69
    v_and_b32 v103, 0xffff0000, v69
    v_lshlrev_b32 v96, 16, v34
    v_and_b32 v97, 0xffff0000, v34
    v_lshlrev_b32 v104, 16, v70
    v_and_b32 v105, 0xffff0000, v70
    v_lshlrev_b32 v98, 16, v35
    v_and_b32 v99, 0xffff0000, v35
    v_lshlrev_b32 v106, 16, v71
    v_and_b32 v107, 0xffff0000, v71
    v_pk_mul_f32 v[92:93], v[92:93], v[100:101]
    v_pk_mul_f32 v[94:95], v[94:95], v[102:103]
    v_pk_mul_f32 v[96:97], v[96:97], v[104:105]
    v_pk_mul_f32 v[98:99], v[98:99], v[106:107]
    v_cvt_pk_bf16_f32 v88, v92, v93
    v_cvt_pk_bf16_f32 v89, v94, v95
    v_cvt_pk_bf16_f32 v90, v96, v97
    v_cvt_pk_bf16_f32 v91, v98, v99
    v_dot2_f32_bf16 v9, v88, v10, v9
    v_dot2_f32_bf16 v9, v89, v10, v9
    v_dot2_f32_bf16 v9, v90, v10, v9
    v_dot2_f32_bf16 v9, v91, v10, v9
    v_lshlrev_b32 v92, 16, v36
    v_and_b32 v93, 0xffff0000, v36
    v_lshlrev_b32 v100, 16, v72
    v_and_b32 v101, 0xffff0000, v72
    v_lshlrev_b32 v94, 16, v37
    v_and_b32 v95, 0xffff0000, v37
    v_lshlrev_b32 v102, 16, v73
    v_and_b32 v103, 0xffff0000, v73
    v_lshlrev_b32 v96, 16, v38
    v_and_b32 v97, 0xffff0000, v38
    v_lshlrev_b32 v104, 16, v74
    v_and_b32 v105, 0xffff0000, v74
    v_lshlrev_b32 v98, 16, v39
    v_and_b32 v99, 0xffff0000, v39
    v_lshlrev_b32 v106, 16, v75
    v_and_b32 v107, 0xffff0000, v75
    v_pk_mul_f32 v[92:93], v[92:93], v[100:101]
    v_pk_mul_f32 v[94:95], v[94:95], v[102:103]
    v_pk_mul_f32 v[96:97], v[96:97], v[104:105]
    v_pk_mul_f32 v[98:99], v[98:99], v[106:107]
    v_cvt_pk_bf16_f32 v88, v92, v93
    v_cvt_pk_bf16_f32 v89, v94, v95
    v_cvt_pk_bf16_f32 v90, v96, v97
    v_cvt_pk_bf16_f32 v91, v98, v99
    v_dot2_f32_bf16 v9, v88, v10, v9
    v_dot2_f32_bf16 v9, v89, v10, v9
    v_dot2_f32_bf16 v9, v90, v10, v9
    v_dot2_f32_bf16 v9, v91, v10, v9
    v_lshlrev_b32 v92, 16, v40
    v_and_b32 v93, 0xffff0000, v40
    v_lshlrev_b32 v100, 16, v76
    v_and_b32 v101, 0xffff0000, v76
    v_lshlrev_b32 v94, 16, v41
    v_and_b32 v95, 0xffff0000, v41
    v_lshlrev_b32 v102, 16, v77
    v_and_b32 v103, 0xffff0000, v77
    v_lshlrev_b32 v96, 16, v42
    v_and_b32 v97, 0xffff0000, v42
    v_lshlrev_b32 v104, 16, v78
    v_and_b32 v105, 0xffff0000, v78
    v_lshlrev_b32 v98, 16, v43
    v_and_b32 v99, 0xffff0000, v43
    v_lshlrev_b32 v106, 16, v79
    v_and_b32 v107, 0xffff0000, v79
    v_pk_mul_f32 v[92:93], v[92:93], v[100:101]
    v_pk_mul_f32 v[94:95], v[94:95], v[102:103]
    v_pk_mul_f32 v[96:97], v[96:97], v[104:105]
    v_pk_mul_f32 v[98:99], v[98:99], v[106:107]
    v_cvt_pk_bf16_f32 v88, v92, v93
    v_cvt_pk_bf16_f32 v89, v94, v95
    v_cvt_pk_bf16_f32 v90, v96, v97
    v_cvt_pk_bf16_f32 v91, v98, v99
    v_dot2_f32_bf16 v9, v88, v10, v9
    v_dot2_f32_bf16 v9, v89, v10, v9
    v_dot2_f32_bf16 v9, v90, v10, v9
    v_dot2_f32_bf16 v9, v91, v10, v9
    v_lshlrev_b32 v92, 16, v44
    v_and_b32 v93, 0xffff0000, v44
    v_lshlrev_b32 v100, 16, v80
    v_and_b32 v101, 0xffff0000, v80
    v_lshlrev_b32 v94, 16, v45
    v_and_b32 v95, 0xffff0000, v45
    v_lshlrev_b32 v102, 16, v81
    v_and_b32 v103, 0xffff0000, v81
    v_lshlrev_b32 v96, 16, v46
    v_and_b32 v97, 0xffff0000, v46
    v_lshlrev_b32 v104, 16, v82
    v_and_b32 v105, 0xffff0000, v82
    v_lshlrev_b32 v98, 16, v47
    v_and_b32 v99, 0xffff0000, v47
    v_lshlrev_b32 v106, 16, v83
    v_and_b32 v107, 0xffff0000, v83
    v_pk_mul_f32 v[92:93], v[92:93], v[100:101]
    v_pk_mul_f32 v[94:95], v[94:95], v[102:103]
    v_pk_mul_f32 v[96:97], v[96:97], v[104:105]
    v_pk_mul_f32 v[98:99], v[98:99], v[106:107]
    v_cvt_pk_bf16_f32 v88, v92, v93
    v_cvt_pk_bf16_f32 v89, v94, v95
    v_cvt_pk_bf16_f32 v90, v96, v97
    v_cvt_pk_bf16_f32 v91, v98, v99
    v_dot2_f32_bf16 v9, v88, v10, v9
    v_dot2_f32_bf16 v9, v89, v10, v9
    v_dot2_f32_bf16 v9, v90, v10, v9
    v_dot2_f32_bf16 v9, v91, v10, v9
    v_lshlrev_b32 v92, 16, v48
    v_and_b32 v93, 0xffff0000, v48
    v_lshlrev_b32 v100, 16, v84
    v_and_b32 v101, 0xffff0000, v84
    v_lshlrev_b32 v94, 16, v49
    v_and_b32 v95, 0xffff0000, v49
    v_lshlrev_b32 v102, 16, v85
    v_and_b32 v103, 0xffff0000, v85
    v_lshlrev_b32 v96, 16, v50
    v_and_b32 v97, 0xffff0000, v50
    v_lshlrev_b32 v104, 16, v86
    v_and_b32 v105, 0xffff0000, v86
    v_lshlrev_b32 v98, 16, v51
    v_and_b32 v99, 0xffff0000, v51
    v_lshlrev_b32 v106, 16, v87
    v_and_b32 v107, 0xffff0000, v87
    v_pk_mul_f32 v[92:93], v[92:93], v[100:101]
    v_pk_mul_f32 v[94:95], v[94:95], v[102:103]
    v_pk_mul_f32 v[96:97], v[96:97], v[104:105]
    v_pk_mul_f32 v[98:99], v[98:99], v[106:107]
    v_cvt_pk_bf16_f32 v88, v92, v93
    v_cvt_pk_bf16_f32 v89, v94, v95
    v_cvt_pk_bf16_f32 v90, v96, v97
    v_cvt_pk_bf16_f32 v91, v98, v99
    v_dot2_f32_bf16 v9, v88, v10, v9
    v_dot2_f32_bf16 v9, v89, v10, v9
    v_dot2_f32_bf16 v9, v90, v10, v9
    v_dot2_f32_bf16 v9, v91, v10, v9
    s_nop 3
    v_add_f32_dpp v9, v9, v9 quad_perm:[1,0,3,2] row_mask:0xf bank_mask:0xf
    s_nop 1
    v_add_f32_dpp v9, v9, v9 quad_perm:[2,3,0,1] row_mask:0xf bank_mask:0xf
    s_nop 1
    v_add_f32_dpp v9, v9, v9 row_half_mirror row_mask:0xf bank_mask:0xf
    s_nop 1
    v_cvt_pk_bf16_f32 v9, v9, v9
    v_and_b32 v9, 0xffff0000, v9
    v_mul_f32 v9, 0xbfb8aa3b, v9
    v_exp_f32 v9, v9
    s_nop 0
    v_add_f32 v9, 1.0, v9
    v_rcp_f32 v9, v9
    s_nop 0
    v_cvt_pk_bf16_f32 v9, v9, v9
    v_and_b32 v9, 0xffff0000, v9
    s_lshl_b32 s55, s67, 5
    s_add_u32 s55, s55, 40239104
    v_lshrrev_b32 v7, 3, v3
    v_lshlrev_b32 v7, 2, v7
    v_and_b32 v5, 7, v3
    v_cmp_eq_u32 vcc, 0, v5
    s_and_saveexec_b64 s[58:59], vcc
    buffer_store_dword v9, v7, s[40:43], s55 offen sc1
    s_mov_b64 exec, -1
    s_setpc_b64 s[68:69]
L_jp_O:
    ds_write_b128 v13, v[16:19] offset:0
    ds_write_b128 v13, v[20:23] offset:1024
    ds_write_b128 v13, v[24:27] offset:2048
    ds_write_b128 v13, v[28:31] offset:3072
    ds_write_b128 v13, v[32:35] offset:4096
    ds_write_b128 v13, v[36:39] offset:5120
    ds_write_b128 v13, v[40:43] offset:6144
    ds_write_b128 v13, v[44:47] offset:7168
    ds_write_b128 v13, v[48:51] offset:8192
    v_lshrrev_b32 v9, 4, v3
    v_lshlrev_b32 v9, 2, v9
    v_bfe_u32 v10, v3, 2, 2
    v_add_u32 v9, v9, v10
    v_mul_u32_u24 v9, 288, v9
    v_and_b32 v10, 3, v3
    v_lshl_add_u32 v9, v10, 3, v9
    v_add_u32 v9, s22, v9
    s_lshr_b32 s55, s67, 2
    s_and_b32 s56, s67, 3
    s_mul_i32 s55, s55, 36864
    s_mul_i32 s56, s56, 9216
    s_add_u32 s55, s55, s56
    s_add_u32 s55, s55, 36700160
    s_waitcnt lgkmcnt(0)
    ds_read_b64_tr_b16 v[52:53], v9 offset:0
    ds_read_b64_tr_b16 v[54:55], v9 offset:4608
    ds_read_b64_tr_b16 v[56:57], v9 offset:32
    ds_read_b64_tr_b16 v[58:59], v9 offset:4640
    ds_read_b64_tr_b16 v[60:61], v9 offset:64
    ds_read_b64_tr_b16 v[62:63], v9 offset:4672
    ds_read_b64_tr_b16 v[64:65], v9 offset:96
    ds_read_b64_tr_b16 v[66:67], v9 offset:4704
    ds_read_b64_tr_b16 v[68:69], v9 offset:128
    ds_read_b64_tr_b16 v[70:71], v9 offset:4736
    ds_read_b64_tr_b16 v[72:73], v9 offset:160
    ds_read_b64_tr_b16 v[74:75], v9 offset:4768
    ds_read_b64_tr_b16 v[76:77], v9 offset:192
    ds_read_b64_tr_b16 v[78:79], v9 offset:4800
    ds_read_b64_tr_b16 v[80:81], v9 offset:224
    ds_read_b64_tr_b16 v[82:83], v9 offset:4832
    ds_read_b64_tr_b16 v[84:85], v9 offset:256
    ds_read_b64_tr_b16 v[86:87], v9 offset:4864
    s_waitcnt lgkmcnt(15)
    s_add_u32 s56, s55, 0
    buffer_store_dwordx4 v[52:55], v1, s[40:43], s56 offen sc1
    s_waitcnt lgkmcnt(14)
    s_add_u32 s56, s55, 1024
    buffer_store_dwordx4 v[56:59], v1, s[40:43], s56 offen sc1
    s_waitcnt lgkmcnt(12)
    s_add_u32 s56, s55, 2048
    buffer_store_dwordx4 v[60:63], v1, s[40:43], s56 offen sc1
    s_waitcnt lgkmcnt(10)
    s_add_u32 s56, s55, 3072
    buffer_store_dwordx4 v[64:67], v1, s[40:43], s56 offen sc1
    s_waitcnt lgkmcnt(8)
    s_add_u32 s56, s55, 4096
    buffer_store_dwordx4 v[68:71], v1, s[40:43], s56 offen sc1
    s_waitcnt lgkmcnt(6)
    s_add_u32 s56, s55, 5120
    buffer_store_dwordx4 v[72:75], v1, s[40:43], s56 offen sc1
    s_waitcnt lgkmcnt(4)
    s_add_u32 s56, s55, 6144
    buffer_store_dwordx4 v[76:79], v1, s[40:43], s56 offen sc1
    s_waitcnt lgkmcnt(2)
    s_add_u32 s56, s55, 7168
    buffer_store_dwordx4 v[80:83], v1, s[40:43], s56 offen sc1
    s_waitcnt lgkmcnt(0)
    s_add_u32 s56, s55, 8192
    buffer_store_dwordx4 v[84:87], v1, s[40:43], s56 offen sc1
    s_setpc_b64 s[68:69]
L_jp_U:
    ds_write_b128 v13, v[16:19] offset:0
    ds_write_b128 v13, v[20:23] offset:1024
    ds_write_b128 v13, v[24:27] offset:2048
    ds_write_b128 v13, v[28:31] offset:3072
    ds_write_b128 v13, v[32:35] offset:4096
    ds_write_b128 v13, v[36:39] offset:5120
    ds_write_b128 v13, v[40:43] offset:6144
    ds_write_b128 v13, v[44:47] offset:7168
    v_bfe_u32 v9, v3, 2, 2
    v_sub_u32 v9, 3, v9
    v_lshlrev_b32 v9, 7, v9
    v_lshrrev_b32 v10, 4, v3
    v_lshl_add_u32 v9, v10, 5, v9
    v_and_b32 v10, 3, v3
    v_lshl_add_u32 v9, v10, 3, v9
    v_add_u32 v9, s22, v9
    v_lshlrev_b32 v10, 7, v3
    v_add_u32 v10, s22, v10
    v_lshrrev_b32 v11, 3, v3
    v_lshlrev_b32 v11, 12, v11
    v_and_b32 v12, 7, v3
    v_lshl_add_u32 v11, v12, 4, v11
    s_mul_i32 s55, s67, 7282
    s_lshr_b32 s55, s55, 16
    s_mul_i32 s56, s55, 9
    s_sub_u32 s56, s67, s56
    s_lshl_b32 s65, s56, 5
    s_add_u32 s65, s65, s55
    s_lshl_b32 s65, s65, 2
    s_add_u32 s65, s65, 40316928
    s_lshl_b32 s56, s56, 18
    s_lshl_b32 s55, s55, 7
    s_add_u32 s55, s55, s56
    s_add_u32 s55, s55, 42991616
    s_waitcnt lgkmcnt(0)
    ds_read_b64_tr_b16 v[16:17], v9 offset:512
    ds_read_b64_tr_b16 v[18:19], v9 offset:0
    ds_read_b64_tr_b16 v[20:21], v9 offset:1536
    ds_read_b64_tr_b16 v[22:23], v9 offset:1024
    ds_read_b64_tr_b16 v[24:25], v9 offset:2560
    ds_read_b64_tr_b16 v[26:27], v9 offset:2048
    ds_read_b64_tr_b16 v[28:29], v9 offset:3584
    ds_read_b64_tr_b16 v[30:31], v9 offset:3072
    ds_read_b64_tr_b16 v[32:33], v9 offset:4608
    ds_read_b64_tr_b16 v[34:35], v9 offset:4096
    ds_read_b64_tr_b16 v[36:37], v9 offset:5632
    ds_read_b64_tr_b16 v[38:39], v9 offset:5120
    ds_read_b64_tr_b16 v[40:41], v9 offset:6656
    ds_read_b64_tr_b16 v[42:43], v9 offset:6144
    ds_read_b64_tr_b16 v[44:45], v9 offset:7680
    ds_read_b64_tr_b16 v[46:47], v9 offset:7168
    s_waitcnt lgkmcnt(0)
    ds_write_b128 v10, v[16:19] offset:0
    ds_write_b128 v10, v[20:23] offset:16
    ds_write_b128 v10, v[24:27] offset:32
    ds_write_b128 v10, v[28:31] offset:48
    ds_write_b128 v10, v[32:35] offset:64
    ds_write_b128 v10, v[36:39] offset:80
    ds_write_b128 v10, v[40:43] offset:96
    ds_write_b128 v10, v[44:47] offset:112
    s_waitcnt lgkmcnt(0)
    ds_read_b128 v[52:55], v13 offset:0
    ds_read_b128 v[56:59], v13 offset:1024
    ds_read_b128 v[60:63], v13 offset:2048
    ds_read_b128 v[64:67], v13 offset:3072
    ds_read_b128 v[68:71], v13 offset:4096
    ds_read_b128 v[72:75], v13 offset:5120
    ds_read_b128 v[76:79], v13 offset:6144
    ds_read_b128 v[80:83], v13 offset:7168
    s_waitcnt lgkmcnt(7)
    s_add_u32 s56, s55, 0
    buffer_store_dwordx4 v[52:55], v11, s[40:43], s56 offen sc1
    s_waitcnt lgkmcnt(6)
    s_add_u32 s56, s55, 32768
    buffer_store_dwordx4 v[56:59], v11, s[40:43], s56 offen sc1
    s_waitcnt lgkmcnt(5)
    s_add_u32 s56, s55, 65536
    buffer_store_dwordx4 v[60:63], v11, s[40:43], s56 offen sc1
    s_waitcnt lgkmcnt(4)
    s_add_u32 s56, s55, 98304
    buffer_store_dwordx4 v[64:67], v11, s[40:43], s56 offen sc1
    s_waitcnt lgkmcnt(3)
    s_add_u32 s56, s55, 131072
    buffer_store_dwordx4 v[68:71], v11, s[40:43], s56 offen sc1
    s_waitcnt lgkmcnt(2)
    s_add_u32 s56, s55, 163840
    buffer_store_dwordx4 v[72:75], v11, s[40:43], s56 offen sc1
    s_waitcnt lgkmcnt(1)
    s_add_u32 s56, s55, 196608
    buffer_store_dwordx4 v[76:79], v11, s[40:43], s56 offen sc1
    s_waitcnt lgkmcnt(0)
    s_add_u32 s56, s55, 229376
    buffer_store_dwordx4 v[80:83], v11, s[40:43], s56 offen sc1
L_jp_ret:
    s_setpc_b64 s[68:69]
L_zbatch:
    s_add_u32 s55, s23, s27
    s_add_u32 m0, s55, 0
    s_nop 0
    buffer_load_dwordx4 v221, s[32:35], s29 offen lds
    s_add_u32 m0, s55, 1024
    s_nop 0
    buffer_load_dwordx4 v222, s[32:35], s29 offen lds
    s_add_u32 m0, s55, 2048
    s_nop 0
    buffer_load_dwordx4 v223, s[32:35], s29 offen lds
    s_add_u32 m0, s55, 3072
    s_nop 0
    buffer_load_dwordx4 v224, s[32:35], s29 offen lds
    s_add_u32 s29, s29, 128
    s_add_u32 s55, s23, s26
    s_add_u32 m0, s55, 0
    s_nop 0
    buffer_load_dwordx4 v216, s[36:39], s28 offen lds
    s_add_u32 m0, s55, 4096
    s_nop 0
    buffer_load_dwordx4 v217, s[36:39], s28 offen lds
    s_add_u32 m0, s55, 8192
    s_nop 0
    buffer_load_dwordx4 v218, s[36:39], s28 offen lds
    s_add_u32 m0, s55, 12288
    s_nop 0
    buffer_load_dwordx4 v219, s[36:39], s28 offen lds
    s_add_u32 m0, s23, s24
    s_nop 0
    buffer_load_dwordx4 v220, s[36:39], s28 offen lds
    s_add_u32 s28, s28, 589824
    s_add_u32 s23, s23, 36864
    s_cmp_ge_u32 s23, 147456
    s_cselect_b32 s23, 0, s23
    s_setpc_b64 s[68:69]
L_mk_done:
    s_endpgm
.section .rodata,"a"
.p2align 6
.amdhsa_kernel mk_kernel
  .amdhsa_next_free_vgpr 232
  .amdhsa_next_free_sgpr 102
  .amdhsa_accum_offset 232
  .amdhsa_group_segment_fixed_size 0
  .amdhsa_kernarg_size 128
  .amdhsa_user_sgpr_count 2
  .amdhsa_user_sgpr_kernarg_segment_ptr 1
  .amdhsa_system_sgpr_workgroup_id_x 1
.end_amdhsa_kernel
```
